```python
import torch

def _softmax(x, axis=-1):
    return torch.softmax(x, dim=axis)
def _gelu(x):
    return torch.nn.functional.gelu(x, approximate="tanh")
def _silu(x):
    return torch.nn.functional.silu(x)
def _sigmoid(x):
    return torch.sigmoid(x)
def _layernorm(x, axis=-1, eps=1e-5):
    m = x.mean(dim=axis, keepdim=True)
    v = x.var(dim=axis, keepdim=True, unbiased=False)
    return (x - m) / torch.sqrt(v + eps)
def _scatter_add(tgt, idx, src, axis=0):
    return tgt.clone().index_add_(axis, idx, src)
def _segment_sum(src, seg, n):
    out = torch.zeros((n,) + src.shape[1:], dtype=src.dtype)
    return out.index_add_(0, seg, src)
def _pad(x, pw):
    flat = tuple(v for pair in reversed(pw) for v in pair)
    return torch.nn.functional.pad(x, flat)

kernel_name = 'concat_heads__linear_attn_block__sliding_local_dilated__prompt'

def setup_inputs():

    _w = (lambda a: (lambda t: t.to(torch.bfloat16) if t.is_floating_point() else t)(torch.as_tensor(a)))
    def _A_setup():
        B, S, D = 1, 2048, 640
        return {
            "x": _w((lambda *s: torch.randn(*s, dtype=torch.bfloat16) * 0.05)(B, S, D)),
            "wqkv": _w((lambda *s: torch.randn(*s, dtype=torch.bfloat16) * 1.6)(D, 3 * D)),
            "wo": _w((lambda *s: torch.randn(*s, dtype=torch.bfloat16) * 0.8)(D, D)),
        }
    _A_in = _A_setup()

    def _B_setup():
        B, S, D = 1, 2048, 640
        return {
            "x": _w((lambda *s: torch.randn(*s, dtype=torch.bfloat16) * 0.2)(B, S, D)),
            "wqkv": _w((lambda *s: torch.randn(*s, dtype=torch.bfloat16) * 0.2)(D, 3 * D)),
            "wo": _w((lambda *s: torch.randn(*s, dtype=torch.bfloat16) * 0.05)(D, D)),
        }
    _B_in = _B_setup()

    return {
        "A_x": _A_in["x"],
        "A_wqkv": _A_in["wqkv"],
        "A_wo": _A_in["wo"],
        "B_x": _B_in["x"],
        "B_wqkv": _B_in["wqkv"],
        "B_wo": _B_in["wo"],
    }

def reference(A_x, A_wqkv, A_wo, B_x, B_wqkv, B_wo):
    def _A_ref(x, wqkv, wo):
        B, S, D = x.shape
        H = 32; Dh = D // H
        qkv = (lambda x, *d: x.permute(*d))((x @ wqkv).reshape(B, S, 3, H, Dh), 2, 0, 3, 1, 4)
        q, k, v = qkv[0], qkv[1], qkv[2]
        phi = lambda t: torch.where(t > 0, t + 1, torch.exp(t)) + 1e-6
        pq, pk = phi(q), phi(k)
        kv = torch.einsum("bhsd,bhse->bhde", pk, v)
        z = torch.einsum("bhsd->bhd", pk)
        num = torch.einsum("bhqd,bhde->bhqe", pq, kv)
        den = torch.einsum("bhqd,bhd->bhq", pq, z)[..., None] + 1e-6
        o = num / den
        return (lambda x, *d: x.permute(*d))(o, 0, 2, 1, 3).reshape(B, S, D) @ wo

    def _B_ref(x, wqkv, wo):
        B, S, D = x.shape
        H = 32; Dh = D // H
        W, dil = 8, 2
        qkv = (lambda x, *d: x.permute(*d))((x @ wqkv).reshape(B, S, 3, H, Dh), 2, 0, 3, 1, 4)
        q, k, v = qkv[0], qkv[1], qkv[2]
        scale = Dh ** -0.5
        pos = torch.arange(S)
        off = torch.arange(W) * dil
        idx = pos[:, None] - off[None, :]
        mask = idx >= 0
        idx_c = torch.where(mask, idx, 0).reshape(-1)
        kg = k[:, :, idx_c, :].reshape(B, H, S, W, Dh)
        vg = v[:, :, idx_c, :].reshape(B, H, S, W, Dh)
        logits = torch.einsum("bhsd,bhswd->bhsw", q, kg) * scale
        logits = torch.where(mask[None, None, :, :], logits, -1e9)
        attn = _softmax(logits, axis=-1)
        o = torch.einsum("bhsw,bhswd->bhsd", attn, vg)
        return (lambda x, *d: x.permute(*d))(o, 0, 2, 1, 3).reshape(B, S, D) @ wo

    a = _A_ref(A_x, A_wqkv, A_wo)
    b = _B_ref(B_x, B_wqkv, B_wo)
    return torch.concatenate([a, b], axis=-1)
```

```asm
; @launch grid=(256,1,1) block=(512,1,1) lds=163840
.amdgcn_target "amdgcn-amd-amdhsa--gfx950"
.text
.globl concat_heads__linear_attn_block__sliding_local_dilated__prompt_kernel
.p2align 8
.type concat_heads__linear_attn_block__sliding_local_dilated__prompt_kernel,@function
concat_heads__linear_attn_block__sliding_local_dilated__prompt_kernel:
    s_cmp_ge_u32 s2, 256
    s_cbranch_scc1 L_end
    s_bitcmp1_b32 s2, 2
    s_cselect_b32 s76, 24, 0
    s_load_dwordx2 s[16:17], s[0:1], s76
    s_load_dwordx2 s[20:21], s[0:1], s76 offset:8
    v_lshrrev_b32 v11, 6, v0
    v_lshrrev_b32 v12, 4, v0
    v_readfirstlane_b32 s43, v11
    s_lshr_b32 s40, s76, 4
    s_getpc_b64 s[6:7]
L_pc:
    s_lshr_b32 s72, s2, 3
    s_lshl3_add_u32 s72, s72, s43
    s_lshl_b32 s72, s72, 7
    s_mul_i32 s73, s40, L_phase2-L_path_00
    s_add_u32 s72, s72, s73
    s_min_u32 s72, s72, L_codeend-L_path_00-4
    s_add_u32 s72, s72, L_path_00-L_pc
    s_add_u32 s6, s6, s72
    s_addc_u32 s7, s7, 0
    v_mov_b32 v86, s6
    v_mov_b32 v87, s7
    s_mov_b64 exec, 1
    global_load_dword v95, v[86:87], off
    s_mov_b64 exec, -1
    v_xor_b32 v12, v12, v0
    v_and_b32 v12, 7, v12
    v_bfe_u32 v11, v0, 3, 3
    v_mul_u32_u24 v11, 1280, v11
    s_lshr_b32 s3, s2, 3
    s_lshr_b32 s42, s2, 5
    s_add_u32 s93, s3, s42
    s_and_b32 s83, s2, 3
    s_and_b32 s3, s3, 3
    s_lshl2_add_u32 s41, s83, s3
    s_lshl3_add_u32 s4, s41, s43
    s_mul_i32 s4, s4, 20480
    s_and_b32 s75, s93, 2
    s_lshl2_add_u32 s75, s83, s75
    s_lshl_b32 s75, s75, 1
    s_lshr_b32 s75, 0x98654310, s75
    s_and_b32 s75, s75, 15
    s_lshl_b32 s50, s75, 7
    s_add_u32 s50, s50, s4
    s_mov_b32 s18, 2621440
    s_mov_b32 s19, 0x20000
    s_lshl_b32 s71, s43, 11
    s_mov_b32 m0, s71
    v_lshl_add_u32 v1, v12, 4, v11
    v_and_b32 v11, 64, v0
    v_xor_b32 v1, v1, v11
    s_waitcnt lgkmcnt(0)
    buffer_load_dwordx4 v1, s[16:19], s50 offen lds
    v_xor_b32 v2, 64, v1
    s_add_u32 m0, s71, 1024
    v_add_u32 v2, 10240, v2
    buffer_load_dwordx4 v2, s[16:19], s50 offen lds
    s_mov_b32 s22, 2457600
    s_mov_b32 s23, s19
    s_mul_i32 s5, s42, 160
    s_add_u32 s5, s5, 1280
    s_mul_i32 s60, s75, 245760
    s_add_u32 s60, s60, s5
    s_lshl_b32 s70, s43, 10
    v_and_b32 v11, 0x1ff, v0
    v_mul_u32_u24 v12, 6554, v11
    v_lshrrev_b32 v12, 16, v12
    v_mul_u32_u24 v13, 10, v12
    v_sub_u32 v11, v11, v13
    v_lshrrev_b32 v13, 1, v12
    v_xor_b32 v13, v13, v12
    v_and_b32 v13, 4, v13
    v_mul_u32_u24 v13, 3, v13
    v_xor_b32 v12, v12, v13
    v_mul_u32_u24 v12, 3840, v12
    v_lshlrev_b32 v11, 4, v11
    v_add_u32 v3, v11, v12
    s_add_u32 m0, s70, 16384
    s_nop 0
    buffer_load_dwordx4 v3, s[20:23], s60 offen lds
    s_load_dwordx2 s[8:9], s[0:1], s76 offset:16
    s_load_dwordx4 s[12:15], s[0:1], 48
    s_load_dwordx2 s[10:11], s[0:1], 64
    v_and_b32 v10, 63, v0
    s_lshr_b32 s45, s43, 2
    s_and_b32 s93, s93, 3
    s_mul_i32 s83, s83, 5
    s_add_u32 s83, s83, 1
    s_lshr_b32 s83, s83, 1
    s_add_u32 s72, s43, 8
    s_cmp_ge_u32 s72, 10
    s_cselect_b32 s73, 1280, 0
    s_cselect_b32 s74, 10, 0
    s_sub_u32 s72, s72, s74
    s_lshl_b32 s72, s72, 6
    v_add_u32 v11, s72, v10
    v_mul_u32_u24 v12, 6554, v11
    v_lshrrev_b32 v12, 16, v12
    v_mul_u32_u24 v13, 10, v12
    v_sub_u32 v11, v11, v13
    v_lshrrev_b32 v13, 1, v12
    v_xor_b32 v13, v13, v12
    v_and_b32 v13, 4, v13
    v_mul_u32_u24 v13, 3, v13
    v_xor_b32 v12, v12, v13
    v_mul_u32_u24 v12, 3840, v12
    v_lshlrev_b32 v11, 4, v11
    v_add3_u32 v4, v11, v12, s73
    s_add_u32 m0, s70, 24576
    s_nop 0
    buffer_load_dwordx4 v4, s[20:23], s60 offen lds
    s_lshl_b32 s72, s43, 6
    s_add_u32 s72, s72, 384
    s_mov_b32 s73, 1280
    v_add_u32 v11, s72, v10
    v_mul_u32_u24 v12, 6554, v11
    v_lshrrev_b32 v12, 16, v12
    v_mul_u32_u24 v13, 10, v12
    v_sub_u32 v11, v11, v13
    v_lshrrev_b32 v13, 1, v12
    v_xor_b32 v13, v13, v12
    v_and_b32 v13, 4, v13
    v_mul_u32_u24 v13, 3, v13
    v_xor_b32 v12, v12, v13
    v_mul_u32_u24 v12, 3840, v12
    v_lshlrev_b32 v11, 4, v11
    v_add3_u32 v5, v11, v12, s73
    s_cmp_eq_u32 s45, 0
    s_cbranch_scc0 L_no5
    s_add_u32 m0, s70, 32768
    s_nop 0
    buffer_load_dwordx4 v5, s[20:23], s60 offen lds
L_no5:
    s_cmp_eq_u32 s40, 0
    s_cbranch_scc1 L_noox
    s_and_b32 s3, s2, 3
    s_lshl_b32 s3, s3, 5
    s_lshr_b32 s6, s2, 3
    s_add_u32 s3, s3, s6
    s_lshl_b32 s3, s3, 3
    s_add_u32 s3, s3, s43
    s_mul_i32 s3, s3, 2560
    v_cmp_le_u32 vcc, 6, v10
    s_add_u32 s6, s83, 4
    v_add_u32 v88, s6, v10
    v_subrev_u32 v87, 6, v88
    v_cndmask_b32 v88, v88, v87, vcc
    v_subrev_u32 v87, 10, v88
    v_min_u32 v88, v88, v87
    v_lshlrev_b32 v88, 7, v88
    v_add_u32 v87, 1280, v88
    v_cndmask_b32 v88, v88, v87, vcc
    s_mov_b64 exec, 4095
    buffer_load_dword v95, v88, s[16:19], s3 offen
    s_mov_b64 exec, -1
L_noox:
    s_waitcnt lgkmcnt(0)
    s_mov_b32 s32, s10
    s_mov_b32 s33, s11
    s_mov_b32 s34, 268435456
    s_mov_b32 s35, 0x20000
    s_mov_b32 s36, s14
    s_mov_b32 s37, s15
    s_mov_b32 s38, 256
    s_mov_b32 s39, 0x20000
    s_and_b32 s44, s43, 3
    s_or_b32 s3, s2, s43
    s_cmp_eq_u32 s3, 0
    s_cbranch_scc0 L_nn0
    s_add_u32 s6, s10, 8519680
    s_addc_u32 s7, s11, 0
    s_load_dword s47, s[6:7], 0
L_nn0:
    s_mul_i32 s7, s45, 3
    s_xor_b32 s86, s44, s7
    s_lshl_b32 s6, s42, 16
    s_lshl_b32 s7, s86, 9
    s_add_u32 s6, s6, s7
    s_lshl_b32 s7, s45, 11
    s_add_u32 s6, s6, s7
    s_add_u32 s78, s6, 6291456
    s_lshl_b32 s7, s41, 12
    s_add_u32 s77, s78, s7
    s_lshl_b32 s6, s41, 3
    s_add_u32 s6, s6, s42
    s_mul_i32 s6, s6, 6144
    s_mul_i32 s7, s45, 3072
    s_add_u32 s79, s6, s7
    s_add_u32 s79, s79, 7340032
    s_add_u32 s49, s6, 7290880
    v_mov_b32 v76, -1
    v_mov_b32 v77, -1
    v_lshlrev_b32 v78, 3, v10
    s_cmp_eq_u32 s40, 0
    s_cbranch_scc0 L_preB
    buffer_store_dwordx2 v[76:77], v78, s[32:35], s77 offen sc1
    s_branch L_pred
L_preB:
    s_cmp_eq_u32 s44, 3
    s_cbranch_scc0 L_pred
    buffer_store_dwordx2 v[76:77], v78, s[32:35], s79 offen offset:0 sc1
    buffer_store_dwordx2 v[76:77], v78, s[32:35], s79 offen offset:512 sc1
    buffer_store_dwordx2 v[76:77], v78, s[32:35], s79 offen offset:1024 sc1
    buffer_store_dwordx2 v[76:77], v78, s[32:35], s79 offen offset:1536 sc1
    buffer_store_dwordx2 v[76:77], v78, s[32:35], s79 offen offset:2048 sc1
L_pred:
    s_mov_b32 s84, 0x87631542
    s_cmp_eq_u32 s93, 1
    s_cselect_b32 s84, 0x54287631, s84
    s_cmp_eq_u32 s93, 2
    s_cselect_b32 s84, 0x87654203, s84
    s_cmp_eq_u32 s93, 3
    s_cselect_b32 s84, 0x76549320, s84
    s_lshl_b32 s73, s93, 2
    s_lshr_b32 s85, 0x8999, s73
    s_and_b32 s85, s85, 15
    s_bfe_u32 s75, s84, 0x40000
    s_add_u32 s75, s75, s83
    s_cmp_ge_u32 s75, 10
    s_cselect_b32 s73, 10, 0
    s_sub_u32 s75, s75, s73
    s_mul_i32 s61, s75, 245760
    s_add_u32 s61, s61, s5
    s_lshl_b32 s51, s75, 7
    s_add_u32 s51, s51, s4
    s_add_u32 m0, s71, 36864
    s_nop 0
    buffer_load_dwordx4 v1, s[16:19], s51 offen lds
    s_lshl_b32 s3, s40, 1
    s_add_u32 s3, s3, s45
    s_cmp_eq_u32 s3, 1
    s_cbranch_scc1 L_path_01
    s_cmp_eq_u32 s3, 2
    s_cbranch_scc1 L_path_10
    s_cmp_eq_u32 s3, 3
    s_cbranch_scc1 L_path_11
L_path_00:
    s_cmp_eq_u32 s44, 0
    s_cselect_b32 s87, s41, 0
    s_bfe_u32 s75, s84, 0x40004
    s_add_u32 s75, s75, s83
    s_cmp_ge_u32 s75, 10
    s_cselect_b32 s73, 10, 0
    s_sub_u32 s75, s75, s73
    s_mul_i32 s62, s75, 245760
    s_add_u32 s62, s62, s5
    s_lshl_b32 s52, s75, 7
    s_add_u32 s52, s52, s4
    s_bfe_u32 s75, s84, 0x40008
    s_add_u32 s75, s75, s83
    s_cmp_ge_u32 s75, 10
    s_cselect_b32 s73, 10, 0
    s_sub_u32 s75, s75, s73
    s_mul_i32 s63, s75, 245760
    s_add_u32 s63, s63, s5
    s_lshl_b32 s53, s75, 7
    s_add_u32 s53, s53, s4
    s_bfe_u32 s75, s84, 0x4000c
    s_add_u32 s75, s75, s83
    s_cmp_ge_u32 s75, 10
    s_cselect_b32 s73, 10, 0
    s_sub_u32 s75, s75, s73
    s_mul_i32 s64, s75, 245760
    s_add_u32 s64, s64, s5
    s_lshl_b32 s54, s75, 7
    s_add_u32 s54, s54, s4
    s_bfe_u32 s75, s84, 0x40010
    s_add_u32 s75, s75, s83
    s_cmp_ge_u32 s75, 10
    s_cselect_b32 s73, 10, 0
    s_sub_u32 s75, s75, s73
    s_mul_i32 s65, s75, 245760
    s_add_u32 s65, s65, s5
    s_lshl_b32 s55, s75, 7
    s_add_u32 s55, s55, s4
    s_bfe_u32 s75, s84, 0x40014
    s_add_u32 s75, s75, s83
    s_cmp_ge_u32 s75, 10
    s_cselect_b32 s73, 10, 0
    s_sub_u32 s75, s75, s73
    s_mul_i32 s66, s75, 245760
    s_add_u32 s66, s66, s5
    s_lshl_b32 s56, s75, 7
    s_add_u32 s56, s56, s4
    s_bfe_u32 s75, s84, 0x40018
    s_add_u32 s75, s75, s83
    s_cmp_ge_u32 s75, 10
    s_cselect_b32 s73, 10, 0
    s_sub_u32 s75, s75, s73
    s_mul_i32 s67, s75, 245760
    s_add_u32 s67, s67, s5
    s_lshl_b32 s57, s75, 7
    s_add_u32 s57, s57, s4
    s_bfe_u32 s75, s84, 0x4001c
    s_add_u32 s75, s75, s83
    s_cmp_ge_u32 s75, 10
    s_cselect_b32 s73, 10, 0
    s_sub_u32 s75, s75, s73
    s_mul_i32 s68, s75, 245760
    s_add_u32 s68, s68, s5
    s_lshl_b32 s58, s75, 7
    s_add_u32 s58, s58, s4
    s_mov_b32 s75, s85
    s_add_u32 s75, s75, s83
    s_cmp_ge_u32 s75, 10
    s_cselect_b32 s73, 10, 0
    s_sub_u32 s75, s75, s73
    s_mul_i32 s69, s75, 245760
    s_add_u32 s69, s69, s5
    s_lshl_b32 s59, s75, 7
    s_add_u32 s59, s59, s4
    s_mov_b32 s24, s8
    s_mov_b32 s25, s9
    s_mov_b32 s26, 819200
    s_mov_b32 s27, 0x20000
    s_mov_b32 s28, s12
    s_mov_b32 s29, s13
    s_mov_b32 s30, 5242880
    s_mov_b32 s31, 0x20000
    s_getreg_b32 s46, hwreg(HW_REG_XCC_ID, 0, 3)
    s_mul_i32 s93, s42, 160
    s_or_b32 s3, s2, s43
    s_cmp_eq_u32 s3, 0
    s_cbranch_scc0 L_nononce
    s_waitcnt lgkmcnt(0)
    s_add_u32 s6, s47, 0x9e3779b0
    s_or_b32 s6, s6, 8
    s_andn2_b32 s6, s6, 7
    v_mov_b32 v11, s6
    v_mov_b32 v12, 0
    s_mov_b32 s3, 8519680
    s_mov_b64 exec, 1
    buffer_store_dword v11, v12, s[36:39], 0 offen sc1
    buffer_store_dword v11, v12, s[32:35], s3 offen sc1
    s_mov_b64 exec, -1
L_nononce:
    v_and_b32 v11, 15, v10
    v_lshrrev_b32 v12, 4, v10
    v_lshrrev_b32 v13, 1, v11
    v_xor_b32 v13, v13, v12
    v_lshlrev_b32 v13, 4, v13
    v_lshl_add_u32 v13, v11, 7, v13
    s_lshl_b32 s3, s44, 12
    v_add_u32 v6, s3, v13
    v_xor_b32 v7, 64, v6
    v_lshrrev_b32 v11, 5, v10
    v_lshlrev_b32 v11, 4, v11
    v_bfe_u32 v13, v10, 2, 3
    v_add_u32 v11, v11, v13
    v_mul_u32_u24 v11, 160, v11
    v_and_b32 v12, 3, v10
    v_lshl_add_u32 v8, v12, 3, v11
    v_mad_u32_u24 v9, v12, 40, v11
    v_add_u32 v9, 32, v9
    s_lshl_b32 s3, s40, 4
    s_add_u32 s3, s3, s41
    s_lshl_b32 s4, s41, 3
    s_lshl_b32 s5, s44, 1
    s_add_u32 s5, s5, s4
    s_mul_i32 s76, s5, 20480
    s_and_b32 s85, s43, 1
    s_add_u32 s5, s4, s43
    s_mul_i32 s99, s5, 40960
    s_sub_u32 s5, s5, s85
    s_mul_i32 s98, s5, 20480
    s_mul_i32 s5, s85, 10240
    s_add_u32 s98, s98, s5
    s_mov_b32 s91, s98
    s_add_u32 s99, s99, s93
    s_lshl_b32 s4, s3, 2
    s_add_u32 s5, s4, s44
    s_lshl_b32 s5, s5, 7
    s_lshl_b32 s6, s42, 3
    s_add_u32 s5, s5, s6
    s_add_u32 s9, s5, 8388608
    s_lshr_b32 s5, s43, 1
    s_add_u32 s5, s5, s4
    s_lshl_b32 s5, s5, 7
    s_add_u32 s5, s5, 8388608
    s_add_u32 s83, s5, 64
    s_lshl_b32 s7, s85, 2
    s_add_u32 s84, s83, s6
    s_add_u32 s84, s84, s7
    s_lshl_b32 s7, s85, 5
    s_add_u32 s8, s5, s7
    s_mov_b32 s94, 0x3fb8aa3b
    s_mov_b32 s95, 0x358637bd
    v_mov_b32 v80, s95
    v_mov_b32 v81, s95
    v_mov_b32 v82, s95
    v_mov_b32 v83, s95
    v_mov_b32 v84, 0
    v_and_b32 v11, 0x1ff, v0
    v_mul_u32_u24 v12, 6554, v11
    v_lshrrev_b32 v12, 16, v12
    v_mul_u32_u24 v13, 10, v12
    v_sub_u32 v11, v11, v13
    v_mul_u32_u24 v12, 1280, v12
    v_lshlrev_b32 v11, 4, v11
    v_add_u32 v90, v11, v12
    s_add_u32 s72, s43, 8
    s_cmp_ge_u32 s72, 10
    s_cselect_b32 s73, 81920, 0
    s_cselect_b32 s74, 10, 0
    s_sub_u32 s72, s72, s74
    s_lshl_b32 s72, s72, 6
    v_add_u32 v11, s72, v10
    v_mul_u32_u24 v12, 6554, v11
    v_lshrrev_b32 v12, 16, v12
    v_mul_u32_u24 v13, 10, v12
    v_sub_u32 v11, v11, v13
    v_mul_u32_u24 v12, 1280, v12
    v_lshlrev_b32 v11, 4, v11
    v_add3_u32 v91, v11, v12, s73
    s_lshl_b32 s72, s43, 6
    s_add_u32 s72, s72, 384
    s_mov_b32 s73, 81920
    v_add_u32 v11, s72, v10
    v_mul_u32_u24 v12, 6554, v11
    v_lshrrev_b32 v12, 16, v12
    v_mul_u32_u24 v13, 10, v12
    v_sub_u32 v11, v11, v13
    v_mul_u32_u24 v12, 1280, v12
    v_lshlrev_b32 v11, 4, v11
    v_add3_u32 v92, v11, v12, s73
    v_and_b32 v11, 7, v10
    v_lshlrev_b32 v11, 7, v11
    s_mul_i32 s3, s42, 2560
    s_add_u32 s3, s3, 0
    v_add_u32 v11, s3, v11
    v_bfe_u32 v12, v10, 3, 1
    v_mul_u32_u24 v12, 20480, v12
    v_add_u32 v11, v11, v12
    v_and_b32 v12, 1, v10
    v_lshlrev_b32 v12, 7, v12
    s_add_u32 s3, s3, 1024
    v_add_u32 v12, s3, v12
    v_bfe_u32 v13, v10, 1, 1
    v_mul_u32_u24 v13, 20480, v13
    v_add_u32 v12, v12, v13
    s_mov_b32 vcc_lo, 0xffff
    s_mov_b32 vcc_hi, 0x0
    v_cndmask_b32 v93, v12, v11, vcc
    v_mov_b32 v56, 0
    v_and_b32 v94, 31, v10
    v_lshlrev_b32 v94, 4, v94
    v_lshrrev_b32 v11, 5, v10
    v_lshl_add_u32 v94, v11, 15, v94
    v_mov_b32 v57, 0x3f80
    v_mov_b32 v58, 0x3f800000
    s_mov_b32 vcc_lo, 0xaaaaaaaa
    s_mov_b32 vcc_hi, 0xaaaaaaaa
    v_cndmask_b32 v57, v57, v58, vcc
    s_mov_b32 vcc_lo, 0x3000003
    s_mov_b32 vcc_hi, 0x3000003
    v_cndmask_b32 v16, v56, v57, vcc
    s_mov_b32 vcc_lo, 0xc00000c
    s_mov_b32 vcc_hi, 0xc00000c
    v_cndmask_b32 v17, v56, v57, vcc
    s_mov_b32 vcc_lo, 0x30000030
    s_mov_b32 vcc_hi, 0x30000030
    v_cndmask_b32 v18, v56, v57, vcc
    s_mov_b32 vcc_lo, 0xc00000c0
    s_mov_b32 vcc_hi, 0xc00000c0
    v_cndmask_b32 v19, v56, v57, vcc
    v_mov_b32 v20, s95
    v_mov_b32 v21, s95
    v_mov_b32 v22, 0
    v_mov_b32 v23, 0
    v_and_b32 v24, 15, v10
    v_lshlrev_b32 v24, 1, v24
    v_and_b32 v25, 32, v10
    v_add_u32 v24, v24, v25
    v_bfe_u32 v25, v10, 4, 1
    v_add_u32 v24, v24, v25
    v_lshlrev_b32 v24, 4, v24
    v_xor_b32 v25, 512, v24
    v_mov_b32 v26, 0
    v_mov_b32 v26, 0
    v_mov_b32 v27, 0
    v_lshlrev_b32 v11, 4, v10
    v_add_u32 v11, 148480, v11
    ds_write_b128 v11, v[16:19] offset:0
    ds_write_b128 v11, v[20:23] offset:1024
    ds_write_b128 v11, v[24:27] offset:2048
    s_waitcnt lgkmcnt(0)
    s_add_u32 m0, s71, 37888
    s_nop 0
    buffer_load_dwordx4 v2, s[16:19], s51 offen lds
    s_add_u32 m0, s70, 53248
    s_nop 0
    buffer_load_dwordx4 v3, s[20:23], s61 offen lds
    s_add_u32 m0, s70, 61440
    s_nop 0
    buffer_load_dwordx4 v4, s[20:23], s61 offen lds
    s_add_u32 m0, s70, 69632
    s_nop 0
    buffer_load_dwordx4 v5, s[20:23], s61 offen lds
    s_waitcnt vmcnt(6)
    s_barrier
    ds_read_b128 v[96:99], v6 offset:0
    ds_read_b128 v[100:103], v6 offset:2048
    ds_read_b64_tr_b16 v[56:57], v8 offset:16384
    ds_read_b64_tr_b16 v[58:59], v8 offset:17664
    ds_read_b64_tr_b16 v[60:61], v8 offset:16424
    ds_read_b64_tr_b16 v[62:63], v8 offset:17704
    ds_read_b64_tr_b16 v[64:65], v8 offset:26624
    ds_read_b64_tr_b16 v[66:67], v8 offset:27904
    ds_read_b64_tr_b16 v[68:69], v8 offset:26664
    ds_read_b64_tr_b16 v[70:71], v8 offset:27944
    ds_read_b64_tr_b16 v[72:73], v9 offset:16384
    ds_read_b64_tr_b16 v[74:75], v9 offset:17664
    s_waitcnt lgkmcnt(8)
    v_mfma_f32_16x16x32_bf16 v[16:19], v[96:99], v[56:59], v[80:83]
    v_mfma_f32_16x16x32_bf16 v[20:23], v[100:103], v[56:59], v[80:83]
    s_cmp_eq_u32 s43, 0
    s_cbranch_scc0 L_nl_00
    v_mov_b32 v84, 0
    buffer_load_dword v85, v84, s[36:39], 0 offen sc1
L_nl_00:
    ds_read_b128 v[104:107], v7 offset:0
    ds_read_b128 v[108:111], v7 offset:2048
    ds_read_b64_tr_b16 v[56:57], v8 offset:21504
    ds_read_b64_tr_b16 v[58:59], v8 offset:22784
    s_waitcnt lgkmcnt(10)
    s_add_u32 m0, s71, 73728
    v_mfma_f32_16x16x32_bf16 v[24:27], v[96:99], v[60:63], v[80:83]
    v_mfma_f32_16x16x32_bf16 v[28:31], v[100:103], v[60:63], v[80:83]
    buffer_load_dwordx4 v1, s[16:19], s52 offen lds
    ds_read_b64_tr_b16 v[60:61], v8 offset:21544
    ds_read_b64_tr_b16 v[62:63], v8 offset:22824
    s_waitcnt lgkmcnt(10)
    s_add_u32 m0, s71, 74752
    v_mfma_f32_16x16x32_bf16 v[32:35], v[96:99], v[64:67], 0
    v_mfma_f32_16x16x32_bf16 v[36:39], v[100:103], v[64:67], 0
    buffer_load_dwordx4 v2, s[16:19], s52 offen lds
    ds_read_b64_tr_b16 v[64:65], v8 offset:31744
    ds_read_b64_tr_b16 v[66:67], v8 offset:33024
    s_waitcnt lgkmcnt(10)
    s_add_u32 m0, s70, 90112
    v_mfma_f32_16x16x32_bf16 v[40:43], v[96:99], v[68:71], 0
    v_mfma_f32_16x16x32_bf16 v[44:47], v[100:103], v[68:71], 0
    buffer_load_dwordx4 v3, s[20:23], s62 offen lds
    ds_read_b64_tr_b16 v[68:69], v8 offset:31784
    ds_read_b64_tr_b16 v[70:71], v8 offset:33064
    s_waitcnt lgkmcnt(10)
    s_add_u32 m0, s70, 98304
    v_mfma_f32_16x16x32_bf16 v[48:51], v[96:99], v[72:75], v[80:83]
    v_mfma_f32_16x16x32_bf16 v[52:55], v[100:103], v[72:75], v[80:83]
    buffer_load_dwordx4 v4, s[20:23], s62 offen lds
    ds_read_b64_tr_b16 v[72:73], v9 offset:21504
    ds_read_b64_tr_b16 v[74:75], v9 offset:22784
    s_waitcnt lgkmcnt(8)
    s_add_u32 m0, s70, 106496
    v_mfma_f32_16x16x32_bf16 v[16:19], v[104:107], v[56:59], v[16:19]
    v_mfma_f32_16x16x32_bf16 v[20:23], v[108:111], v[56:59], v[20:23]
    buffer_load_dwordx4 v5, s[20:23], s62 offen lds
    s_waitcnt lgkmcnt(6)
    v_mfma_f32_16x16x32_bf16 v[24:27], v[104:107], v[60:63], v[24:27]
    v_mfma_f32_16x16x32_bf16 v[28:31], v[108:111], v[60:63], v[28:31]
    s_waitcnt lgkmcnt(4)
    v_mfma_f32_16x16x32_bf16 v[32:35], v[104:107], v[64:67], v[32:35]
    v_mfma_f32_16x16x32_bf16 v[36:39], v[108:111], v[64:67], v[36:39]
    v_add_u32 v6, 36864, v6
    v_add_u32 v7, 36864, v7
    v_add_u32 v8, 36864, v8
    v_add_u32 v9, 36864, v9
    s_cmp_eq_u32 s43, 0
    s_cbranch_scc1 L_gw527
    s_waitcnt vmcnt(5)
    s_branch L_gx527
L_gw527:
    s_waitcnt vmcnt(6)
L_gx527:
    s_barrier
    ds_read_b128 v[112:115], v6 offset:0
    ds_read_b128 v[116:119], v6 offset:2048
    ds_read_b64_tr_b16 v[56:57], v8 offset:16384
    ds_read_b64_tr_b16 v[58:59], v8 offset:17664
    ds_read_b64_tr_b16 v[60:61], v8 offset:16424
    ds_read_b64_tr_b16 v[62:63], v8 offset:17704
    ds_read_b64_tr_b16 v[64:65], v8 offset:26624
    ds_read_b64_tr_b16 v[66:67], v8 offset:27904
    s_waitcnt lgkmcnt(10)
    v_mfma_f32_16x16x32_bf16 v[40:43], v[104:107], v[68:71], v[40:43]
    v_mfma_f32_16x16x32_bf16 v[44:47], v[108:111], v[68:71], v[44:47]
    s_cmp_eq_u32 s43, 0
    s_cbranch_scc0 L_nc_00
    s_waitcnt vmcnt(5)
    v_readfirstlane_b32 s47, v85
    s_nop 0
    s_cmp_lg_u32 s47, 0
    s_cbranch_scc1 L_nok_00
    s_mov_b32 s92, 0
L_nsp_00:
    buffer_load_dword v85, v84, s[36:39], 0 offen sc1
    s_waitcnt vmcnt(0)
    v_readfirstlane_b32 s47, v85
    s_nop 0
    s_cmp_lg_u32 s47, 0
    s_cbranch_scc1 L_nok_00
    s_add_u32 s92, s92, 1
    s_cmp_lt_u32 s92, 200000
    s_cbranch_scc1 L_nsp_00
L_nok_00:
    s_lshl_b32 s3, s40, 4
    s_add_u32 s3, s3, s41
    s_lshl_b32 s3, s3, 3
    s_add_u32 s3, s3, s42
    s_lshl_b32 s3, s3, 7
    s_add_u32 s3, s3, 8454144
    s_or_b32 s4, s47, s46
    v_mov_b32 v85, s4
    s_mov_b64 exec, 1
    buffer_store_dword v85, v84, s[32:35], s3 offen sc1
    s_mov_b64 exec, -1
L_nc_00:
    ds_read_b64_tr_b16 v[68:69], v8 offset:26664
    ds_read_b64_tr_b16 v[70:71], v8 offset:27944
    s_waitcnt lgkmcnt(10)
    s_add_u32 m0, s71, 110592
    v_mfma_f32_16x16x32_bf16 v[48:51], v[104:107], v[72:75], v[48:51]
    v_mfma_f32_16x16x32_bf16 v[52:55], v[108:111], v[72:75], v[52:55]
    buffer_load_dwordx4 v1, s[16:19], s53 offen lds
    ds_read_b64_tr_b16 v[72:73], v9 offset:16384
    ds_read_b64_tr_b16 v[74:75], v9 offset:17664
    s_waitcnt lgkmcnt(8)
    s_add_u32 m0, s71, 111616
    v_mfma_f32_16x16x32_bf16 v[16:19], v[112:115], v[56:59], v[16:19]
    v_mfma_f32_16x16x32_bf16 v[20:23], v[116:119], v[56:59], v[20:23]
    buffer_load_dwordx4 v2, s[16:19], s53 offen lds
    ds_read_b128 v[120:123], v7 offset:0
    ds_read_b128 v[124:127], v7 offset:2048
    ds_read_b64_tr_b16 v[56:57], v8 offset:21504
    ds_read_b64_tr_b16 v[58:59], v8 offset:22784
    s_waitcnt lgkmcnt(10)
    s_add_u32 m0, s70, 126976
    v_mfma_f32_16x16x32_bf16 v[24:27], v[112:115], v[60:63], v[24:27]
    v_mfma_f32_16x16x32_bf16 v[28:31], v[116:119], v[60:63], v[28:31]
    buffer_load_dwordx4 v3, s[20:23], s63 offen lds
    ds_read_b64_tr_b16 v[60:61], v8 offset:21544
    ds_read_b64_tr_b16 v[62:63], v8 offset:22824
    s_waitcnt lgkmcnt(10)
    s_add_u32 m0, s70, 135168
    v_mfma_f32_16x16x32_bf16 v[32:35], v[112:115], v[64:67], v[32:35]
    v_mfma_f32_16x16x32_bf16 v[36:39], v[116:119], v[64:67], v[36:39]
    buffer_load_dwordx4 v4, s[20:23], s63 offen lds
    ds_read_b64_tr_b16 v[64:65], v8 offset:31744
    ds_read_b64_tr_b16 v[66:67], v8 offset:33024
    s_waitcnt lgkmcnt(10)
    s_add_u32 m0, s70, 143360
    v_mfma_f32_16x16x32_bf16 v[40:43], v[112:115], v[68:71], v[40:43]
    v_mfma_f32_16x16x32_bf16 v[44:47], v[116:119], v[68:71], v[44:47]
    buffer_load_dwordx4 v5, s[20:23], s63 offen lds
    ds_read_b64_tr_b16 v[68:69], v8 offset:31784
    ds_read_b64_tr_b16 v[70:71], v8 offset:33064
    s_waitcnt lgkmcnt(10)
    v_mfma_f32_16x16x32_bf16 v[48:51], v[112:115], v[72:75], v[48:51]
    v_mfma_f32_16x16x32_bf16 v[52:55], v[116:119], v[72:75], v[52:55]
    ds_read_b64_tr_b16 v[72:73], v9 offset:21504
    ds_read_b64_tr_b16 v[74:75], v9 offset:22784
    s_waitcnt lgkmcnt(8)
    v_mfma_f32_16x16x32_bf16 v[16:19], v[120:123], v[56:59], v[16:19]
    v_mfma_f32_16x16x32_bf16 v[20:23], v[124:127], v[56:59], v[20:23]
    s_waitcnt lgkmcnt(6)
    v_mfma_f32_16x16x32_bf16 v[24:27], v[120:123], v[60:63], v[24:27]
    v_mfma_f32_16x16x32_bf16 v[28:31], v[124:127], v[60:63], v[28:31]
    s_waitcnt lgkmcnt(4)
    v_mfma_f32_16x16x32_bf16 v[32:35], v[120:123], v[64:67], v[32:35]
    v_mfma_f32_16x16x32_bf16 v[36:39], v[124:127], v[64:67], v[36:39]
    v_add_u32 v6, 36864, v6
    v_add_u32 v7, 36864, v7
    v_add_u32 v8, 36864, v8
    v_add_u32 v9, 36864, v9
    s_cmp_eq_u32 s43, 0
    s_cbranch_scc1 L_gw621
    s_waitcnt vmcnt(5)
    s_branch L_gx621
L_gw621:
    s_waitcnt vmcnt(6)
L_gx621:
    s_barrier
    ds_read_b128 v[128:131], v6 offset:0
    ds_read_b128 v[132:135], v6 offset:2048
    ds_read_b64_tr_b16 v[56:57], v8 offset:16384
    ds_read_b64_tr_b16 v[58:59], v8 offset:17664
    ds_read_b64_tr_b16 v[60:61], v8 offset:16424
    ds_read_b64_tr_b16 v[62:63], v8 offset:17704
    ds_read_b64_tr_b16 v[64:65], v8 offset:26624
    ds_read_b64_tr_b16 v[66:67], v8 offset:27904
    s_waitcnt lgkmcnt(10)
    s_add_u32 m0, s71, 0
    v_mfma_f32_16x16x32_bf16 v[40:43], v[120:123], v[68:71], v[40:43]
    v_mfma_f32_16x16x32_bf16 v[44:47], v[124:127], v[68:71], v[44:47]
    buffer_load_dwordx4 v1, s[16:19], s54 offen lds
    ds_read_b64_tr_b16 v[68:69], v8 offset:26664
    ds_read_b64_tr_b16 v[70:71], v8 offset:27944
    s_waitcnt lgkmcnt(10)
    s_add_u32 m0, s71, 1024
    v_mfma_f32_16x16x32_bf16 v[48:51], v[120:123], v[72:75], v[48:51]
    v_mfma_f32_16x16x32_bf16 v[52:55], v[124:127], v[72:75], v[52:55]
    buffer_load_dwordx4 v2, s[16:19], s54 offen lds
    ds_read_b64_tr_b16 v[72:73], v9 offset:16384
    ds_read_b64_tr_b16 v[74:75], v9 offset:17664
    s_waitcnt lgkmcnt(8)
    s_add_u32 m0, s70, 16384
    v_mfma_f32_16x16x32_bf16 v[16:19], v[128:131], v[56:59], v[16:19]
    v_mfma_f32_16x16x32_bf16 v[20:23], v[132:135], v[56:59], v[20:23]
    buffer_load_dwordx4 v3, s[20:23], s64 offen lds
    ds_read_b128 v[136:139], v7 offset:0
    ds_read_b128 v[140:143], v7 offset:2048
    ds_read_b64_tr_b16 v[56:57], v8 offset:21504
    ds_read_b64_tr_b16 v[58:59], v8 offset:22784
    s_waitcnt lgkmcnt(10)
    s_add_u32 m0, s70, 24576
    v_mfma_f32_16x16x32_bf16 v[24:27], v[128:131], v[60:63], v[24:27]
    v_mfma_f32_16x16x32_bf16 v[28:31], v[132:135], v[60:63], v[28:31]
    buffer_load_dwordx4 v4, s[20:23], s64 offen lds
    ds_read_b64_tr_b16 v[60:61], v8 offset:21544
    ds_read_b64_tr_b16 v[62:63], v8 offset:22824
    s_waitcnt lgkmcnt(10)
    s_add_u32 m0, s70, 32768
    v_mfma_f32_16x16x32_bf16 v[32:35], v[128:131], v[64:67], v[32:35]
    v_mfma_f32_16x16x32_bf16 v[36:39], v[132:135], v[64:67], v[36:39]
    buffer_load_dwordx4 v5, s[20:23], s64 offen lds
    ds_read_b64_tr_b16 v[64:65], v8 offset:31744
    ds_read_b64_tr_b16 v[66:67], v8 offset:33024
    s_waitcnt lgkmcnt(10)
    v_mfma_f32_16x16x32_bf16 v[40:43], v[128:131], v[68:71], v[40:43]
    v_mfma_f32_16x16x32_bf16 v[44:47], v[132:135], v[68:71], v[44:47]
    ds_read_b64_tr_b16 v[68:69], v8 offset:31784
    ds_read_b64_tr_b16 v[70:71], v8 offset:33064
    s_waitcnt lgkmcnt(10)
    v_mfma_f32_16x16x32_bf16 v[48:51], v[128:131], v[72:75], v[48:51]
    v_mfma_f32_16x16x32_bf16 v[52:55], v[132:135], v[72:75], v[52:55]
    ds_read_b64_tr_b16 v[72:73], v9 offset:21504
    ds_read_b64_tr_b16 v[74:75], v9 offset:22784
    s_waitcnt lgkmcnt(8)
    v_mfma_f32_16x16x32_bf16 v[16:19], v[136:139], v[56:59], v[16:19]
    v_mfma_f32_16x16x32_bf16 v[20:23], v[140:143], v[56:59], v[20:23]
    s_waitcnt lgkmcnt(6)
    v_mfma_f32_16x16x32_bf16 v[24:27], v[136:139], v[60:63], v[24:27]
    v_mfma_f32_16x16x32_bf16 v[28:31], v[140:143], v[60:63], v[28:31]
    s_waitcnt lgkmcnt(4)
    v_mfma_f32_16x16x32_bf16 v[32:35], v[136:139], v[64:67], v[32:35]
    v_mfma_f32_16x16x32_bf16 v[36:39], v[140:143], v[64:67], v[36:39]
    v_add_u32 v6, 36864, v6
    v_add_u32 v7, 36864, v7
    v_add_u32 v8, 36864, v8
    v_add_u32 v9, 36864, v9
    s_waitcnt vmcnt(5)
    s_barrier
    ds_read_b128 v[144:147], v6 offset:0
    ds_read_b128 v[148:151], v6 offset:2048
    ds_read_b64_tr_b16 v[56:57], v8 offset:16384
    ds_read_b64_tr_b16 v[58:59], v8 offset:17664
    ds_read_b64_tr_b16 v[60:61], v8 offset:16424
    ds_read_b64_tr_b16 v[62:63], v8 offset:17704
    ds_read_b64_tr_b16 v[64:65], v8 offset:26624
    ds_read_b64_tr_b16 v[66:67], v8 offset:27904
    s_waitcnt lgkmcnt(10)
    s_add_u32 m0, s71, 36864
    v_mfma_f32_16x16x32_bf16 v[40:43], v[136:139], v[68:71], v[40:43]
    v_mfma_f32_16x16x32_bf16 v[44:47], v[140:143], v[68:71], v[44:47]
    buffer_load_dwordx4 v1, s[16:19], s55 offen lds
    ds_read_b64_tr_b16 v[68:69], v8 offset:26664
    ds_read_b64_tr_b16 v[70:71], v8 offset:27944
    s_waitcnt lgkmcnt(10)
    s_add_u32 m0, s71, 37888
    v_mfma_f32_16x16x32_bf16 v[48:51], v[136:139], v[72:75], v[48:51]
    v_mfma_f32_16x16x32_bf16 v[52:55], v[140:143], v[72:75], v[52:55]
    buffer_load_dwordx4 v2, s[16:19], s55 offen lds
    ds_read_b64_tr_b16 v[72:73], v9 offset:16384
    ds_read_b64_tr_b16 v[74:75], v9 offset:17664
    s_waitcnt lgkmcnt(8)
    s_add_u32 m0, s70, 53248
    v_mfma_f32_16x16x32_bf16 v[16:19], v[144:147], v[56:59], v[16:19]
    v_mfma_f32_16x16x32_bf16 v[20:23], v[148:151], v[56:59], v[20:23]
    buffer_load_dwordx4 v3, s[20:23], s65 offen lds
    ds_read_b128 v[152:155], v7 offset:0
    ds_read_b128 v[156:159], v7 offset:2048
    ds_read_b64_tr_b16 v[56:57], v8 offset:21504
    ds_read_b64_tr_b16 v[58:59], v8 offset:22784
    s_waitcnt lgkmcnt(10)
    s_add_u32 m0, s70, 61440
    v_mfma_f32_16x16x32_bf16 v[24:27], v[144:147], v[60:63], v[24:27]
    v_mfma_f32_16x16x32_bf16 v[28:31], v[148:151], v[60:63], v[28:31]
    buffer_load_dwordx4 v4, s[20:23], s65 offen lds
    ds_read_b64_tr_b16 v[60:61], v8 offset:21544
    ds_read_b64_tr_b16 v[62:63], v8 offset:22824
    s_waitcnt lgkmcnt(10)
    s_add_u32 m0, s70, 69632
    v_mfma_f32_16x16x32_bf16 v[32:35], v[144:147], v[64:67], v[32:35]
    v_mfma_f32_16x16x32_bf16 v[36:39], v[148:151], v[64:67], v[36:39]
    buffer_load_dwordx4 v5, s[20:23], s65 offen lds
    ds_read_b64_tr_b16 v[64:65], v8 offset:31744
    ds_read_b64_tr_b16 v[66:67], v8 offset:33024
    s_waitcnt lgkmcnt(10)
    v_mfma_f32_16x16x32_bf16 v[40:43], v[144:147], v[68:71], v[40:43]
    v_mfma_f32_16x16x32_bf16 v[44:47], v[148:151], v[68:71], v[44:47]
    s_lshl_b32 s3, s41, 3
    s_add_u32 s3, s3, s42
    s_mul_i32 s3, s3, 50
    s_mul_i32 s6, s44, 13
    s_add_u32 s3, s3, s6
    v_add_u32 v86, s3, v10
    v_mul_u32_u24 v87, 52429, v86
    v_lshrrev_b32 v87, 19, v87
    v_mul_u32_u24 v88, 10, v87
    v_sub_u32 v86, v86, v88
    v_lshlrev_b32 v86, 7, v86
    v_mul_u32_u24 v87, 3840, v87
    v_add_u32 v86, v86, v87
    s_mov_b64 exec, 8191
    buffer_load_dword v95, v86, s[20:23], 0 offen
    s_mov_b64 exec, -1
    ds_read_b64_tr_b16 v[68:69], v8 offset:31784
    ds_read_b64_tr_b16 v[70:71], v8 offset:33064
    s_waitcnt lgkmcnt(10)
    v_mfma_f32_16x16x32_bf16 v[48:51], v[144:147], v[72:75], v[48:51]
    v_mfma_f32_16x16x32_bf16 v[52:55], v[148:151], v[72:75], v[52:55]
    ds_read_b64_tr_b16 v[72:73], v9 offset:21504
    ds_read_b64_tr_b16 v[74:75], v9 offset:22784
    s_waitcnt lgkmcnt(8)
    v_mfma_f32_16x16x32_bf16 v[16:19], v[152:155], v[56:59], v[16:19]
    v_mfma_f32_16x16x32_bf16 v[20:23], v[156:159], v[56:59], v[20:23]
    s_waitcnt lgkmcnt(6)
    v_mfma_f32_16x16x32_bf16 v[24:27], v[152:155], v[60:63], v[24:27]
    v_mfma_f32_16x16x32_bf16 v[28:31], v[156:159], v[60:63], v[28:31]
    s_waitcnt lgkmcnt(4)
    v_mfma_f32_16x16x32_bf16 v[32:35], v[152:155], v[64:67], v[32:35]
    v_mfma_f32_16x16x32_bf16 v[36:39], v[156:159], v[64:67], v[36:39]
    v_add_u32 v6, -110592, v6
    v_add_u32 v7, -110592, v7
    v_add_u32 v8, -110592, v8
    v_add_u32 v9, -110592, v9
    s_waitcnt vmcnt(6)
    s_barrier
    ds_read_b128 v[160:163], v6 offset:0
    ds_read_b128 v[164:167], v6 offset:2048
    ds_read_b64_tr_b16 v[56:57], v8 offset:16384
    ds_read_b64_tr_b16 v[58:59], v8 offset:17664
    ds_read_b64_tr_b16 v[60:61], v8 offset:16424
    ds_read_b64_tr_b16 v[62:63], v8 offset:17704
    ds_read_b64_tr_b16 v[64:65], v8 offset:26624
    ds_read_b64_tr_b16 v[66:67], v8 offset:27904
    s_waitcnt lgkmcnt(10)
    v_mfma_f32_16x16x32_bf16 v[40:43], v[152:155], v[68:71], v[40:43]
    v_mfma_f32_16x16x32_bf16 v[44:47], v[156:159], v[68:71], v[44:47]
    s_cmp_eq_u32 s43, 0
    s_cbranch_scc0 L_rl_00
    s_lshl_b32 s3, s40, 4
    s_add_u32 s4, s3, s41
    s_lshl_b32 s4, s4, 3
    v_add_u32 v84, s4, v10
    s_lshl_b32 s5, s3, 3
    s_add_u32 s5, s5, s42
    s_sub_u32 s5, s5, 64
    v_lshl_add_u32 v85, v10, 3, s5
    s_mov_b32 s80, 0xff
    s_mov_b32 s81, 0x0
    v_cndmask_b32_e64 v84, v85, v84, s[80:81]
    v_lshlrev_b32 v84, 7, v84
    s_mov_b32 s3, 8454144
    s_mov_b64 exec, 16777215
    buffer_load_dword v85, v84, s[32:35], s3 offen sc1
    s_mov_b64 exec, -1
L_rl_00:
    ds_read_b64_tr_b16 v[68:69], v8 offset:26664
    ds_read_b64_tr_b16 v[70:71], v8 offset:27944
    s_waitcnt lgkmcnt(10)
    s_add_u32 m0, s71, 73728
    v_mfma_f32_16x16x32_bf16 v[48:51], v[152:155], v[72:75], v[48:51]
    v_mfma_f32_16x16x32_bf16 v[52:55], v[156:159], v[72:75], v[52:55]
    buffer_load_dwordx4 v1, s[16:19], s56 offen lds
    ds_read_b64_tr_b16 v[72:73], v9 offset:16384
    ds_read_b64_tr_b16 v[74:75], v9 offset:17664
    s_waitcnt lgkmcnt(8)
    s_add_u32 m0, s71, 74752
    v_mfma_f32_16x16x32_bf16 v[16:19], v[160:163], v[56:59], v[16:19]
    v_mfma_f32_16x16x32_bf16 v[20:23], v[164:167], v[56:59], v[20:23]
    buffer_load_dwordx4 v2, s[16:19], s56 offen lds
    ds_read_b128 v[168:171], v7 offset:0
    ds_read_b128 v[172:175], v7 offset:2048
    ds_read_b64_tr_b16 v[56:57], v8 offset:21504
    ds_read_b64_tr_b16 v[58:59], v8 offset:22784
    s_waitcnt lgkmcnt(10)
    s_add_u32 m0, s70, 90112
    v_mfma_f32_16x16x32_bf16 v[24:27], v[160:163], v[60:63], v[24:27]
    v_mfma_f32_16x16x32_bf16 v[28:31], v[164:167], v[60:63], v[28:31]
    buffer_load_dwordx4 v3, s[20:23], s66 offen lds
    ds_read_b64_tr_b16 v[60:61], v8 offset:21544
    ds_read_b64_tr_b16 v[62:63], v8 offset:22824
    s_waitcnt lgkmcnt(10)
    s_add_u32 m0, s70, 98304
    v_mfma_f32_16x16x32_bf16 v[32:35], v[160:163], v[64:67], v[32:35]
    v_mfma_f32_16x16x32_bf16 v[36:39], v[164:167], v[64:67], v[36:39]
    buffer_load_dwordx4 v4, s[20:23], s66 offen lds
    ds_read_b64_tr_b16 v[64:65], v8 offset:31744
    ds_read_b64_tr_b16 v[66:67], v8 offset:33024
    s_waitcnt lgkmcnt(10)
    s_add_u32 m0, s70, 106496
    v_mfma_f32_16x16x32_bf16 v[40:43], v[160:163], v[68:71], v[40:43]
    v_mfma_f32_16x16x32_bf16 v[44:47], v[164:167], v[68:71], v[44:47]
    buffer_load_dwordx4 v5, s[20:23], s66 offen lds
    ds_read_b64_tr_b16 v[68:69], v8 offset:31784
    ds_read_b64_tr_b16 v[70:71], v8 offset:33064
    s_waitcnt lgkmcnt(10)
    v_mfma_f32_16x16x32_bf16 v[48:51], v[160:163], v[72:75], v[48:51]
    v_mfma_f32_16x16x32_bf16 v[52:55], v[164:167], v[72:75], v[52:55]
    ds_read_b64_tr_b16 v[72:73], v9 offset:21504
    ds_read_b64_tr_b16 v[74:75], v9 offset:22784
    s_waitcnt lgkmcnt(8)
    v_mfma_f32_16x16x32_bf16 v[16:19], v[168:171], v[56:59], v[16:19]
    v_mfma_f32_16x16x32_bf16 v[20:23], v[172:175], v[56:59], v[20:23]
    s_waitcnt lgkmcnt(6)
    v_mfma_f32_16x16x32_bf16 v[24:27], v[168:171], v[60:63], v[24:27]
    v_mfma_f32_16x16x32_bf16 v[28:31], v[172:175], v[60:63], v[28:31]
    s_waitcnt lgkmcnt(4)
    v_mfma_f32_16x16x32_bf16 v[32:35], v[168:171], v[64:67], v[32:35]
    v_mfma_f32_16x16x32_bf16 v[36:39], v[172:175], v[64:67], v[36:39]
    v_add_u32 v6, 36864, v6
    v_add_u32 v7, 36864, v7
    v_add_u32 v8, 36864, v8
    v_add_u32 v9, 36864, v9
    s_cmp_eq_u32 s43, 0
    s_cbranch_scc1 L_gw854
    s_waitcnt vmcnt(6)
    s_branch L_gx854
L_gw854:
    s_waitcnt vmcnt(7)
L_gx854:
    s_barrier
    ds_read_b128 v[176:179], v6 offset:0
    ds_read_b128 v[180:183], v6 offset:2048
    ds_read_b64_tr_b16 v[56:57], v8 offset:16384
    ds_read_b64_tr_b16 v[58:59], v8 offset:17664
    ds_read_b64_tr_b16 v[60:61], v8 offset:16424
    ds_read_b64_tr_b16 v[62:63], v8 offset:17704
    ds_read_b64_tr_b16 v[64:65], v8 offset:26624
    ds_read_b64_tr_b16 v[66:67], v8 offset:27904
    s_waitcnt lgkmcnt(10)
    s_add_u32 m0, s71, 110592
    v_mfma_f32_16x16x32_bf16 v[40:43], v[168:171], v[68:71], v[40:43]
    v_mfma_f32_16x16x32_bf16 v[44:47], v[172:175], v[68:71], v[44:47]
    buffer_load_dwordx4 v1, s[16:19], s57 offen lds
    ds_read_b64_tr_b16 v[68:69], v8 offset:26664
    ds_read_b64_tr_b16 v[70:71], v8 offset:27944
    s_waitcnt lgkmcnt(10)
    s_add_u32 m0, s71, 111616
    v_mfma_f32_16x16x32_bf16 v[48:51], v[168:171], v[72:75], v[48:51]
    v_mfma_f32_16x16x32_bf16 v[52:55], v[172:175], v[72:75], v[52:55]
    buffer_load_dwordx4 v2, s[16:19], s57 offen lds
    ds_read_b64_tr_b16 v[72:73], v9 offset:16384
    ds_read_b64_tr_b16 v[74:75], v9 offset:17664
    s_waitcnt lgkmcnt(8)
    s_add_u32 m0, s70, 126976
    v_mfma_f32_16x16x32_bf16 v[16:19], v[176:179], v[56:59], v[16:19]
    v_mfma_f32_16x16x32_bf16 v[20:23], v[180:183], v[56:59], v[20:23]
    buffer_load_dwordx4 v3, s[20:23], s67 offen lds
    ds_read_b128 v[184:187], v7 offset:0
    ds_read_b128 v[188:191], v7 offset:2048
    ds_read_b64_tr_b16 v[56:57], v8 offset:21504
    ds_read_b64_tr_b16 v[58:59], v8 offset:22784
    s_waitcnt lgkmcnt(10)
    s_add_u32 m0, s70, 135168
    v_mfma_f32_16x16x32_bf16 v[24:27], v[176:179], v[60:63], v[24:27]
    v_mfma_f32_16x16x32_bf16 v[28:31], v[180:183], v[60:63], v[28:31]
    buffer_load_dwordx4 v4, s[20:23], s67 offen lds
    ds_read_b64_tr_b16 v[60:61], v8 offset:21544
    ds_read_b64_tr_b16 v[62:63], v8 offset:22824
    s_waitcnt lgkmcnt(10)
    s_add_u32 m0, s70, 143360
    v_mfma_f32_16x16x32_bf16 v[32:35], v[176:179], v[64:67], v[32:35]
    v_mfma_f32_16x16x32_bf16 v[36:39], v[180:183], v[64:67], v[36:39]
    buffer_load_dwordx4 v5, s[20:23], s67 offen lds
    ds_read_b64_tr_b16 v[64:65], v8 offset:31744
    ds_read_b64_tr_b16 v[66:67], v8 offset:33024
    s_waitcnt lgkmcnt(10)
    v_mfma_f32_16x16x32_bf16 v[40:43], v[176:179], v[68:71], v[40:43]
    v_mfma_f32_16x16x32_bf16 v[44:47], v[180:183], v[68:71], v[44:47]
    ds_read_b64_tr_b16 v[68:69], v8 offset:31784
    ds_read_b64_tr_b16 v[70:71], v8 offset:33064
    s_waitcnt lgkmcnt(10)
    v_mfma_f32_16x16x32_bf16 v[48:51], v[176:179], v[72:75], v[48:51]
    v_mfma_f32_16x16x32_bf16 v[52:55], v[180:183], v[72:75], v[52:55]
    ds_read_b64_tr_b16 v[72:73], v9 offset:21504
    ds_read_b64_tr_b16 v[74:75], v9 offset:22784
    s_waitcnt lgkmcnt(8)
    v_mfma_f32_16x16x32_bf16 v[16:19], v[184:187], v[56:59], v[16:19]
    v_mfma_f32_16x16x32_bf16 v[20:23], v[188:191], v[56:59], v[20:23]
    s_waitcnt lgkmcnt(6)
    v_mfma_f32_16x16x32_bf16 v[24:27], v[184:187], v[60:63], v[24:27]
    v_mfma_f32_16x16x32_bf16 v[28:31], v[188:191], v[60:63], v[28:31]
    s_waitcnt lgkmcnt(4)
    v_mfma_f32_16x16x32_bf16 v[32:35], v[184:187], v[64:67], v[32:35]
    v_mfma_f32_16x16x32_bf16 v[36:39], v[188:191], v[64:67], v[36:39]
    v_add_u32 v6, 36864, v6
    v_add_u32 v7, 36864, v7
    v_add_u32 v8, 36864, v8
    v_add_u32 v9, 36864, v9
    s_waitcnt vmcnt(5)
    s_barrier
    ds_read_b128 v[192:195], v6 offset:0
    ds_read_b128 v[196:199], v6 offset:2048
    ds_read_b64_tr_b16 v[56:57], v8 offset:16384
    ds_read_b64_tr_b16 v[58:59], v8 offset:17664
    ds_read_b64_tr_b16 v[60:61], v8 offset:16424
    ds_read_b64_tr_b16 v[62:63], v8 offset:17704
    ds_read_b64_tr_b16 v[64:65], v8 offset:26624
    ds_read_b64_tr_b16 v[66:67], v8 offset:27904
    s_waitcnt lgkmcnt(10)
    v_mfma_f32_16x16x32_bf16 v[40:43], v[184:187], v[68:71], v[40:43]
    v_mfma_f32_16x16x32_bf16 v[44:47], v[188:191], v[68:71], v[44:47]
    s_cmp_eq_u32 s43, 0
    s_cbranch_scc0 L_rc_00
    v_and_b32 v86, -8, v85
    s_mov_b64 exec, 16777215
    v_cmp_ne_u32 vcc, s47, v86
    s_mov_b64 exec, -1
    s_cbranch_vccz L_rok_00
    s_mov_b32 s92, 0
L_rsp_00:
    s_mov_b32 s3, 8454144
    s_mov_b64 exec, 16777215
    buffer_load_dword v85, v84, s[32:35], s3 offen sc1
    s_waitcnt vmcnt(0)
    v_and_b32 v86, -8, v85
    s_mov_b64 exec, 16777215
    v_cmp_ne_u32 vcc, s47, v86
    s_mov_b64 exec, -1
    s_cbranch_vccz L_rok_00
    s_add_u32 s92, s92, 1
    s_cmp_lt_u32 s92, 200000
    s_cbranch_scc1 L_rsp_00
L_rok_00:
    s_or_b32 s3, s47, s46
    s_mov_b64 exec, 0xff
    v_cmp_ne_u32 vcc, s3, v85
    s_mov_b64 exec, -1
    s_cmp_eq_u32 vcc_lo, 0
    s_cselect_b32 s3, 1, 0
    s_or_b32 s3, s3, s47
    v_mov_b32 v85, s3
    v_mov_b32 v84, 147520
    ds_write_b32 v84, v85
L_rc_00:
    ds_read_b64_tr_b16 v[68:69], v8 offset:26664
    ds_read_b64_tr_b16 v[70:71], v8 offset:27944
    s_waitcnt lgkmcnt(10)
    s_add_u32 m0, s71, 0
    v_mfma_f32_16x16x32_bf16 v[48:51], v[184:187], v[72:75], v[48:51]
    v_mfma_f32_16x16x32_bf16 v[52:55], v[188:191], v[72:75], v[52:55]
    buffer_load_dwordx4 v1, s[16:19], s58 offen lds
    ds_read_b64_tr_b16 v[72:73], v9 offset:16384
    ds_read_b64_tr_b16 v[74:75], v9 offset:17664
    s_waitcnt lgkmcnt(8)
    s_add_u32 m0, s71, 1024
    v_mfma_f32_16x16x32_bf16 v[16:19], v[192:195], v[56:59], v[16:19]
    v_mfma_f32_16x16x32_bf16 v[20:23], v[196:199], v[56:59], v[20:23]
    buffer_load_dwordx4 v2, s[16:19], s58 offen lds
    ds_read_b128 v[200:203], v7 offset:0
    ds_read_b128 v[204:207], v7 offset:2048
    ds_read_b64_tr_b16 v[56:57], v8 offset:21504
    ds_read_b64_tr_b16 v[58:59], v8 offset:22784
    s_waitcnt lgkmcnt(10)
    s_add_u32 m0, s70, 16384
    v_mfma_f32_16x16x32_bf16 v[24:27], v[192:195], v[60:63], v[24:27]
    v_mfma_f32_16x16x32_bf16 v[28:31], v[196:199], v[60:63], v[28:31]
    buffer_load_dwordx4 v3, s[20:23], s68 offen lds
    ds_read_b64_tr_b16 v[60:61], v8 offset:21544
    ds_read_b64_tr_b16 v[62:63], v8 offset:22824
    s_waitcnt lgkmcnt(10)
    s_add_u32 m0, s70, 24576
    v_mfma_f32_16x16x32_bf16 v[32:35], v[192:195], v[64:67], v[32:35]
    v_mfma_f32_16x16x32_bf16 v[36:39], v[196:199], v[64:67], v[36:39]
    buffer_load_dwordx4 v4, s[20:23], s68 offen lds
    ds_read_b64_tr_b16 v[64:65], v8 offset:31744
    ds_read_b64_tr_b16 v[66:67], v8 offset:33024
    s_waitcnt lgkmcnt(10)
    s_add_u32 m0, s70, 32768
    v_mfma_f32_16x16x32_bf16 v[40:43], v[192:195], v[68:71], v[40:43]
    v_mfma_f32_16x16x32_bf16 v[44:47], v[196:199], v[68:71], v[44:47]
    buffer_load_dwordx4 v5, s[20:23], s68 offen lds
    ds_read_b64_tr_b16 v[68:69], v8 offset:31784
    ds_read_b64_tr_b16 v[70:71], v8 offset:33064
    s_waitcnt lgkmcnt(10)
    v_mfma_f32_16x16x32_bf16 v[48:51], v[192:195], v[72:75], v[48:51]
    v_mfma_f32_16x16x32_bf16 v[52:55], v[196:199], v[72:75], v[52:55]
    ds_read_b64_tr_b16 v[72:73], v9 offset:21504
    ds_read_b64_tr_b16 v[74:75], v9 offset:22784
    s_waitcnt lgkmcnt(8)
    v_mfma_f32_16x16x32_bf16 v[16:19], v[200:203], v[56:59], v[16:19]
    v_mfma_f32_16x16x32_bf16 v[20:23], v[204:207], v[56:59], v[20:23]
    s_waitcnt lgkmcnt(6)
    v_mfma_f32_16x16x32_bf16 v[24:27], v[200:203], v[60:63], v[24:27]
    v_mfma_f32_16x16x32_bf16 v[28:31], v[204:207], v[60:63], v[28:31]
    s_waitcnt lgkmcnt(4)
    v_mfma_f32_16x16x32_bf16 v[32:35], v[200:203], v[64:67], v[32:35]
    v_mfma_f32_16x16x32_bf16 v[36:39], v[204:207], v[64:67], v[36:39]
    v_add_u32 v6, 36864, v6
    v_add_u32 v7, 36864, v7
    v_add_u32 v8, 36864, v8
    v_add_u32 v9, 36864, v9
    s_waitcnt vmcnt(5)
    s_barrier
    ds_read_b128 v[208:211], v6 offset:0
    ds_read_b128 v[212:215], v6 offset:2048
    ds_read_b64_tr_b16 v[56:57], v8 offset:16384
    ds_read_b64_tr_b16 v[58:59], v8 offset:17664
    ds_read_b64_tr_b16 v[60:61], v8 offset:16424
    ds_read_b64_tr_b16 v[62:63], v8 offset:17704
    ds_read_b64_tr_b16 v[64:65], v8 offset:26624
    ds_read_b64_tr_b16 v[66:67], v8 offset:27904
    s_waitcnt lgkmcnt(10)
    v_mfma_f32_16x16x32_bf16 v[40:43], v[200:203], v[68:71], v[40:43]
    v_mfma_f32_16x16x32_bf16 v[44:47], v[204:207], v[68:71], v[44:47]
    v_mov_b32 v84, 147520
    ds_read_b32 v85, v84
    ds_read_b64_tr_b16 v[68:69], v8 offset:26664
    ds_read_b64_tr_b16 v[70:71], v8 offset:27944
    s_waitcnt lgkmcnt(11)
    s_add_u32 m0, s71, 36864
    v_mfma_f32_16x16x32_bf16 v[48:51], v[200:203], v[72:75], v[48:51]
    v_mfma_f32_16x16x32_bf16 v[52:55], v[204:207], v[72:75], v[52:55]
    buffer_load_dwordx4 v1, s[16:19], s59 offen lds
    ds_read_b64_tr_b16 v[72:73], v9 offset:16384
    ds_read_b64_tr_b16 v[74:75], v9 offset:17664
    s_waitcnt lgkmcnt(9)
    s_add_u32 m0, s71, 37888
    v_mfma_f32_16x16x32_bf16 v[16:19], v[208:211], v[56:59], v[16:19]
    v_mfma_f32_16x16x32_bf16 v[20:23], v[212:215], v[56:59], v[20:23]
    buffer_load_dwordx4 v2, s[16:19], s59 offen lds
    ds_read_b128 v[216:219], v7 offset:0
    ds_read_b128 v[220:223], v7 offset:2048
    ds_read_b64_tr_b16 v[56:57], v8 offset:21504
    ds_read_b64_tr_b16 v[58:59], v8 offset:22784
    s_waitcnt lgkmcnt(11)
    s_add_u32 m0, s70, 53248
    v_mfma_f32_16x16x32_bf16 v[24:27], v[208:211], v[60:63], v[24:27]
    v_mfma_f32_16x16x32_bf16 v[28:31], v[212:215], v[60:63], v[28:31]
    buffer_load_dwordx4 v3, s[20:23], s69 offen lds
    ds_read_b64_tr_b16 v[60:61], v8 offset:21544
    ds_read_b64_tr_b16 v[62:63], v8 offset:22824
    s_waitcnt lgkmcnt(11)
    s_add_u32 m0, s70, 61440
    v_mfma_f32_16x16x32_bf16 v[32:35], v[208:211], v[64:67], v[32:35]
    v_mfma_f32_16x16x32_bf16 v[36:39], v[212:215], v[64:67], v[36:39]
    buffer_load_dwordx4 v4, s[20:23], s69 offen lds
    ds_read_b64_tr_b16 v[64:65], v8 offset:31744
    ds_read_b64_tr_b16 v[66:67], v8 offset:33024
    s_waitcnt lgkmcnt(10)
    s_add_u32 m0, s70, 69632
    v_mfma_f32_16x16x32_bf16 v[40:43], v[208:211], v[68:71], v[40:43]
    v_mfma_f32_16x16x32_bf16 v[44:47], v[212:215], v[68:71], v[44:47]
    buffer_load_dwordx4 v5, s[20:23], s69 offen lds
    ds_read_b64_tr_b16 v[68:69], v8 offset:31784
    ds_read_b64_tr_b16 v[70:71], v8 offset:33064
    s_waitcnt lgkmcnt(10)
    v_mfma_f32_16x16x32_bf16 v[48:51], v[208:211], v[72:75], v[48:51]
    v_mfma_f32_16x16x32_bf16 v[52:55], v[212:215], v[72:75], v[52:55]
    v_readfirstlane_b32 s3, v85
    s_nop 0
    s_and_b32 s48, s3, 1
    s_andn2_b32 s47, s3, 7
    ds_read_b64_tr_b16 v[72:73], v9 offset:21504
    ds_read_b64_tr_b16 v[74:75], v9 offset:22784
    s_waitcnt lgkmcnt(8)
    v_mfma_f32_16x16x32_bf16 v[16:19], v[216:219], v[56:59], v[16:19]
    v_mfma_f32_16x16x32_bf16 v[20:23], v[220:223], v[56:59], v[20:23]
    s_waitcnt lgkmcnt(6)
    v_mfma_f32_16x16x32_bf16 v[24:27], v[216:219], v[60:63], v[24:27]
    v_mfma_f32_16x16x32_bf16 v[28:31], v[220:223], v[60:63], v[28:31]
    s_waitcnt lgkmcnt(4)
    v_mfma_f32_16x16x32_bf16 v[32:35], v[216:219], v[64:67], v[32:35]
    v_mfma_f32_16x16x32_bf16 v[36:39], v[220:223], v[64:67], v[36:39]
    v_add_u32 v6, -110592, v6
    v_add_u32 v7, -110592, v7
    v_add_u32 v8, -110592, v8
    v_add_u32 v9, -110592, v9
    s_waitcnt vmcnt(5)
    s_barrier
    ds_read_b128 v[224:227], v6 offset:0
    ds_read_b128 v[228:231], v6 offset:2048
    ds_read_b64_tr_b16 v[56:57], v8 offset:16384
    ds_read_b64_tr_b16 v[58:59], v8 offset:17664
    ds_read_b64_tr_b16 v[60:61], v8 offset:16424
    ds_read_b64_tr_b16 v[62:63], v8 offset:17704
    ds_read_b64_tr_b16 v[64:65], v8 offset:26624
    ds_read_b64_tr_b16 v[66:67], v8 offset:27904
    s_waitcnt lgkmcnt(10)
    v_mfma_f32_16x16x32_bf16 v[40:43], v[216:219], v[68:71], v[40:43]
    v_mfma_f32_16x16x32_bf16 v[44:47], v[220:223], v[68:71], v[44:47]
    ds_read_b64_tr_b16 v[68:69], v8 offset:26664
    ds_read_b64_tr_b16 v[70:71], v8 offset:27944
    s_waitcnt lgkmcnt(10)
    v_mfma_f32_16x16x32_bf16 v[48:51], v[216:219], v[72:75], v[48:51]
    v_mfma_f32_16x16x32_bf16 v[52:55], v[220:223], v[72:75], v[52:55]
    s_cmp_lt_u32 s43, 2
    s_cselect_b32 s3, 0, 1280
    v_subrev_u32 v4, s3, v4
    v_subrev_u32 v5, 1280, v5
    ds_read_b64_tr_b16 v[72:73], v9 offset:16384
    ds_read_b64_tr_b16 v[74:75], v9 offset:17664
    s_waitcnt lgkmcnt(8)
    v_mfma_f32_16x16x32_bf16 v[16:19], v[224:227], v[56:59], v[16:19]
    v_mfma_f32_16x16x32_bf16 v[20:23], v[228:231], v[56:59], v[20:23]
    ds_read_b128 v[232:235], v7 offset:0
    ds_read_b128 v[236:239], v7 offset:2048
    ds_read_b64_tr_b16 v[56:57], v8 offset:21504
    ds_read_b64_tr_b16 v[58:59], v8 offset:22784
    s_waitcnt lgkmcnt(10)
    s_sub_u32 s75, s60, 1280
    s_add_u32 m0, s70, 81920
    v_mfma_f32_16x16x32_bf16 v[24:27], v[224:227], v[60:63], v[24:27]
    v_mfma_f32_16x16x32_bf16 v[28:31], v[228:231], v[60:63], v[28:31]
    buffer_load_dwordx4 v3, s[20:23], s75 offen lds
    ds_read_b64_tr_b16 v[60:61], v8 offset:21544
    ds_read_b64_tr_b16 v[62:63], v8 offset:22824
    s_waitcnt lgkmcnt(10)
    v_mfma_f32_16x16x32_bf16 v[32:35], v[224:227], v[64:67], v[32:35]
    v_mfma_f32_16x16x32_bf16 v[36:39], v[228:231], v[64:67], v[36:39]
    ds_read_b64_tr_b16 v[64:65], v8 offset:31744
    ds_read_b64_tr_b16 v[66:67], v8 offset:33024
    s_waitcnt lgkmcnt(10)
    s_cmp_lt_u32 s43, 2
    s_cselect_b32 s75, s60, s61
    s_sub_u32 s75, s75, 1280
    s_add_u32 m0, s70, 90112
    v_mfma_f32_16x16x32_bf16 v[40:43], v[224:227], v[68:71], v[40:43]
    v_mfma_f32_16x16x32_bf16 v[44:47], v[228:231], v[68:71], v[44:47]
    buffer_load_dwordx4 v4, s[20:23], s75 offen lds
    ds_read_b64_tr_b16 v[68:69], v8 offset:31784
    ds_read_b64_tr_b16 v[70:71], v8 offset:33064
    s_waitcnt lgkmcnt(10)
    v_mfma_f32_16x16x32_bf16 v[48:51], v[224:227], v[72:75], v[48:51]
    v_mfma_f32_16x16x32_bf16 v[52:55], v[228:231], v[72:75], v[52:55]
    ds_read_b64_tr_b16 v[72:73], v9 offset:21504
    ds_read_b64_tr_b16 v[74:75], v9 offset:22784
    s_waitcnt lgkmcnt(8)
    s_sub_u32 s75, s61, 1280
    s_add_u32 m0, s70, 98304
    v_mfma_f32_16x16x32_bf16 v[16:19], v[232:235], v[56:59], v[16:19]
    v_mfma_f32_16x16x32_bf16 v[20:23], v[236:239], v[56:59], v[20:23]
    buffer_load_dwordx4 v5, s[20:23], s75 offen lds
    s_waitcnt lgkmcnt(6)
    v_mfma_f32_16x16x32_bf16 v[24:27], v[232:235], v[60:63], v[24:27]
    v_mfma_f32_16x16x32_bf16 v[28:31], v[236:239], v[60:63], v[28:31]
    s_waitcnt lgkmcnt(4)
    v_mfma_f32_16x16x32_bf16 v[32:35], v[232:235], v[64:67], v[32:35]
    v_mfma_f32_16x16x32_bf16 v[36:39], v[236:239], v[64:67], v[36:39]
    v_add_u32 v6, 36864, v6
    v_add_u32 v7, 36864, v7
    v_add_u32 v8, 36864, v8
    v_add_u32 v9, 36864, v9
    s_waitcnt vmcnt(3) lgkmcnt(0)
    s_barrier
    ds_read_b128 v[240:243], v6 offset:0
    ds_read_b128 v[244:247], v6 offset:2048
    ds_read_b64_tr_b16 v[56:57], v8 offset:16384
    ds_read_b64_tr_b16 v[58:59], v8 offset:17664
    ds_read_b64_tr_b16 v[60:61], v9 offset:16384
    ds_read_b64_tr_b16 v[62:63], v9 offset:17664
    ds_read_b64_tr_b16 v[64:65], v8 offset:16424
    ds_read_b64_tr_b16 v[66:67], v8 offset:17704
    s_sub_u32 s75, s62, 1280
    s_add_u32 m0, s70, 102400
    v_mfma_f32_16x16x32_bf16 v[40:43], v[232:235], v[68:71], v[40:43]
    v_mfma_f32_16x16x32_bf16 v[44:47], v[236:239], v[68:71], v[44:47]
    buffer_load_dwordx4 v3, s[20:23], s75 offen lds
    ds_read_b128 v[248:251], v7 offset:0
    ds_read_b128 v[252:255], v7 offset:2048
    ds_read_b64_tr_b16 v[68:69], v8 offset:21504
    ds_read_b64_tr_b16 v[70:71], v8 offset:22784
    s_cmp_lt_u32 s43, 2
    s_cselect_b32 s75, s62, s63
    s_sub_u32 s75, s75, 1280
    s_add_u32 m0, s70, 110592
    v_mfma_f32_16x16x32_bf16 v[48:51], v[232:235], v[72:75], v[48:51]
    v_mfma_f32_16x16x32_bf16 v[52:55], v[236:239], v[72:75], v[52:55]
    buffer_load_dwordx4 v4, s[20:23], s75 offen lds
    ds_read_b64_tr_b16 v[72:73], v9 offset:21504
    ds_read_b64_tr_b16 v[74:75], v9 offset:22784
    s_waitcnt lgkmcnt(10)
    s_sub_u32 s75, s63, 1280
    s_add_u32 m0, s70, 118784
    v_mfma_f32_16x16x32_bf16 v[16:19], v[240:243], v[56:59], v[16:19]
    v_mfma_f32_16x16x32_bf16 v[20:23], v[244:247], v[56:59], v[20:23]
    buffer_load_dwordx4 v5, s[20:23], s75 offen lds
    ds_read_b64_tr_b16 v[56:57], v8 offset:21544
    ds_read_b64_tr_b16 v[58:59], v8 offset:22824
    s_waitcnt lgkmcnt(10)
    s_sub_u32 s75, s64, 1280
    s_add_u32 m0, s70, 122880
    v_mfma_f32_16x16x32_bf16 v[48:51], v[240:243], v[60:63], v[48:51]
    v_mfma_f32_16x16x32_bf16 v[52:55], v[244:247], v[60:63], v[52:55]
    buffer_load_dwordx4 v3, s[20:23], s75 offen lds
    ds_read_b64_tr_b16 v[60:61], v8 offset:26624
    ds_read_b64_tr_b16 v[62:63], v8 offset:27904
    s_waitcnt lgkmcnt(10)
    s_cmp_lt_u32 s43, 2
    s_cselect_b32 s75, s64, s65
    s_sub_u32 s75, s75, 1280
    s_add_u32 m0, s70, 131072
    v_mfma_f32_16x16x32_bf16 v[24:27], v[240:243], v[64:67], v[24:27]
    v_mfma_f32_16x16x32_bf16 v[28:31], v[244:247], v[64:67], v[28:31]
    buffer_load_dwordx4 v4, s[20:23], s75 offen lds
    ds_read_b64_tr_b16 v[64:65], v8 offset:26664
    ds_read_b64_tr_b16 v[66:67], v8 offset:27944
    s_waitcnt lgkmcnt(8)
    s_sub_u32 s75, s65, 1280
    s_add_u32 m0, s70, 139264
    v_mfma_f32_16x16x32_bf16 v[16:19], v[248:251], v[68:71], v[16:19]
    v_mfma_f32_16x16x32_bf16 v[20:23], v[252:255], v[68:71], v[20:23]
    buffer_load_dwordx4 v5, s[20:23], s75 offen lds
    ds_read_b64_tr_b16 v[68:69], v8 offset:31744
    ds_read_b64_tr_b16 v[70:71], v8 offset:33024
    s_waitcnt lgkmcnt(8)
    v_mfma_f32_16x16x32_bf16 v[48:51], v[248:251], v[72:75], v[48:51]
    v_mfma_f32_16x16x32_bf16 v[52:55], v[252:255], v[72:75], v[52:55]
    ds_read_b64_tr_b16 v[72:73], v8 offset:31784
    ds_read_b64_tr_b16 v[74:75], v8 offset:33064
    s_waitcnt lgkmcnt(8)
    v_mfma_f32_16x16x32_bf16 v[24:27], v[248:251], v[56:59], v[24:27]
    v_mfma_f32_16x16x32_bf16 v[28:31], v[252:255], v[56:59], v[28:31]
    s_waitcnt lgkmcnt(6)
    v_mfma_f32_16x16x32_bf16 v[32:35], v[240:243], v[60:63], v[32:35]
    v_mfma_f32_16x16x32_bf16 v[36:39], v[244:247], v[60:63], v[36:39]
    s_waitcnt lgkmcnt(4)
    v_mfma_f32_16x16x32_bf16 v[40:43], v[240:243], v[64:67], v[40:43]
    v_mfma_f32_16x16x32_bf16 v[44:47], v[244:247], v[64:67], v[44:47]
    s_waitcnt lgkmcnt(2)
    v_mfma_f32_16x16x32_bf16 v[32:35], v[248:251], v[68:71], v[32:35]
    v_mfma_f32_16x16x32_bf16 v[36:39], v[252:255], v[68:71], v[36:39]
    s_waitcnt lgkmcnt(0)
    v_mfma_f32_16x16x32_bf16 v[40:43], v[248:251], v[72:75], v[40:43]
    v_mfma_f32_16x16x32_bf16 v[44:47], v[252:255], v[72:75], v[44:47]
    v_lshlrev_b32 v6, 4, v10
    v_lshlrev_b32 v7, 3, v10
    v_add_u32 v8, 45056, v8
    v_add_u32 v9, 45056, v9
    s_lshl_b32 s3, s43, 12
    v_add_u32 v11, s3, v6
    v_add_u32 v12, s70, v6
    v_add_u32 v12, 154624, v12
    v_mul_f32 v76, s94, v16
    v_mul_f32 v77, s94, v17
    v_mul_f32 v78, s94, v18
    v_mul_f32 v79, s94, v19
    v_mul_f32 v80, s94, v20
    v_mul_f32 v81, s94, v21
    v_mul_f32 v82, s94, v22
    v_mul_f32 v83, s94, v23
    v_exp_f32_e64 v76, v76 clamp
    v_max_f32 v16, s95, v16
    v_exp_f32_e64 v77, v77 clamp
    v_max_f32 v17, s95, v17
    v_exp_f32_e64 v78, v78 clamp
    v_max_f32 v18, s95, v18
    v_exp_f32_e64 v79, v79 clamp
    v_max_f32 v19, s95, v19
    v_exp_f32_e64 v80, v80 clamp
    v_max_f32 v20, s95, v20
    v_exp_f32_e64 v81, v81 clamp
    v_max_f32 v21, s95, v21
    v_exp_f32_e64 v82, v82 clamp
    v_max_f32 v22, s95, v22
    v_exp_f32_e64 v83, v83 clamp
    v_max_f32 v23, s95, v23
    v_add_f32 v16, v16, v76
    v_add_f32 v17, v17, v77
    v_add_f32 v18, v18, v78
    v_add_f32 v19, v19, v79
    v_add_f32 v20, v20, v80
    v_add_f32 v21, v21, v81
    v_add_f32 v22, v22, v82
    v_add_f32 v23, v23, v83
    v_cvt_pk_bf16_f32 v56, v16, v17
    v_cvt_pk_bf16_f32 v57, v18, v19
    v_cvt_pk_bf16_f32 v58, v20, v21
    v_cvt_pk_bf16_f32 v59, v22, v23
    ds_write_b128 v11, v[56:59] offset:0
    v_mul_f32 v76, s94, v48
    v_mul_f32 v77, s94, v49
    v_mul_f32 v78, s94, v50
    v_mul_f32 v79, s94, v51
    v_mul_f32 v80, s94, v52
    v_mul_f32 v81, s94, v53
    v_mul_f32 v82, s94, v54
    v_mul_f32 v83, s94, v55
    v_exp_f32_e64 v76, v76 clamp
    v_max_f32 v48, s95, v48
    v_exp_f32_e64 v77, v77 clamp
    v_max_f32 v49, s95, v49
    v_exp_f32_e64 v78, v78 clamp
    v_max_f32 v50, s95, v50
    v_exp_f32_e64 v79, v79 clamp
    v_max_f32 v51, s95, v51
    v_exp_f32_e64 v80, v80 clamp
    v_max_f32 v52, s95, v52
    v_exp_f32_e64 v81, v81 clamp
    v_max_f32 v53, s95, v53
    v_exp_f32_e64 v82, v82 clamp
    v_max_f32 v54, s95, v54
    v_exp_f32_e64 v83, v83 clamp
    v_max_f32 v55, s95, v55
    v_add_f32 v48, v48, v76
    v_add_f32 v49, v49, v77
    v_add_f32 v50, v50, v78
    v_add_f32 v51, v51, v79
    v_add_f32 v52, v52, v80
    v_add_f32 v53, v53, v81
    v_add_f32 v54, v54, v82
    v_add_f32 v55, v55, v83
    v_cvt_pk_bf16_f32 v72, v48, v49
    v_cvt_pk_bf16_f32 v73, v50, v51
    v_cvt_pk_bf16_f32 v74, v52, v53
    v_cvt_pk_bf16_f32 v75, v54, v55
    ds_write_b128 v12, v[72:75]
    v_mul_f32 v76, s94, v24
    v_mul_f32 v77, s94, v25
    v_mul_f32 v78, s94, v26
    v_mul_f32 v79, s94, v27
    v_mul_f32 v80, s94, v28
    v_mul_f32 v81, s94, v29
    v_mul_f32 v82, s94, v30
    v_mul_f32 v83, s94, v31
    v_exp_f32_e64 v76, v76 clamp
    v_max_f32 v24, s95, v24
    v_exp_f32_e64 v77, v77 clamp
    v_max_f32 v25, s95, v25
    v_exp_f32_e64 v78, v78 clamp
    v_max_f32 v26, s95, v26
    v_exp_f32_e64 v79, v79 clamp
    v_max_f32 v27, s95, v27
    v_exp_f32_e64 v80, v80 clamp
    v_max_f32 v28, s95, v28
    v_exp_f32_e64 v81, v81 clamp
    v_max_f32 v29, s95, v29
    v_exp_f32_e64 v82, v82 clamp
    v_max_f32 v30, s95, v30
    v_exp_f32_e64 v83, v83 clamp
    v_max_f32 v31, s95, v31
    v_add_f32 v24, v24, v76
    v_add_f32 v25, v25, v77
    v_add_f32 v26, v26, v78
    v_add_f32 v27, v27, v79
    v_add_f32 v28, v28, v80
    v_add_f32 v29, v29, v81
    v_add_f32 v30, v30, v82
    v_add_f32 v31, v31, v83
    v_cvt_pk_bf16_f32 v60, v24, v25
    v_cvt_pk_bf16_f32 v61, v26, v27
    v_cvt_pk_bf16_f32 v62, v28, v29
    v_cvt_pk_bf16_f32 v63, v30, v31
    ds_write_b128 v11, v[60:63] offset:1024
    v_cvt_pk_bf16_f32 v64, v32, v33
    v_cvt_pk_bf16_f32 v65, v34, v35
    v_cvt_pk_bf16_f32 v66, v36, v37
    v_cvt_pk_bf16_f32 v67, v38, v39
    ds_write_b128 v11, v[64:67] offset:2048
    v_cvt_pk_bf16_f32 v68, v40, v41
    v_cvt_pk_bf16_f32 v69, v42, v43
    v_cvt_pk_bf16_f32 v70, v44, v45
    v_cvt_pk_bf16_f32 v71, v46, v47
    ds_write_b128 v11, v[68:71] offset:3072
    v_add_u32 v11, 0, v6
    v_add_u32 v12, 154624, v6
    v_and_b32 v13, 0x31, v10
    v_bfe_u32 v14, v10, 2, 2
    v_lshl_add_u32 v13, v14, 1, v13
    v_lshlrev_b32 v13, 4, v13
    v_add_u32 v13, 158720, v13
    v_mov_b32 v89, 0x3f803f80
    v_mov_b32 v80, s95
    v_mov_b32 v81, s95
    v_mov_b32 v82, s95
    v_mov_b32 v83, s95
    s_waitcnt vmcnt(6) lgkmcnt(0)
    s_barrier
    s_cmp_lt_u32 s86, 2
    s_cbranch_scc0 L_t23_00
    s_lshl_b32 s3, s86, 10
    v_add_u32 v11, s3, v11
    ds_read_b128 v[16:19], v11 offset:0
    ds_read_b128 v[20:23], v11 offset:2048
    ds_read_b128 v[24:27], v11 offset:4096
    ds_read_b128 v[28:31], v11 offset:6144
    ds_read_b128 v[32:35], v11 offset:8192
    ds_read_b128 v[36:39], v11 offset:10240
    ds_read_b128 v[40:43], v11 offset:12288
    ds_read_b128 v[44:47], v11 offset:14336
    s_waitcnt lgkmcnt(6)
    v_mfma_f32_16x16x32_bf16 v[84:87], v[16:19], v[20:23], 0
    s_waitcnt lgkmcnt(4)
    v_mfma_f32_16x16x32_bf16 v[84:87], v[24:27], v[28:31], v[84:87]
    s_waitcnt lgkmcnt(2)
    v_mfma_f32_16x16x32_bf16 v[84:87], v[32:35], v[36:39], v[84:87]
    s_waitcnt lgkmcnt(0)
    v_mfma_f32_16x16x32_bf16 v[84:87], v[40:43], v[44:47], v[84:87]
    s_nop 7
    s_branch L_tdone_00
L_t23_00:
    s_mov_b32 vcc_lo, 0x33333333
    s_mov_b32 vcc_hi, 0x33333333
    s_cmp_eq_u32 s86, 2
    s_cbranch_scc0 L_t3_00
    ds_read_b128 v[16:19], v13 offset:0
    ds_read_b128 v[20:23], v11 offset:0
    ds_read_b128 v[24:27], v11 offset:1024
    ds_read_b128 v[28:31], v13 offset:1024
    ds_read_b128 v[32:35], v11 offset:4096
    ds_read_b128 v[36:39], v11 offset:5120
    ds_read_b128 v[40:43], v13 offset:2048
    ds_read_b128 v[44:47], v11 offset:8192
    ds_read_b128 v[48:51], v11 offset:9216
    ds_read_b128 v[52:55], v13 offset:3072
    ds_read_b128 v[56:59], v11 offset:12288
    ds_read_b128 v[60:63], v11 offset:13312
    s_waitcnt lgkmcnt(9)
    v_cndmask_b32 v16, v16, v89, vcc
    v_cndmask_b32 v17, v17, v89, vcc
    v_cndmask_b32 v18, v18, v89, vcc
    v_cndmask_b32 v19, v19, v89, vcc
    s_nop 1
    v_mfma_f32_16x16x32_bf16 v[84:87], v[20:23], v[16:19], 0
    v_mfma_f32_16x16x32_bf16 v[72:75], v[24:27], v[16:19], 0
    s_waitcnt lgkmcnt(6)
    v_cndmask_b32 v28, v28, v89, vcc
    v_cndmask_b32 v29, v29, v89, vcc
    v_cndmask_b32 v30, v30, v89, vcc
    v_cndmask_b32 v31, v31, v89, vcc
    s_nop 1
    v_mfma_f32_16x16x32_bf16 v[84:87], v[32:35], v[28:31], v[84:87]
    v_mfma_f32_16x16x32_bf16 v[72:75], v[36:39], v[28:31], v[72:75]
    s_waitcnt lgkmcnt(3)
    v_cndmask_b32 v40, v40, v89, vcc
    v_cndmask_b32 v41, v41, v89, vcc
    v_cndmask_b32 v42, v42, v89, vcc
    v_cndmask_b32 v43, v43, v89, vcc
    s_nop 1
    v_mfma_f32_16x16x32_bf16 v[84:87], v[44:47], v[40:43], v[84:87]
    v_mfma_f32_16x16x32_bf16 v[72:75], v[48:51], v[40:43], v[72:75]
    s_waitcnt lgkmcnt(0)
    v_cndmask_b32 v52, v52, v89, vcc
    v_cndmask_b32 v53, v53, v89, vcc
    v_cndmask_b32 v54, v54, v89, vcc
    v_cndmask_b32 v55, v55, v89, vcc
    s_nop 1
    v_mfma_f32_16x16x32_bf16 v[84:87], v[56:59], v[52:55], v[84:87]
    v_mfma_f32_16x16x32_bf16 v[72:75], v[60:63], v[52:55], v[72:75]
    s_mov_b32 vcc_lo, 0x11dd11dd
    s_mov_b32 vcc_hi, 0x11dd11dd
    s_nop 5
    v_cndmask_b32 v84, v72, v84, vcc
    v_cndmask_b32 v85, v73, v85, vcc
    v_cndmask_b32 v86, v74, v86, vcc
    v_cndmask_b32 v87, v75, v87, vcc
    s_branch L_tdone_00
L_t3_00:
    ds_read_b128 v[16:19], v13 offset:0
    ds_read_b128 v[20:23], v12 offset:0
    ds_read_b128 v[24:27], v11 offset:2048
    ds_read_b128 v[28:31], v11 offset:3072
    ds_read_b128 v[32:35], v13 offset:1024
    ds_read_b128 v[36:39], v12 offset:1024
    ds_read_b128 v[40:43], v11 offset:6144
    ds_read_b128 v[44:47], v11 offset:7168
    ds_read_b128 v[48:51], v13 offset:2048
    ds_read_b128 v[52:55], v12 offset:2048
    ds_read_b128 v[56:59], v11 offset:10240
    ds_read_b128 v[60:63], v11 offset:11264
    s_waitcnt lgkmcnt(8)
    v_cndmask_b32 v16, v16, v89, vcc
    v_cndmask_b32 v17, v17, v89, vcc
    v_cndmask_b32 v18, v18, v89, vcc
    v_cndmask_b32 v19, v19, v89, vcc
    v_mfma_f32_16x16x32_bf16 v[84:87], v[20:23], v[24:27], 0
    v_mfma_f32_16x16x32_bf16 v[72:75], v[20:23], v[28:31], 0
    v_mfma_f32_16x16x32_bf16 v[76:79], v[20:23], v[16:19], 0
    ds_read_b128 v[16:19], v13 offset:3072
    ds_read_b128 v[20:23], v12 offset:3072
    ds_read_b128 v[24:27], v11 offset:14336
    ds_read_b128 v[28:31], v11 offset:15360
    s_waitcnt lgkmcnt(8)
    v_cndmask_b32 v32, v32, v89, vcc
    v_cndmask_b32 v33, v33, v89, vcc
    v_cndmask_b32 v34, v34, v89, vcc
    v_cndmask_b32 v35, v35, v89, vcc
    v_mfma_f32_16x16x32_bf16 v[84:87], v[36:39], v[40:43], v[84:87]
    v_mfma_f32_16x16x32_bf16 v[72:75], v[36:39], v[44:47], v[72:75]
    v_mfma_f32_16x16x32_bf16 v[76:79], v[36:39], v[32:35], v[76:79]
    s_waitcnt lgkmcnt(4)
    v_cndmask_b32 v48, v48, v89, vcc
    v_cndmask_b32 v49, v49, v89, vcc
    v_cndmask_b32 v50, v50, v89, vcc
    v_cndmask_b32 v51, v51, v89, vcc
    v_mfma_f32_16x16x32_bf16 v[84:87], v[52:55], v[56:59], v[84:87]
    v_mfma_f32_16x16x32_bf16 v[72:75], v[52:55], v[60:63], v[72:75]
    v_mfma_f32_16x16x32_bf16 v[76:79], v[52:55], v[48:51], v[76:79]
    s_waitcnt lgkmcnt(0)
    v_cndmask_b32 v16, v16, v89, vcc
    v_cndmask_b32 v17, v17, v89, vcc
    v_cndmask_b32 v18, v18, v89, vcc
    v_cndmask_b32 v19, v19, v89, vcc
    v_mfma_f32_16x16x32_bf16 v[84:87], v[20:23], v[24:27], v[84:87]
    v_mfma_f32_16x16x32_bf16 v[72:75], v[20:23], v[28:31], v[72:75]
    v_mfma_f32_16x16x32_bf16 v[76:79], v[20:23], v[16:19], v[76:79]
    s_mov_b32 vcc_lo, 0xffff
    s_mov_b32 vcc_hi, 0x0
    s_nop 4
    v_cndmask_b32 v84, v72, v84, vcc
    v_cndmask_b32 v85, v73, v85, vcc
    v_cndmask_b32 v86, v74, v86, vcc
    v_cndmask_b32 v87, v75, v87, vcc
    v_permlane32_swap_b32 v84, v76
    v_permlane32_swap_b32 v85, v77
    v_permlane32_swap_b32 v86, v78
    v_permlane32_swap_b32 v87, v79
L_tdone_00:
    v_cvt_pk_bf16_f32 v88, v84, v85
    v_cvt_pk_bf16_f32 v89, v86, v87
    v_min_u32 v84, -2, v88
    v_min_u32 v85, -2, v89
    buffer_store_dwordx2 v[84:85], v7, s[32:35], s77 offen sc1
    ds_read_b64_tr_b16 v[40:41], v8 offset:0
    ds_read_b64_tr_b16 v[42:43], v8 offset:1280
    ds_read_b64_tr_b16 v[44:45], v8 offset:40
    ds_read_b64_tr_b16 v[46:47], v8 offset:1320
    ds_read_b64_tr_b16 v[48:49], v9 offset:0
    ds_read_b64_tr_b16 v[50:51], v9 offset:1280
    ds_read_b64_tr_b16 v[52:53], v8 offset:5120
    ds_read_b64_tr_b16 v[54:55], v8 offset:6400
    s_waitcnt lgkmcnt(6)
    v_mfma_f32_16x16x32_bf16 v[16:19], v[40:43], v[96:99], v[80:83]
    v_mfma_f32_16x16x32_bf16 v[20:23], v[40:43], v[100:103], v[80:83]
    ds_read_b64_tr_b16 v[40:41], v8 offset:5160
    ds_read_b64_tr_b16 v[42:43], v8 offset:6440
    s_waitcnt lgkmcnt(6)
    v_mfma_f32_16x16x32_bf16 v[24:27], v[44:47], v[96:99], v[80:83]
    v_mfma_f32_16x16x32_bf16 v[28:31], v[44:47], v[100:103], v[80:83]
    ds_read_b64_tr_b16 v[44:45], v9 offset:5120
    ds_read_b64_tr_b16 v[46:47], v9 offset:6400
    s_waitcnt lgkmcnt(6)
    v_mfma_f32_16x16x32_bf16 v[32:35], v[48:51], v[96:99], v[80:83]
    v_mfma_f32_16x16x32_bf16 v[36:39], v[48:51], v[100:103], v[80:83]
    ds_read_b64_tr_b16 v[48:49], v8 offset:10240
    ds_read_b64_tr_b16 v[50:51], v8 offset:11520
    s_waitcnt lgkmcnt(6)
    v_mfma_f32_16x16x32_bf16 v[16:19], v[52:55], v[104:107], v[16:19]
    v_mfma_f32_16x16x32_bf16 v[20:23], v[52:55], v[108:111], v[20:23]
    ds_read_b64_tr_b16 v[52:53], v8 offset:10280
    ds_read_b64_tr_b16 v[54:55], v8 offset:11560
    s_waitcnt lgkmcnt(6)
    v_mfma_f32_16x16x32_bf16 v[24:27], v[40:43], v[104:107], v[24:27]
    v_mfma_f32_16x16x32_bf16 v[28:31], v[40:43], v[108:111], v[28:31]
    ds_read_b64_tr_b16 v[40:41], v9 offset:10240
    ds_read_b64_tr_b16 v[42:43], v9 offset:11520
    s_waitcnt lgkmcnt(6)
    v_mfma_f32_16x16x32_bf16 v[32:35], v[44:47], v[104:107], v[32:35]
    v_mfma_f32_16x16x32_bf16 v[36:39], v[44:47], v[108:111], v[36:39]
    ds_read_b64_tr_b16 v[44:45], v8 offset:15360
    ds_read_b64_tr_b16 v[46:47], v8 offset:16640
    s_waitcnt lgkmcnt(6)
    v_mfma_f32_16x16x32_bf16 v[16:19], v[48:51], v[112:115], v[16:19]
    v_mfma_f32_16x16x32_bf16 v[20:23], v[48:51], v[116:119], v[20:23]
    ds_read_b64_tr_b16 v[48:49], v8 offset:15400
    ds_read_b64_tr_b16 v[50:51], v8 offset:16680
    s_waitcnt lgkmcnt(6)
    v_mfma_f32_16x16x32_bf16 v[24:27], v[52:55], v[112:115], v[24:27]
    v_mfma_f32_16x16x32_bf16 v[28:31], v[52:55], v[116:119], v[28:31]
    ds_read_b64_tr_b16 v[52:53], v9 offset:15360
    ds_read_b64_tr_b16 v[54:55], v9 offset:16640
    s_waitcnt lgkmcnt(6)
    v_mfma_f32_16x16x32_bf16 v[32:35], v[40:43], v[112:115], v[32:35]
    v_mfma_f32_16x16x32_bf16 v[36:39], v[40:43], v[116:119], v[36:39]
    v_add_u32 v8, 20480, v8
    v_add_u32 v9, 20480, v9
    s_waitcnt vmcnt(1) lgkmcnt(0)
    s_barrier
    ds_read_b64_tr_b16 v[40:41], v8 offset:0
    ds_read_b64_tr_b16 v[42:43], v8 offset:1280
    s_sub_u32 s75, s66, 1280
    s_add_u32 m0, s70, 0
    v_mfma_f32_16x16x32_bf16 v[16:19], v[44:47], v[120:123], v[16:19]
    v_mfma_f32_16x16x32_bf16 v[20:23], v[44:47], v[124:127], v[20:23]
    buffer_load_dwordx4 v3, s[20:23], s75 offen lds
    ds_read_b64_tr_b16 v[44:45], v8 offset:40
    ds_read_b64_tr_b16 v[46:47], v8 offset:1320
    s_cmp_lt_u32 s43, 2
    s_cselect_b32 s75, s66, s67
    s_sub_u32 s75, s75, 1280
    s_add_u32 m0, s70, 8192
    v_mfma_f32_16x16x32_bf16 v[24:27], v[48:51], v[120:123], v[24:27]
    v_mfma_f32_16x16x32_bf16 v[28:31], v[48:51], v[124:127], v[28:31]
    buffer_load_dwordx4 v4, s[20:23], s75 offen lds
    ds_read_b64_tr_b16 v[48:49], v9 offset:0
    ds_read_b64_tr_b16 v[50:51], v9 offset:1280
    s_sub_u32 s75, s67, 1280
    s_add_u32 m0, s70, 16384
    v_mfma_f32_16x16x32_bf16 v[32:35], v[52:55], v[120:123], v[32:35]
    v_mfma_f32_16x16x32_bf16 v[36:39], v[52:55], v[124:127], v[36:39]
    buffer_load_dwordx4 v5, s[20:23], s75 offen lds
    ds_read_b64_tr_b16 v[52:53], v8 offset:5120
    ds_read_b64_tr_b16 v[54:55], v8 offset:6400
    s_waitcnt lgkmcnt(6)
    s_sub_u32 s75, s68, 1280
    s_add_u32 m0, s70, 20480
    v_mfma_f32_16x16x32_bf16 v[16:19], v[40:43], v[128:131], v[16:19]
    v_mfma_f32_16x16x32_bf16 v[20:23], v[40:43], v[132:135], v[20:23]
    buffer_load_dwordx4 v3, s[20:23], s75 offen lds
    ds_read_b64_tr_b16 v[40:41], v8 offset:5160
    ds_read_b64_tr_b16 v[42:43], v8 offset:6440
    s_waitcnt lgkmcnt(6)
    s_cmp_lt_u32 s43, 2
    s_cselect_b32 s75, s68, s69
    s_sub_u32 s75, s75, 1280
    s_add_u32 m0, s70, 28672
    v_mfma_f32_16x16x32_bf16 v[24:27], v[44:47], v[128:131], v[24:27]
    v_mfma_f32_16x16x32_bf16 v[28:31], v[44:47], v[132:135], v[28:31]
    buffer_load_dwordx4 v4, s[20:23], s75 offen lds
    v_add_u32 v126, 148480, v6
    ds_read_b128 v[96:99], v126 offset:0
    ds_read_b128 v[100:103], v126 offset:1024
    ds_read_b64_tr_b16 v[44:45], v9 offset:5120
    ds_read_b64_tr_b16 v[46:47], v9 offset:6400
    s_waitcnt lgkmcnt(8)
    s_sub_u32 s75, s69, 1280
    s_add_u32 m0, s70, 36864
    v_mfma_f32_16x16x32_bf16 v[32:35], v[48:51], v[128:131], v[32:35]
    v_mfma_f32_16x16x32_bf16 v[36:39], v[48:51], v[132:135], v[36:39]
    buffer_load_dwordx4 v5, s[20:23], s75 offen lds
    ds_read_b128 v[104:107], v126 offset:2048
    s_lshl_b32 s4, s44, 10
    v_add_u32 v124, s4, v7
    ds_read_b64_tr_b16 v[48:49], v8 offset:10240
    ds_read_b64_tr_b16 v[50:51], v8 offset:11520
    s_waitcnt lgkmcnt(9)
    v_mfma_f32_16x16x32_bf16 v[16:19], v[52:55], v[136:139], v[16:19]
    v_mfma_f32_16x16x32_bf16 v[20:23], v[52:55], v[140:143], v[20:23]
    s_mov_b64 exec, 0xfffff
    buffer_load_dword v95, v93, s[32:35], s76 offen
    s_mov_b64 exec, 1
    buffer_load_dword v95, off, s[32:35], s8
    s_mov_b64 exec, -1
    ds_read_b64_tr_b16 v[52:53], v8 offset:10280
    ds_read_b64_tr_b16 v[54:55], v8 offset:11560
    s_waitcnt lgkmcnt(9)
    v_mfma_f32_16x16x32_bf16 v[24:27], v[40:43], v[136:139], v[24:27]
    v_mfma_f32_16x16x32_bf16 v[28:31], v[40:43], v[140:143], v[28:31]
    ds_read_b64_tr_b16 v[40:41], v9 offset:10240
    ds_read_b64_tr_b16 v[42:43], v9 offset:11520
    s_waitcnt lgkmcnt(7)
    v_mfma_f32_16x16x32_bf16 v[32:35], v[44:47], v[136:139], v[32:35]
    v_mfma_f32_16x16x32_bf16 v[36:39], v[44:47], v[140:143], v[36:39]
    ds_read_b64_tr_b16 v[44:45], v8 offset:15360
    ds_read_b64_tr_b16 v[46:47], v8 offset:16640
    s_waitcnt lgkmcnt(6)
    v_mfma_f32_16x16x32_bf16 v[16:19], v[48:51], v[144:147], v[16:19]
    v_mfma_f32_16x16x32_bf16 v[20:23], v[48:51], v[148:151], v[20:23]
    ds_read_b64_tr_b16 v[48:49], v8 offset:15400
    ds_read_b64_tr_b16 v[50:51], v8 offset:16680
    s_waitcnt lgkmcnt(6)
    v_mfma_f32_16x16x32_bf16 v[24:27], v[52:55], v[144:147], v[24:27]
    v_mfma_f32_16x16x32_bf16 v[28:31], v[52:55], v[148:151], v[28:31]
    ds_read_b64_tr_b16 v[52:53], v9 offset:15360
    ds_read_b64_tr_b16 v[54:55], v9 offset:16640
    s_waitcnt lgkmcnt(6)
    v_mfma_f32_16x16x32_bf16 v[32:35], v[40:43], v[144:147], v[32:35]
    v_mfma_f32_16x16x32_bf16 v[36:39], v[40:43], v[148:151], v[36:39]
    v_add_u32 v8, 20480, v8
    v_add_u32 v9, 20480, v9
    ds_read_b64_tr_b16 v[40:41], v8 offset:0
    ds_read_b64_tr_b16 v[42:43], v8 offset:1280
    s_waitcnt lgkmcnt(6)
    v_mfma_f32_16x16x32_bf16 v[16:19], v[44:47], v[152:155], v[16:19]
    v_mfma_f32_16x16x32_bf16 v[20:23], v[44:47], v[156:159], v[20:23]
    ds_read_b64_tr_b16 v[44:45], v8 offset:40
    ds_read_b64_tr_b16 v[46:47], v8 offset:1320
    s_waitcnt lgkmcnt(6)
    v_mfma_f32_16x16x32_bf16 v[24:27], v[48:51], v[152:155], v[24:27]
    v_mfma_f32_16x16x32_bf16 v[28:31], v[48:51], v[156:159], v[28:31]
    ds_read_b64_tr_b16 v[48:49], v9 offset:0
    ds_read_b64_tr_b16 v[50:51], v9 offset:1280
    s_waitcnt lgkmcnt(6)
    s_add_u32 s75, s93, 0
    s_add_u32 m0, s70, 61440
    v_mfma_f32_16x16x32_bf16 v[32:35], v[52:55], v[152:155], v[32:35]
    v_mfma_f32_16x16x32_bf16 v[36:39], v[52:55], v[156:159], v[36:39]
    buffer_load_dwordx4 v90, s[24:27], s75 offen lds
    s_waitcnt lgkmcnt(0)
    v_mov_b32 v126, v104
    v_mov_b32 v127, v105
    ds_read_b64_tr_b16 v[52:53], v8 offset:5120
    ds_read_b64_tr_b16 v[54:55], v8 offset:6400
    v_mfma_f32_16x16x32_bf16 v[16:19], v[40:43], v[160:163], v[16:19]
    v_mfma_f32_16x16x32_bf16 v[20:23], v[40:43], v[164:167], v[20:23]
    ds_read_b64_tr_b16 v[40:41], v8 offset:5160
    ds_read_b64_tr_b16 v[42:43], v8 offset:6440
    ds_read_b64_tr_b16 v[128:129], v9 offset:5120
    ds_read_b64_tr_b16 v[130:131], v9 offset:6400
    ds_read_b64_tr_b16 v[132:133], v8 offset:10240
    ds_read_b64_tr_b16 v[134:135], v8 offset:11520
    ds_read_b64_tr_b16 v[136:137], v8 offset:10280
    ds_read_b64_tr_b16 v[138:139], v8 offset:11560
    ds_read_b64_tr_b16 v[140:141], v9 offset:10240
    ds_read_b64_tr_b16 v[142:143], v9 offset:11520
    ds_read_b64_tr_b16 v[144:145], v8 offset:15360
    ds_read_b64_tr_b16 v[146:147], v8 offset:16640
    v_mfma_f32_16x16x32_bf16 v[24:27], v[44:47], v[160:163], v[24:27]
    v_mfma_f32_16x16x32_bf16 v[28:31], v[44:47], v[164:167], v[28:31]
    ds_read_b64_tr_b16 v[148:149], v8 offset:15400
    s_waitcnt lgkmcnt(12)
    ds_read_b64_tr_b16 v[150:151], v8 offset:16680
    s_add_u32 s75, s93, 0
    s_add_u32 m0, s70, 69632
    v_mfma_f32_16x16x32_bf16 v[32:35], v[48:51], v[160:163], v[32:35]
    v_mfma_f32_16x16x32_bf16 v[36:39], v[48:51], v[164:167], v[36:39]
    buffer_load_dwordx4 v91, s[24:27], s75 offen lds
    ds_read_b64_tr_b16 v[152:153], v9 offset:15360
    ds_read_b64_tr_b16 v[154:155], v9 offset:16640
    v_mfma_f32_16x16x32_bf16 v[16:19], v[52:55], v[168:171], v[16:19]
    v_mfma_f32_16x16x32_bf16 v[20:23], v[52:55], v[172:175], v[20:23]
    s_waitcnt lgkmcnt(14)
    v_mfma_f32_16x16x32_bf16 v[24:27], v[40:43], v[168:171], v[24:27]
    v_mfma_f32_16x16x32_bf16 v[28:31], v[40:43], v[172:175], v[28:31]
    s_waitcnt lgkmcnt(12)
    s_add_u32 s75, s93, 0
    s_add_u32 m0, s70, 77824
    v_mfma_f32_16x16x32_bf16 v[32:35], v[128:131], v[168:171], v[32:35]
    v_mfma_f32_16x16x32_bf16 v[36:39], v[128:131], v[172:175], v[36:39]
    buffer_load_dwordx4 v92, s[24:27], s75 offen lds
    s_waitcnt lgkmcnt(10)
    v_mfma_f32_16x16x32_bf16 v[16:19], v[132:135], v[176:179], v[16:19]
    v_mfma_f32_16x16x32_bf16 v[20:23], v[132:135], v[180:183], v[20:23]
    s_waitcnt lgkmcnt(8)
    v_mfma_f32_16x16x32_bf16 v[24:27], v[136:139], v[176:179], v[24:27]
    v_mfma_f32_16x16x32_bf16 v[28:31], v[136:139], v[180:183], v[28:31]
    v_add_u32 v8, -122880, v8
    v_add_u32 v9, -122880, v9
    s_waitcnt vmcnt(5) lgkmcnt(0)
    s_barrier
    ds_read_b64_tr_b16 v[44:45], v8 offset:0
    ds_read_b64_tr_b16 v[46:47], v8 offset:1280
    ds_read_b64_tr_b16 v[48:49], v8 offset:40
    ds_read_b64_tr_b16 v[50:51], v8 offset:1320
    ds_read_b64_tr_b16 v[52:53], v9 offset:0
    ds_read_b64_tr_b16 v[54:55], v9 offset:1280
    ds_read_b64_tr_b16 v[40:41], v8 offset:5120
    ds_read_b64_tr_b16 v[42:43], v8 offset:6400
    ds_read_b64_tr_b16 v[128:129], v8 offset:5160
    ds_read_b64_tr_b16 v[130:131], v8 offset:6440
    v_mfma_f32_16x16x32_bf16 v[32:35], v[140:143], v[176:179], v[32:35]
    v_mfma_f32_16x16x32_bf16 v[36:39], v[140:143], v[180:183], v[36:39]
    ds_read_b64_tr_b16 v[132:133], v9 offset:5120
    ds_read_b64_tr_b16 v[134:135], v9 offset:6400
    s_add_u32 s3, s78, 0
    v_mfma_f32_16x16x32_bf16 v[16:19], v[144:147], v[184:187], v[16:19]
    v_mfma_f32_16x16x32_bf16 v[20:23], v[144:147], v[188:191], v[20:23]
    buffer_load_dwordx4 v[56:59], v94, s[32:35], s3 offen sc1
    ds_read_b64_tr_b16 v[136:137], v8 offset:10240
    ds_read_b64_tr_b16 v[138:139], v8 offset:11520
    v_mfma_f32_16x16x32_bf16 v[24:27], v[148:151], v[184:187], v[24:27]
    v_mfma_f32_16x16x32_bf16 v[28:31], v[148:151], v[188:191], v[28:31]
    ds_read_b64_tr_b16 v[140:141], v8 offset:10280
    s_waitcnt lgkmcnt(12)
    ds_read_b64_tr_b16 v[142:143], v8 offset:11560
    s_add_u32 s3, s78, 4096
    v_mfma_f32_16x16x32_bf16 v[32:35], v[152:155], v[184:187], v[32:35]
    v_mfma_f32_16x16x32_bf16 v[36:39], v[152:155], v[188:191], v[36:39]
    buffer_load_dwordx4 v[60:63], v94, s[32:35], s3 offen sc1
    ds_read_b64_tr_b16 v[144:145], v9 offset:10240
    ds_read_b64_tr_b16 v[146:147], v9 offset:11520
    v_mfma_f32_16x16x32_bf16 v[16:19], v[44:47], v[192:195], v[16:19]
    v_mfma_f32_16x16x32_bf16 v[20:23], v[44:47], v[196:199], v[20:23]
    s_waitcnt lgkmcnt(12)
    ds_read_b64_tr_b16 v[148:149], v8 offset:15360
    ds_read_b64_tr_b16 v[150:151], v8 offset:16640
    s_add_u32 s3, s78, 8192
    v_mfma_f32_16x16x32_bf16 v[24:27], v[48:51], v[192:195], v[24:27]
    v_mfma_f32_16x16x32_bf16 v[28:31], v[48:51], v[196:199], v[28:31]
    buffer_load_dwordx4 v[64:67], v94, s[32:35], s3 offen sc1
    ds_read_b64_tr_b16 v[152:153], v8 offset:15400
    s_waitcnt lgkmcnt(12)
    ds_read_b64_tr_b16 v[154:155], v8 offset:16680
    v_mfma_f32_16x16x32_bf16 v[32:35], v[52:55], v[192:195], v[32:35]
    v_mfma_f32_16x16x32_bf16 v[36:39], v[52:55], v[196:199], v[36:39]
    ds_read_b64_tr_b16 v[44:45], v9 offset:15360
    ds_read_b64_tr_b16 v[46:47], v9 offset:16640
    s_add_u32 s3, s78, 12288
    v_mfma_f32_16x16x32_bf16 v[16:19], v[40:43], v[200:203], v[16:19]
    v_mfma_f32_16x16x32_bf16 v[20:23], v[40:43], v[204:207], v[20:23]
    buffer_load_dwordx4 v[68:71], v94, s[32:35], s3 offen sc1
    s_waitcnt lgkmcnt(14)
    v_mfma_f32_16x16x32_bf16 v[24:27], v[128:131], v[200:203], v[24:27]
    v_mfma_f32_16x16x32_bf16 v[28:31], v[128:131], v[204:207], v[28:31]
    s_waitcnt lgkmcnt(12)
    v_mfma_f32_16x16x32_bf16 v[32:35], v[132:135], v[200:203], v[32:35]
    v_mfma_f32_16x16x32_bf16 v[36:39], v[132:135], v[204:207], v[36:39]
    s_waitcnt lgkmcnt(10)
    v_mfma_f32_16x16x32_bf16 v[16:19], v[136:139], v[208:211], v[16:19]
    v_mfma_f32_16x16x32_bf16 v[20:23], v[136:139], v[212:215], v[20:23]
    s_waitcnt lgkmcnt(8)
    v_mfma_f32_16x16x32_bf16 v[24:27], v[140:143], v[208:211], v[24:27]
    v_mfma_f32_16x16x32_bf16 v[28:31], v[140:143], v[212:215], v[28:31]
    v_add_u32 v8, 20480, v8
    v_add_u32 v9, 20480, v9
    ds_read_b64_tr_b16 v[48:49], v9 offset:0
    ds_read_b64_tr_b16 v[50:51], v9 offset:1280
    ds_read_b64_tr_b16 v[52:53], v9 offset:5120
    ds_read_b64_tr_b16 v[54:55], v9 offset:6400
    ds_read_b64_tr_b16 v[40:41], v9 offset:10240
    ds_read_b64_tr_b16 v[42:43], v9 offset:11520
    ds_read_b64_tr_b16 v[128:129], v9 offset:15360
    s_waitcnt lgkmcnt(12)
    ds_read_b64_tr_b16 v[130:131], v9 offset:16640
    ds_read_b64_tr_b16 v[132:133], v8 offset:0
    ds_read_b64_tr_b16 v[134:135], v8 offset:1280
    s_add_u32 s3, s78, 16384
    v_mfma_f32_16x16x32_bf16 v[32:35], v[144:147], v[208:211], v[32:35]
    v_mfma_f32_16x16x32_bf16 v[36:39], v[144:147], v[212:215], v[36:39]
    buffer_load_dwordx4 v[72:75], v94, s[32:35], s3 offen sc1
    s_waitcnt lgkmcnt(12)
    ds_read_b64_tr_b16 v[136:137], v8 offset:5120
    ds_read_b64_tr_b16 v[138:139], v8 offset:6400
    s_add_u32 s3, s78, 20480
    v_mfma_f32_16x16x32_bf16 v[16:19], v[148:151], v[216:219], v[16:19]
    v_mfma_f32_16x16x32_bf16 v[20:23], v[148:151], v[220:223], v[20:23]
    buffer_load_dwordx4 v[76:79], v94, s[32:35], s3 offen sc1
    ds_read_b64_tr_b16 v[140:141], v8 offset:10240
    s_waitcnt lgkmcnt(12)
    ds_read_b64_tr_b16 v[142:143], v8 offset:11520
    s_add_u32 s3, s78, 24576
    v_mfma_f32_16x16x32_bf16 v[24:27], v[152:155], v[216:219], v[24:27]
    v_mfma_f32_16x16x32_bf16 v[28:31], v[152:155], v[220:223], v[28:31]
    buffer_load_dwordx4 v[80:83], v94, s[32:35], s3 offen sc1
    ds_read_b64_tr_b16 v[144:145], v8 offset:15360
    ds_read_b64_tr_b16 v[146:147], v8 offset:16640
    s_add_u32 s3, s78, 28672
    v_mfma_f32_16x16x32_bf16 v[32:35], v[44:47], v[216:219], v[32:35]
    v_mfma_f32_16x16x32_bf16 v[36:39], v[44:47], v[220:223], v[36:39]
    buffer_load_dwordx4 v[84:87], v94, s[32:35], s3 offen sc1
    s_waitcnt lgkmcnt(12)
    ds_read_b64_tr_b16 v[148:149], v8 offset:40
    ds_read_b64_tr_b16 v[150:151], v8 offset:1320
    s_add_u32 s75, s93, 163840
    s_add_u32 m0, s70, 81920
    v_mfma_f32_16x16x32_bf16 v[32:35], v[48:51], v[224:227], v[32:35]
    v_mfma_f32_16x16x32_bf16 v[36:39], v[48:51], v[228:231], v[36:39]
    buffer_load_dwordx4 v90, s[24:27], s75 offen lds
    ds_read_b64_tr_b16 v[152:153], v8 offset:5160
    s_waitcnt lgkmcnt(12)
    ds_read_b64_tr_b16 v[154:155], v8 offset:6440
    s_add_u32 s75, s93, 163840
    s_add_u32 m0, s70, 90112
    v_mfma_f32_16x16x32_bf16 v[32:35], v[52:55], v[232:235], v[32:35]
    v_mfma_f32_16x16x32_bf16 v[36:39], v[52:55], v[236:239], v[36:39]
    buffer_load_dwordx4 v91, s[24:27], s75 offen lds
    ds_read_b64_tr_b16 v[44:45], v8 offset:10280
    ds_read_b64_tr_b16 v[46:47], v8 offset:11560
    s_add_u32 s75, s93, 163840
    s_add_u32 m0, s70, 98304
    v_mfma_f32_16x16x32_bf16 v[32:35], v[40:43], v[240:243], v[32:35]
    v_mfma_f32_16x16x32_bf16 v[36:39], v[40:43], v[244:247], v[36:39]
    buffer_load_dwordx4 v92, s[24:27], s75 offen lds
    s_waitcnt lgkmcnt(12)
    ds_read_b64_tr_b16 v[48:49], v8 offset:15400
    ds_read_b64_tr_b16 v[50:51], v8 offset:16680
    v_mfma_f32_16x16x32_bf16 v[32:35], v[128:131], v[248:251], v[32:35]
    v_mfma_f32_16x16x32_bf16 v[36:39], v[128:131], v[252:255], v[36:39]
    v_mfma_f32_16x16x32_bf16 v[16:19], v[132:135], v[224:227], v[16:19]
    v_mfma_f32_16x16x32_bf16 v[20:23], v[132:135], v[228:231], v[20:23]
    s_nop 4
    v_mul_f32 v112, s94, v32
    v_mul_f32 v113, s94, v33
    v_mul_f32 v114, s94, v34
    s_waitcnt lgkmcnt(12)
    v_mfma_f32_16x16x32_bf16 v[16:19], v[136:139], v[232:235], v[16:19]
    v_mfma_f32_16x16x32_bf16 v[20:23], v[136:139], v[236:239], v[20:23]
    v_mul_f32 v115, s94, v35
    v_mul_f32 v116, s94, v36
    v_mul_f32 v117, s94, v37
    s_waitcnt lgkmcnt(10)
    v_mfma_f32_16x16x32_bf16 v[16:19], v[140:143], v[240:243], v[16:19]
    v_mfma_f32_16x16x32_bf16 v[20:23], v[140:143], v[244:247], v[20:23]
    v_mul_f32 v118, s94, v38
    v_mul_f32 v119, s94, v39
    v_exp_f32_e64 v112, v112 clamp
    s_waitcnt lgkmcnt(8)
    v_mfma_f32_16x16x32_bf16 v[16:19], v[144:147], v[248:251], v[16:19]
    v_mfma_f32_16x16x32_bf16 v[20:23], v[144:147], v[252:255], v[20:23]
    v_max_f32 v32, s95, v32
    v_exp_f32_e64 v113, v113 clamp
    v_max_f32 v33, s95, v33
    s_waitcnt lgkmcnt(6)
    v_mfma_f32_16x16x32_bf16 v[24:27], v[148:151], v[224:227], v[24:27]
    v_mfma_f32_16x16x32_bf16 v[28:31], v[148:151], v[228:231], v[28:31]
    v_exp_f32_e64 v114, v114 clamp
    v_max_f32 v34, s95, v34
    v_exp_f32_e64 v115, v115 clamp
    s_waitcnt lgkmcnt(4)
    v_mfma_f32_16x16x32_bf16 v[24:27], v[152:155], v[232:235], v[24:27]
    v_mfma_f32_16x16x32_bf16 v[28:31], v[152:155], v[236:239], v[28:31]
    v_max_f32 v35, s95, v35
    v_exp_f32_e64 v116, v116 clamp
    v_max_f32 v36, s95, v36
    s_waitcnt lgkmcnt(2)
    v_mfma_f32_16x16x32_bf16 v[24:27], v[44:47], v[240:243], v[24:27]
    v_mfma_f32_16x16x32_bf16 v[28:31], v[44:47], v[244:247], v[28:31]
    v_exp_f32_e64 v117, v117 clamp
    v_max_f32 v37, s95, v37
    v_exp_f32_e64 v118, v118 clamp
    s_waitcnt lgkmcnt(0)
    v_mfma_f32_16x16x32_bf16 v[24:27], v[48:51], v[248:251], v[24:27]
    v_mfma_f32_16x16x32_bf16 v[28:31], v[48:51], v[252:255], v[28:31]
    v_max_f32 v38, s95, v38
    v_exp_f32_e64 v119, v119 clamp
    v_max_f32 v39, s95, v39
    v_add_f32 v32, v32, v112
    v_add_f32 v33, v33, v113
    v_add_f32 v34, v34, v114
    v_add_f32 v35, v35, v115
    v_add_f32 v36, v36, v116
    v_add_f32 v37, v37, v117
    v_add_f32 v38, v38, v118
    v_add_f32 v39, v39, v119
    v_cvt_pk_bf16_f32 v162, v32, v33
    v_cvt_pk_bf16_f32 v163, v34, v35
    ds_write_b64 v124, v[162:163] offset:49152
    v_mov_b32 v166, v162
    v_mov_b32 v167, v163
    v_cvt_pk_bf16_f32 v170, v36, v37
    v_cvt_pk_bf16_f32 v171, v38, v39
    ds_write_b64 v124, v[170:171] offset:49664
    v_mov_b32 v174, v170
    v_mov_b32 v175, v171
    s_waitcnt vmcnt(3)
    v_mfma_f32_16x16x32_bf16 v[108:111], v[96:99], v[56:59], 0
    v_mfma_f32_16x16x32_bf16 v[108:111], v[96:99], v[60:63], v[108:111]
    v_mfma_f32_16x16x32_bf16 v[108:111], v[96:99], v[64:67], v[108:111]
    v_mfma_f32_16x16x32_bf16 v[108:111], v[96:99], v[68:71], v[108:111]
    v_mfma_f32_16x16x32_bf16 v[108:111], v[96:99], v[72:75], v[108:111]
    v_mfma_f32_16x16x32_bf16 v[108:111], v[96:99], v[76:79], v[108:111]
    v_mfma_f32_16x16x32_bf16 v[108:111], v[96:99], v[80:83], v[108:111]
    v_mfma_f32_16x16x32_bf16 v[108:111], v[96:99], v[84:87], v[108:111]
    v_mul_f32 v112, s94, v16
    v_mul_f32 v113, s94, v17
    v_mul_f32 v114, s94, v18
    v_mul_f32 v115, s94, v19
    v_mul_f32 v116, s94, v20
    v_mul_f32 v117, s94, v21
    v_mul_f32 v118, s94, v22
    v_mul_f32 v119, s94, v23
    v_exp_f32_e64 v112, v112 clamp
    v_max_f32 v16, s95, v16
    v_exp_f32_e64 v113, v113 clamp
    v_max_f32 v17, s95, v17
    v_exp_f32_e64 v114, v114 clamp
    v_max_f32 v18, s95, v18
    v_exp_f32_e64 v115, v115 clamp
    v_max_f32 v19, s95, v19
    v_exp_f32_e64 v116, v116 clamp
    v_max_f32 v20, s95, v20
    v_exp_f32_e64 v117, v117 clamp
    v_max_f32 v21, s95, v21
    v_exp_f32_e64 v118, v118 clamp
    v_max_f32 v22, s95, v22
    v_exp_f32_e64 v119, v119 clamp
    v_max_f32 v23, s95, v23
    v_add_f32 v16, v16, v112
    v_add_f32 v17, v17, v113
    v_add_f32 v18, v18, v114
    v_add_f32 v19, v19, v115
    v_add_f32 v20, v20, v116
    v_add_f32 v21, v21, v117
    v_add_f32 v22, v22, v118
    v_add_f32 v23, v23, v119
    v_cvt_pk_bf16_f32 v160, v16, v17
    v_cvt_pk_bf16_f32 v161, v18, v19
    v_cvt_pk_bf16_f32 v168, v20, v21
    v_cvt_pk_bf16_f32 v169, v22, v23
    v_add_f32 v88, v108, v109
    v_add_f32 v89, v110, v111
    v_add_f32 v88, v88, v89
    v_cmp_u_f32 vcc, v88, v88
    s_cbranch_vccz L_gok_00
    s_mov_b32 s92, 0
L_gsp_00:
    v_max3_u32 v88, v56, v57, v58
    v_max3_u32 v88, v88, v59, v60
    v_max3_u32 v88, v88, v61, v62
    v_max3_u32 v88, v88, v63, v64
    v_max3_u32 v88, v88, v65, v66
    v_max3_u32 v88, v88, v67, v68
    v_max3_u32 v88, v88, v69, v70
    v_max3_u32 v88, v88, v71, v72
    v_max3_u32 v88, v88, v73, v74
    v_max3_u32 v88, v88, v75, v76
    v_max3_u32 v88, v88, v77, v78
    v_max3_u32 v88, v88, v79, v80
    v_max3_u32 v88, v88, v81, v82
    v_max3_u32 v88, v88, v83, v84
    v_max3_u32 v88, v88, v85, v86
    v_max_u32 v88, v88, v87
    v_cmp_eq_u32 vcc, -1, v88
    s_cbranch_vccz L_gre_00
    s_add_u32 s3, s78, 0
    buffer_load_dwordx4 v[56:59], v94, s[32:35], s3 offen sc1
    s_add_u32 s3, s78, 4096
    buffer_load_dwordx4 v[60:63], v94, s[32:35], s3 offen sc1
    s_add_u32 s3, s78, 8192
    buffer_load_dwordx4 v[64:67], v94, s[32:35], s3 offen sc1
    s_add_u32 s3, s78, 12288
    buffer_load_dwordx4 v[68:71], v94, s[32:35], s3 offen sc1
    s_add_u32 s3, s78, 16384
    buffer_load_dwordx4 v[72:75], v94, s[32:35], s3 offen sc1
    s_add_u32 s3, s78, 20480
    buffer_load_dwordx4 v[76:79], v94, s[32:35], s3 offen sc1
    s_add_u32 s3, s78, 24576
    buffer_load_dwordx4 v[80:83], v94, s[32:35], s3 offen sc1
    s_add_u32 s3, s78, 28672
    buffer_load_dwordx4 v[84:87], v94, s[32:35], s3 offen sc1
    s_waitcnt vmcnt(0)
    s_add_u32 s92, s92, 1
    s_cmp_lt_u32 s92, 200000
    s_cbranch_scc1 L_gsp_00
L_gre_00:
    v_mfma_f32_16x16x32_bf16 v[108:111], v[96:99], v[56:59], 0
    v_mfma_f32_16x16x32_bf16 v[108:111], v[96:99], v[60:63], v[108:111]
    v_mfma_f32_16x16x32_bf16 v[108:111], v[96:99], v[64:67], v[108:111]
    v_mfma_f32_16x16x32_bf16 v[108:111], v[96:99], v[68:71], v[108:111]
    v_mfma_f32_16x16x32_bf16 v[108:111], v[96:99], v[72:75], v[108:111]
    v_mfma_f32_16x16x32_bf16 v[108:111], v[96:99], v[76:79], v[108:111]
    v_mfma_f32_16x16x32_bf16 v[108:111], v[96:99], v[80:83], v[108:111]
    v_mfma_f32_16x16x32_bf16 v[108:111], v[96:99], v[84:87], v[108:111]
    s_nop 7
L_gok_00:
    v_cvt_pk_bf16_f32 v88, v108, v109
    v_cvt_pk_bf16_f32 v89, v110, v111
    s_cmp_lt_u32 s86, 2
    s_cbranch_scc0 L_w23_00
    s_lshl_b32 s4, s86, 10
    v_add_u32 v108, s4, v126
    ds_write_b64 v108, v[88:89] offset:40960
    s_branch L_wd_00
L_w23_00:
    s_cmp_eq_u32 s86, 2
    s_cbranch_scc0 L_w3_00
    s_mov_b32 vcc_lo, 0xa0a5f5f
    s_mov_b32 vcc_hi, 0xa0a5f5f
    v_cndmask_b32 v108, v106, v88, vcc
    v_cndmask_b32 v109, v106, v89, vcc
    ds_write_b64 v126, v[108:109] offset:43008
    s_mov_b32 vcc_lo, 0xf5f5a0a0
    s_mov_b32 vcc_hi, 0xf5f5a0a0
    v_cndmask_b32 v110, v106, v88, vcc
    v_cndmask_b32 v111, v106, v89, vcc
    ds_write_b64 v126, v[110:111] offset:44032
    s_branch L_wd_00
L_w3_00:
    s_mov_b32 vcc_lo, 0x0
    s_mov_b32 vcc_hi, 0xf50aa05f
    v_cndmask_b32 v108, v106, v88, vcc
    v_cndmask_b32 v109, v106, v89, vcc
    ds_write_b64 v127, v[108:109] offset:43016
    s_mov_b32 vcc_lo, 0xff00ff
    s_mov_b32 vcc_hi, 0x0
    v_cndmask_b32 v110, v106, v88, vcc
    v_cndmask_b32 v111, v106, v89, vcc
    ds_write_b64 v126, v[110:111] offset:40968
    s_mov_b32 vcc_lo, 0xff00ff00
    s_mov_b32 vcc_hi, 0x0
    v_cndmask_b32 v108, v106, v88, vcc
    v_cndmask_b32 v109, v106, v89, vcc
    ds_write_b64 v126, v[108:109] offset:41992
L_wd_00:
    s_add_u32 s75, s93, 327680
    s_add_u32 m0, s70, 102400
    s_nop 0
    buffer_load_dwordx4 v90, s[24:27], s75 offen lds
    s_add_u32 s75, s93, 327680
    s_add_u32 m0, s70, 110592
    s_nop 0
    buffer_load_dwordx4 v91, s[24:27], s75 offen lds
    s_add_u32 s75, s93, 327680
    s_add_u32 m0, s70, 118784
    s_nop 0
    buffer_load_dwordx4 v92, s[24:27], s75 offen lds
    v_mul_f32 v136, s94, v24
    v_mul_f32 v137, s94, v25
    v_mul_f32 v138, s94, v26
    v_mul_f32 v139, s94, v27
    v_mul_f32 v140, s94, v28
    v_mul_f32 v141, s94, v29
    v_mul_f32 v142, s94, v30
    v_mul_f32 v143, s94, v31
    v_exp_f32_e64 v136, v136 clamp
    v_max_f32 v24, s95, v24
    v_exp_f32_e64 v137, v137 clamp
    v_max_f32 v25, s95, v25
    v_exp_f32_e64 v138, v138 clamp
    v_max_f32 v26, s95, v26
    v_exp_f32_e64 v139, v139 clamp
    v_max_f32 v27, s95, v27
    v_exp_f32_e64 v140, v140 clamp
    v_max_f32 v28, s95, v28
    v_exp_f32_e64 v141, v141 clamp
    v_max_f32 v29, s95, v29
    v_exp_f32_e64 v142, v142 clamp
    v_max_f32 v30, s95, v30
    v_exp_f32_e64 v143, v143 clamp
    v_max_f32 v31, s95, v31
    v_add_f32 v24, v24, v136
    v_add_f32 v25, v25, v137
    v_add_f32 v26, v26, v138
    v_add_f32 v27, v27, v139
    v_add_f32 v28, v28, v140
    v_add_f32 v29, v29, v141
    v_add_f32 v30, v30, v142
    v_add_f32 v31, v31, v143
    v_cvt_pk_bf16_f32 v164, v24, v25
    v_cvt_pk_bf16_f32 v165, v26, v27
    v_cvt_pk_bf16_f32 v172, v28, v29
    v_cvt_pk_bf16_f32 v173, v30, v31
    s_add_u32 s75, s93, 491520
    s_add_u32 m0, s70, 122880
    s_nop 0
    buffer_load_dwordx4 v90, s[24:27], s75 offen lds
    s_add_u32 s75, s93, 491520
    s_add_u32 m0, s70, 131072
    s_nop 0
    buffer_load_dwordx4 v91, s[24:27], s75 offen lds
    s_add_u32 s75, s93, 491520
    s_add_u32 m0, s70, 139264
    s_nop 0
    buffer_load_dwordx4 v92, s[24:27], s75 offen lds
    s_add_u32 s75, s93, 655360
    s_add_u32 m0, s70, 143360
    s_nop 0
    buffer_load_dwordx4 v90, s[24:27], s75 offen lds
    s_add_u32 s75, s93, 655360
    s_add_u32 m0, s70, 151552
    s_nop 0
    buffer_load_dwordx4 v91, s[24:27], s75 offen lds
    s_add_u32 s75, s93, 655360
    s_add_u32 m0, s70, 159744
    s_nop 0
    buffer_load_dwordx4 v92, s[24:27], s75 offen lds
    s_waitcnt lgkmcnt(0)
    s_barrier
    ds_read_b128 v[136:139], v6 offset:43008
    ds_read_b128 v[128:131], v6 offset:40960
    ds_read_b64 v[104:105], v6 offset:44032
    ds_read_b128 v[132:135], v6 offset:41984
    s_waitcnt lgkmcnt(3)
    v_mfma_f32_16x16x32_bf16 v[16:19], v[136:139], v[160:163], v[100:103]
    v_mfma_f32_16x16x32_bf16 v[28:31], v[136:139], v[168:171], v[100:103]
    s_waitcnt lgkmcnt(2)
    v_mfma_f32_16x16x32_bf16 v[20:23], v[128:131], v[160:163], 0
    v_mfma_f32_16x16x32_bf16 v[32:35], v[128:131], v[168:171], 0
    s_waitcnt lgkmcnt(1)
    v_mfma_f32_16x16x32_bf16 v[16:19], v[104:107], v[164:167], v[16:19]
    v_mfma_f32_16x16x32_bf16 v[28:31], v[104:107], v[172:175], v[28:31]
    s_waitcnt lgkmcnt(0)
    v_mfma_f32_16x16x32_bf16 v[24:27], v[132:135], v[164:167], 0
    v_mfma_f32_16x16x32_bf16 v[36:39], v[132:135], v[172:175], 0
    s_mov_b32 vcc_lo, 0xffffffff
    s_mov_b32 vcc_hi, 0x0
    s_nop 1
    v_rcp_f32 v16, v16
    v_rcp_f32 v17, v17
    v_rcp_f32 v28, v28
    v_rcp_f32 v29, v29
    v_mul_f32 v20, v20, v16
    v_mul_f32 v21, v21, v16
    v_mul_f32 v22, v22, v16
    v_mul_f32 v23, v23, v16
    v_mul_f32 v24, v24, v17
    v_mul_f32 v25, v25, v17
    v_mul_f32 v26, v26, v17
    v_mul_f32 v27, v27, v17
    v_cndmask_b32 v16, v17, v16, vcc
    v_cvt_pk_bf16_f32 v176, v20, v21
    v_cvt_pk_bf16_f32 v177, v22, v23
    v_cvt_pk_bf16_f32 v178, v24, v25
    v_cvt_pk_bf16_f32 v179, v26, v27
    v_mul_f32 v18, v18, v16
    v_mul_f32 v19, v19, v16
    v_cvt_pk_bf16_f32 v184, v18, v19
    v_mul_f32 v32, v32, v28
    v_mul_f32 v33, v33, v28
    v_mul_f32 v34, v34, v28
    v_mul_f32 v35, v35, v28
    v_mul_f32 v36, v36, v29
    v_mul_f32 v37, v37, v29
    v_mul_f32 v38, v38, v29
    v_mul_f32 v39, v39, v29
    v_cndmask_b32 v28, v29, v28, vcc
    v_cvt_pk_bf16_f32 v180, v32, v33
    v_cvt_pk_bf16_f32 v181, v34, v35
    v_cvt_pk_bf16_f32 v182, v36, v37
    v_cvt_pk_bf16_f32 v183, v38, v39
    v_mul_f32 v30, v30, v28
    v_mul_f32 v31, v31, v28
    v_cvt_pk_bf16_f32 v186, v30, v31
    s_mul_i32 s3, s42, 2560
    s_add_u32 s3, s3, s76
    s_add_u32 s3, s3, 0
    s_add_u32 s4, s3, 20480
    s_lshr_b32 s5, s42, 1
    s_mul_i32 s5, s5, 5120
    s_and_b32 s6, s42, 1
    s_lshl_b32 s6, s6, 3
    s_add_u32 s5, s5, s6
    s_add_u32 s5, s5, s76
    s_add_u32 s6, s5, 20480
    v_lshrrev_b32 v14, 4, v10
    v_mul_u32_u24 v14, 1024, v14
    v_add_u32 v14, v14, v6
    v_mov_b32 v11, s47
    s_cmp_eq_u32 s48, 1
    s_cbranch_scc1 L_fast_00
    buffer_store_dwordx4 v[176:179], v6, s[32:35], s3 offen sc1
    buffer_store_dwordx4 v[180:183], v6, s[32:35], s4 offen sc1
    buffer_store_dword v184, v14, s[32:35], s5 offen offset:1024 sc1
    buffer_store_dword v186, v14, s[32:35], s6 offen offset:1024 sc1
    s_branch L_pubd_00
L_fast_00:
    buffer_store_dwordx4 v[176:179], v6, s[32:35], s3 offen nt
    buffer_store_dwordx4 v[180:183], v6, s[32:35], s4 offen nt
    buffer_store_dword v184, v14, s[32:35], s5 offen offset:1024 nt
    buffer_store_dword v186, v14, s[32:35], s6 offen offset:1024 nt
L_pubd_00:
    s_mov_b64 exec, -1
    s_mul_i32 s7, s85, 51200
    s_add_u32 s7, s7, 61440
    v_and_b32 v0, 3, v10
    v_lshrrev_b32 v1, 2, v10
    v_mul_u32_u24 v1, 160, v1
    v_lshl_add_u32 v1, v0, 3, v1
    v_add_u32 v1, s7, v1
    v_bfe_u32 v2, v10, 3, 1
    v_mul_u32_u24 v2, 40, v2
    v_lshrrev_b32 v3, 5, v10
    v_mad_u32_u24 v2, v3, 20, v2
    v_bfe_u32 v3, v10, 4, 1
    v_lshl_add_u32 v2, v3, 1, v2
    v_bfe_u32 v3, v10, 2, 1
    v_add_u32 v2, v2, v3
    v_mul_u32_u24 v2, 160, v2
    v_lshl_add_u32 v2, v0, 3, v2
    v_add_u32 v2, s7, v2
    v_lshlrev_b32 v3, 2, v10
    s_mul_i32 s7, s43, 5120
    v_add_u32 v7, s7, v6
    s_xor_b32 s7, s43, 1
    s_mul_i32 s7, s7, 5120
    v_add_u32 v4, s7, v6
    s_waitcnt vmcnt(4) lgkmcnt(0)
    s_branch L_phase2
L_path_01:
    s_cmp_eq_u32 s44, 0
    s_cselect_b32 s87, s41, 0
    s_bfe_u32 s75, s84, 0x40004
    s_add_u32 s75, s75, s83
    s_cmp_ge_u32 s75, 10
    s_cselect_b32 s73, 10, 0
    s_sub_u32 s75, s75, s73
    s_mul_i32 s62, s75, 245760
    s_add_u32 s62, s62, s5
    s_lshl_b32 s52, s75, 7
    s_add_u32 s52, s52, s4
    s_bfe_u32 s75, s84, 0x40008
    s_add_u32 s75, s75, s83
    s_cmp_ge_u32 s75, 10
    s_cselect_b32 s73, 10, 0
    s_sub_u32 s75, s75, s73
    s_mul_i32 s63, s75, 245760
    s_add_u32 s63, s63, s5
    s_lshl_b32 s53, s75, 7
    s_add_u32 s53, s53, s4
    s_bfe_u32 s75, s84, 0x4000c
    s_add_u32 s75, s75, s83
    s_cmp_ge_u32 s75, 10
    s_cselect_b32 s73, 10, 0
    s_sub_u32 s75, s75, s73
    s_mul_i32 s64, s75, 245760
    s_add_u32 s64, s64, s5
    s_lshl_b32 s54, s75, 7
    s_add_u32 s54, s54, s4
    s_bfe_u32 s75, s84, 0x40010
    s_add_u32 s75, s75, s83
    s_cmp_ge_u32 s75, 10
    s_cselect_b32 s73, 10, 0
    s_sub_u32 s75, s75, s73
    s_mul_i32 s65, s75, 245760
    s_add_u32 s65, s65, s5
    s_lshl_b32 s55, s75, 7
    s_add_u32 s55, s55, s4
    s_bfe_u32 s75, s84, 0x40014
    s_add_u32 s75, s75, s83
    s_cmp_ge_u32 s75, 10
    s_cselect_b32 s73, 10, 0
    s_sub_u32 s75, s75, s73
    s_mul_i32 s66, s75, 245760
    s_add_u32 s66, s66, s5
    s_lshl_b32 s56, s75, 7
    s_add_u32 s56, s56, s4
    s_bfe_u32 s75, s84, 0x40018
    s_add_u32 s75, s75, s83
    s_cmp_ge_u32 s75, 10
    s_cselect_b32 s73, 10, 0
    s_sub_u32 s75, s75, s73
    s_mul_i32 s67, s75, 245760
    s_add_u32 s67, s67, s5
    s_lshl_b32 s57, s75, 7
    s_add_u32 s57, s57, s4
    s_bfe_u32 s75, s84, 0x4001c
    s_add_u32 s75, s75, s83
    s_cmp_ge_u32 s75, 10
    s_cselect_b32 s73, 10, 0
    s_sub_u32 s75, s75, s73
    s_mul_i32 s68, s75, 245760
    s_add_u32 s68, s68, s5
    s_lshl_b32 s58, s75, 7
    s_add_u32 s58, s58, s4
    s_mov_b32 s75, s85
    s_add_u32 s75, s75, s83
    s_cmp_ge_u32 s75, 10
    s_cselect_b32 s73, 10, 0
    s_sub_u32 s75, s75, s73
    s_mul_i32 s69, s75, 245760
    s_add_u32 s69, s69, s5
    s_lshl_b32 s59, s75, 7
    s_add_u32 s59, s59, s4
    s_mov_b32 s24, s8
    s_mov_b32 s25, s9
    s_mov_b32 s26, 819200
    s_mov_b32 s27, 0x20000
    s_mov_b32 s28, s12
    s_mov_b32 s29, s13
    s_mov_b32 s30, 5242880
    s_mov_b32 s31, 0x20000
    s_getreg_b32 s46, hwreg(HW_REG_XCC_ID, 0, 3)
    s_mul_i32 s93, s42, 160
    v_and_b32 v11, 15, v10
    v_lshrrev_b32 v12, 4, v10
    v_lshrrev_b32 v13, 1, v11
    v_xor_b32 v13, v13, v12
    v_lshlrev_b32 v13, 4, v13
    v_lshl_add_u32 v13, v11, 7, v13
    s_lshl_b32 s3, s44, 12
    v_add_u32 v6, s3, v13
    v_xor_b32 v7, 64, v6
    v_lshrrev_b32 v11, 5, v10
    v_lshlrev_b32 v11, 4, v11
    v_bfe_u32 v13, v10, 2, 3
    v_add_u32 v11, v11, v13
    v_mul_u32_u24 v11, 160, v11
    v_and_b32 v12, 3, v10
    v_lshl_add_u32 v8, v12, 3, v11
    v_add_u32 v8, 80, v8
    v_mad_u32_u24 v9, v12, 40, v11
    v_add_u32 v9, 10272, v9
    s_lshl_b32 s3, s40, 4
    s_add_u32 s3, s3, s41
    s_lshl_b32 s4, s41, 3
    s_lshl_b32 s5, s44, 1
    s_add_u32 s5, s5, s4
    s_mul_i32 s76, s5, 20480
    s_and_b32 s85, s43, 1
    s_add_u32 s5, s4, s43
    s_mul_i32 s99, s5, 40960
    s_sub_u32 s5, s5, s85
    s_mul_i32 s98, s5, 20480
    s_mul_i32 s5, s85, 10240
    s_add_u32 s98, s98, s5
    s_mov_b32 s91, s98
    s_add_u32 s99, s99, s93
    s_lshl_b32 s4, s3, 2
    s_add_u32 s5, s4, s44
    s_lshl_b32 s5, s5, 7
    s_lshl_b32 s6, s42, 3
    s_add_u32 s5, s5, s6
    s_add_u32 s9, s5, 8388612
    s_lshr_b32 s5, s43, 1
    s_add_u32 s5, s5, s4
    s_lshl_b32 s5, s5, 7
    s_add_u32 s5, s5, 8388608
    s_add_u32 s83, s5, 64
    s_lshl_b32 s7, s85, 2
    s_add_u32 s84, s83, s6
    s_add_u32 s84, s84, s7
    s_lshl_b32 s7, s85, 5
    s_add_u32 s8, s5, s7
    s_mov_b32 s94, 0x3fb8aa3b
    s_mov_b32 s95, 0x358637bd
    v_mov_b32 v80, s95
    v_mov_b32 v81, s95
    v_mov_b32 v82, s95
    v_mov_b32 v83, s95
    v_mov_b32 v84, 0
    v_and_b32 v11, 0x1ff, v0
    v_mul_u32_u24 v12, 6554, v11
    v_lshrrev_b32 v12, 16, v12
    v_mul_u32_u24 v13, 10, v12
    v_sub_u32 v11, v11, v13
    v_mul_u32_u24 v12, 1280, v12
    v_lshlrev_b32 v11, 4, v11
    v_add_u32 v90, v11, v12
    s_add_u32 s72, s43, 8
    s_cmp_ge_u32 s72, 10
    s_cselect_b32 s73, 81920, 0
    s_cselect_b32 s74, 10, 0
    s_sub_u32 s72, s72, s74
    s_lshl_b32 s72, s72, 6
    v_add_u32 v11, s72, v10
    v_mul_u32_u24 v12, 6554, v11
    v_lshrrev_b32 v12, 16, v12
    v_mul_u32_u24 v13, 10, v12
    v_sub_u32 v11, v11, v13
    v_mul_u32_u24 v12, 1280, v12
    v_lshlrev_b32 v11, 4, v11
    v_add3_u32 v91, v11, v12, s73
    v_and_b32 v11, 7, v10
    v_lshlrev_b32 v11, 7, v11
    s_mul_i32 s3, s42, 2560
    s_add_u32 s3, s3, 1280
    v_add_u32 v11, s3, v11
    v_bfe_u32 v12, v10, 3, 1
    v_mul_u32_u24 v12, 20480, v12
    v_add_u32 v11, v11, v12
    v_and_b32 v12, 1, v10
    v_lshlrev_b32 v12, 7, v12
    s_add_u32 s3, s3, 1024
    v_add_u32 v12, s3, v12
    v_bfe_u32 v13, v10, 1, 1
    v_mul_u32_u24 v13, 20480, v13
    v_add_u32 v12, v12, v13
    s_mov_b32 vcc_lo, 0xffff
    s_mov_b32 vcc_hi, 0x0
    v_cndmask_b32 v93, v12, v11, vcc
    v_mov_b32 v56, 0
    v_and_b32 v94, 31, v10
    v_lshlrev_b32 v94, 4, v94
    v_lshrrev_b32 v11, 5, v10
    v_lshl_add_u32 v94, v11, 15, v94
    v_mov_b32 v57, 0x3f80
    v_mov_b32 v58, 0x3f800000
    s_mov_b32 vcc_lo, 0xaaaaaaaa
    s_mov_b32 vcc_hi, 0xaaaaaaaa
    v_cndmask_b32 v57, v57, v58, vcc
    s_mov_b32 vcc_lo, 0x3000003
    s_mov_b32 vcc_hi, 0x3000003
    v_cndmask_b32 v16, v56, v57, vcc
    s_mov_b32 vcc_lo, 0xc00000c
    s_mov_b32 vcc_hi, 0xc00000c
    v_cndmask_b32 v17, v56, v57, vcc
    s_mov_b32 vcc_lo, 0x30000030
    s_mov_b32 vcc_hi, 0x30000030
    v_cndmask_b32 v18, v56, v57, vcc
    s_mov_b32 vcc_lo, 0xc00000c0
    s_mov_b32 vcc_hi, 0xc00000c0
    v_cndmask_b32 v19, v56, v57, vcc
    v_mov_b32 v20, s95
    v_mov_b32 v21, s95
    v_mov_b32 v22, 0
    v_mov_b32 v23, 0
    v_and_b32 v24, 15, v10
    v_lshlrev_b32 v24, 1, v24
    v_and_b32 v25, 32, v10
    v_add_u32 v24, v24, v25
    v_bfe_u32 v25, v10, 4, 1
    v_add_u32 v24, v24, v25
    v_lshlrev_b32 v24, 4, v24
    v_xor_b32 v25, 512, v24
    v_mov_b32 v26, 0
    v_mov_b32 v26, 0
    v_mov_b32 v27, 0
    v_lshlrev_b32 v11, 4, v10
    v_add_u32 v11, 148480, v11
    ds_write_b128 v11, v[16:19] offset:0
    ds_write_b128 v11, v[20:23] offset:1024
    ds_write_b128 v11, v[24:27] offset:2048
    s_waitcnt lgkmcnt(0)
    s_add_u32 m0, s71, 37888
    s_nop 0
    buffer_load_dwordx4 v2, s[16:19], s51 offen lds
    s_add_u32 m0, s70, 53248
    s_nop 0
    buffer_load_dwordx4 v3, s[20:23], s61 offen lds
    s_add_u32 m0, s70, 61440
    s_nop 0
    buffer_load_dwordx4 v4, s[20:23], s61 offen lds
    s_waitcnt vmcnt(5)
    s_barrier
    ds_read_b128 v[96:99], v6 offset:0
    ds_read_b128 v[100:103], v6 offset:2048
    ds_read_b64_tr_b16 v[56:57], v8 offset:16384
    ds_read_b64_tr_b16 v[58:59], v8 offset:17664
    ds_read_b64_tr_b16 v[60:61], v8 offset:16424
    ds_read_b64_tr_b16 v[62:63], v8 offset:17704
    ds_read_b64_tr_b16 v[64:65], v8 offset:26624
    ds_read_b64_tr_b16 v[66:67], v8 offset:27904
    ds_read_b64_tr_b16 v[68:69], v8 offset:26664
    ds_read_b64_tr_b16 v[70:71], v8 offset:27944
    ds_read_b64_tr_b16 v[72:73], v9 offset:16384
    ds_read_b64_tr_b16 v[74:75], v9 offset:17664
    s_waitcnt lgkmcnt(8)
    v_mfma_f32_16x16x32_bf16 v[16:19], v[96:99], v[56:59], v[80:83]
    v_mfma_f32_16x16x32_bf16 v[20:23], v[100:103], v[56:59], v[80:83]
    ds_read_b128 v[104:107], v7 offset:0
    ds_read_b128 v[108:111], v7 offset:2048
    ds_read_b64_tr_b16 v[56:57], v8 offset:21504
    ds_read_b64_tr_b16 v[58:59], v8 offset:22784
    s_waitcnt lgkmcnt(10)
    s_add_u32 m0, s71, 73728
    v_mfma_f32_16x16x32_bf16 v[24:27], v[96:99], v[60:63], v[80:83]
    v_mfma_f32_16x16x32_bf16 v[28:31], v[100:103], v[60:63], v[80:83]
    buffer_load_dwordx4 v1, s[16:19], s52 offen lds
    ds_read_b64_tr_b16 v[60:61], v8 offset:21544
    ds_read_b64_tr_b16 v[62:63], v8 offset:22824
    s_waitcnt lgkmcnt(10)
    v_mfma_f32_16x16x32_bf16 v[32:35], v[96:99], v[64:67], 0
    v_mfma_f32_16x16x32_bf16 v[36:39], v[100:103], v[64:67], 0
    ds_read_b64_tr_b16 v[64:65], v8 offset:31744
    ds_read_b64_tr_b16 v[66:67], v8 offset:33024
    s_waitcnt lgkmcnt(10)
    s_add_u32 m0, s71, 74752
    v_mfma_f32_16x16x32_bf16 v[40:43], v[96:99], v[68:71], 0
    v_mfma_f32_16x16x32_bf16 v[44:47], v[100:103], v[68:71], 0
    buffer_load_dwordx4 v2, s[16:19], s52 offen lds
    ds_read_b64_tr_b16 v[68:69], v8 offset:31784
    ds_read_b64_tr_b16 v[70:71], v8 offset:33064
    s_waitcnt lgkmcnt(10)
    v_mfma_f32_16x16x32_bf16 v[48:51], v[96:99], v[72:75], 0
    v_mfma_f32_16x16x32_bf16 v[52:55], v[100:103], v[72:75], 0
    ds_read_b64_tr_b16 v[72:73], v9 offset:21504
    ds_read_b64_tr_b16 v[74:75], v9 offset:22784
    s_waitcnt lgkmcnt(8)
    s_add_u32 m0, s70, 90112
    v_mfma_f32_16x16x32_bf16 v[16:19], v[104:107], v[56:59], v[16:19]
    v_mfma_f32_16x16x32_bf16 v[20:23], v[108:111], v[56:59], v[20:23]
    buffer_load_dwordx4 v3, s[20:23], s62 offen lds
    s_waitcnt lgkmcnt(6)
    v_mfma_f32_16x16x32_bf16 v[24:27], v[104:107], v[60:63], v[24:27]
    v_mfma_f32_16x16x32_bf16 v[28:31], v[108:111], v[60:63], v[28:31]
    s_waitcnt lgkmcnt(4)
    s_add_u32 m0, s70, 98304
    v_mfma_f32_16x16x32_bf16 v[32:35], v[104:107], v[64:67], v[32:35]
    v_mfma_f32_16x16x32_bf16 v[36:39], v[108:111], v[64:67], v[36:39]
    buffer_load_dwordx4 v4, s[20:23], s62 offen lds
    v_add_u32 v6, 36864, v6
    v_add_u32 v7, 36864, v7
    v_add_u32 v8, 36864, v8
    v_add_u32 v9, 36864, v9
    s_waitcnt vmcnt(4)
    s_barrier
    ds_read_b128 v[112:115], v6 offset:0
    ds_read_b128 v[116:119], v6 offset:2048
    ds_read_b64_tr_b16 v[56:57], v8 offset:16384
    ds_read_b64_tr_b16 v[58:59], v8 offset:17664
    ds_read_b64_tr_b16 v[60:61], v8 offset:16424
    ds_read_b64_tr_b16 v[62:63], v8 offset:17704
    ds_read_b64_tr_b16 v[64:65], v8 offset:26624
    ds_read_b64_tr_b16 v[66:67], v8 offset:27904
    s_waitcnt lgkmcnt(10)
    v_mfma_f32_16x16x32_bf16 v[40:43], v[104:107], v[68:71], v[40:43]
    v_mfma_f32_16x16x32_bf16 v[44:47], v[108:111], v[68:71], v[44:47]
    ds_read_b64_tr_b16 v[68:69], v8 offset:26664
    ds_read_b64_tr_b16 v[70:71], v8 offset:27944
    s_waitcnt lgkmcnt(10)
    s_add_u32 m0, s71, 110592
    v_mfma_f32_16x16x32_bf16 v[48:51], v[104:107], v[72:75], v[48:51]
    v_mfma_f32_16x16x32_bf16 v[52:55], v[108:111], v[72:75], v[52:55]
    buffer_load_dwordx4 v1, s[16:19], s53 offen lds
    ds_read_b64_tr_b16 v[72:73], v9 offset:16384
    ds_read_b64_tr_b16 v[74:75], v9 offset:17664
    s_waitcnt lgkmcnt(8)
    v_mfma_f32_16x16x32_bf16 v[16:19], v[112:115], v[56:59], v[16:19]
    v_mfma_f32_16x16x32_bf16 v[20:23], v[116:119], v[56:59], v[20:23]
    ds_read_b128 v[120:123], v7 offset:0
    ds_read_b128 v[124:127], v7 offset:2048
    ds_read_b64_tr_b16 v[56:57], v8 offset:21504
    ds_read_b64_tr_b16 v[58:59], v8 offset:22784
    s_waitcnt lgkmcnt(10)
    s_add_u32 m0, s71, 111616
    v_mfma_f32_16x16x32_bf16 v[24:27], v[112:115], v[60:63], v[24:27]
    v_mfma_f32_16x16x32_bf16 v[28:31], v[116:119], v[60:63], v[28:31]
    buffer_load_dwordx4 v2, s[16:19], s53 offen lds
    ds_read_b64_tr_b16 v[60:61], v8 offset:21544
    ds_read_b64_tr_b16 v[62:63], v8 offset:22824
    s_waitcnt lgkmcnt(10)
    v_mfma_f32_16x16x32_bf16 v[32:35], v[112:115], v[64:67], v[32:35]
    v_mfma_f32_16x16x32_bf16 v[36:39], v[116:119], v[64:67], v[36:39]
    ds_read_b64_tr_b16 v[64:65], v8 offset:31744
    ds_read_b64_tr_b16 v[66:67], v8 offset:33024
    s_waitcnt lgkmcnt(10)
    s_add_u32 m0, s70, 126976
    v_mfma_f32_16x16x32_bf16 v[40:43], v[112:115], v[68:71], v[40:43]
    v_mfma_f32_16x16x32_bf16 v[44:47], v[116:119], v[68:71], v[44:47]
    buffer_load_dwordx4 v3, s[20:23], s63 offen lds
    ds_read_b64_tr_b16 v[68:69], v8 offset:31784
    ds_read_b64_tr_b16 v[70:71], v8 offset:33064
    s_waitcnt lgkmcnt(10)
    v_mfma_f32_16x16x32_bf16 v[48:51], v[112:115], v[72:75], v[48:51]
    v_mfma_f32_16x16x32_bf16 v[52:55], v[116:119], v[72:75], v[52:55]
    ds_read_b64_tr_b16 v[72:73], v9 offset:21504
    ds_read_b64_tr_b16 v[74:75], v9 offset:22784
    s_waitcnt lgkmcnt(8)
    s_add_u32 m0, s70, 135168
    v_mfma_f32_16x16x32_bf16 v[16:19], v[120:123], v[56:59], v[16:19]
    v_mfma_f32_16x16x32_bf16 v[20:23], v[124:127], v[56:59], v[20:23]
    buffer_load_dwordx4 v4, s[20:23], s63 offen lds
    s_waitcnt lgkmcnt(6)
    v_mfma_f32_16x16x32_bf16 v[24:27], v[120:123], v[60:63], v[24:27]
    v_mfma_f32_16x16x32_bf16 v[28:31], v[124:127], v[60:63], v[28:31]
    s_waitcnt lgkmcnt(4)
    v_mfma_f32_16x16x32_bf16 v[32:35], v[120:123], v[64:67], v[32:35]
    v_mfma_f32_16x16x32_bf16 v[36:39], v[124:127], v[64:67], v[36:39]
    v_add_u32 v6, 36864, v6
    v_add_u32 v7, 36864, v7
    v_add_u32 v8, 36864, v8
    v_add_u32 v9, 36864, v9
    s_waitcnt vmcnt(4)
    s_barrier
    ds_read_b128 v[128:131], v6 offset:0
    ds_read_b128 v[132:135], v6 offset:2048
    ds_read_b64_tr_b16 v[56:57], v8 offset:16384
    ds_read_b64_tr_b16 v[58:59], v8 offset:17664
    ds_read_b64_tr_b16 v[60:61], v8 offset:16424
    ds_read_b64_tr_b16 v[62:63], v8 offset:17704
    ds_read_b64_tr_b16 v[64:65], v8 offset:26624
    ds_read_b64_tr_b16 v[66:67], v8 offset:27904
    s_waitcnt lgkmcnt(10)
    v_mfma_f32_16x16x32_bf16 v[40:43], v[120:123], v[68:71], v[40:43]
    v_mfma_f32_16x16x32_bf16 v[44:47], v[124:127], v[68:71], v[44:47]
    ds_read_b64_tr_b16 v[68:69], v8 offset:26664
    ds_read_b64_tr_b16 v[70:71], v8 offset:27944
    s_waitcnt lgkmcnt(10)
    s_add_u32 m0, s71, 0
    v_mfma_f32_16x16x32_bf16 v[48:51], v[120:123], v[72:75], v[48:51]
    v_mfma_f32_16x16x32_bf16 v[52:55], v[124:127], v[72:75], v[52:55]
    buffer_load_dwordx4 v1, s[16:19], s54 offen lds
    ds_read_b64_tr_b16 v[72:73], v9 offset:16384
    ds_read_b64_tr_b16 v[74:75], v9 offset:17664
    s_waitcnt lgkmcnt(8)
    v_mfma_f32_16x16x32_bf16 v[16:19], v[128:131], v[56:59], v[16:19]
    v_mfma_f32_16x16x32_bf16 v[20:23], v[132:135], v[56:59], v[20:23]
    ds_read_b128 v[136:139], v7 offset:0
    ds_read_b128 v[140:143], v7 offset:2048
    ds_read_b64_tr_b16 v[56:57], v8 offset:21504
    ds_read_b64_tr_b16 v[58:59], v8 offset:22784
    s_waitcnt lgkmcnt(10)
    s_add_u32 m0, s71, 1024
    v_mfma_f32_16x16x32_bf16 v[24:27], v[128:131], v[60:63], v[24:27]
    v_mfma_f32_16x16x32_bf16 v[28:31], v[132:135], v[60:63], v[28:31]
    buffer_load_dwordx4 v2, s[16:19], s54 offen lds
    ds_read_b64_tr_b16 v[60:61], v8 offset:21544
    ds_read_b64_tr_b16 v[62:63], v8 offset:22824
    s_waitcnt lgkmcnt(10)
    v_mfma_f32_16x16x32_bf16 v[32:35], v[128:131], v[64:67], v[32:35]
    v_mfma_f32_16x16x32_bf16 v[36:39], v[132:135], v[64:67], v[36:39]
    ds_read_b64_tr_b16 v[64:65], v8 offset:31744
    ds_read_b64_tr_b16 v[66:67], v8 offset:33024
    s_waitcnt lgkmcnt(10)
    s_add_u32 m0, s70, 16384
    v_mfma_f32_16x16x32_bf16 v[40:43], v[128:131], v[68:71], v[40:43]
    v_mfma_f32_16x16x32_bf16 v[44:47], v[132:135], v[68:71], v[44:47]
    buffer_load_dwordx4 v3, s[20:23], s64 offen lds
    ds_read_b64_tr_b16 v[68:69], v8 offset:31784
    ds_read_b64_tr_b16 v[70:71], v8 offset:33064
    s_waitcnt lgkmcnt(10)
    v_mfma_f32_16x16x32_bf16 v[48:51], v[128:131], v[72:75], v[48:51]
    v_mfma_f32_16x16x32_bf16 v[52:55], v[132:135], v[72:75], v[52:55]
    ds_read_b64_tr_b16 v[72:73], v9 offset:21504
    ds_read_b64_tr_b16 v[74:75], v9 offset:22784
    s_waitcnt lgkmcnt(8)
    s_add_u32 m0, s70, 24576
    v_mfma_f32_16x16x32_bf16 v[16:19], v[136:139], v[56:59], v[16:19]
    v_mfma_f32_16x16x32_bf16 v[20:23], v[140:143], v[56:59], v[20:23]
    buffer_load_dwordx4 v4, s[20:23], s64 offen lds
    s_waitcnt lgkmcnt(6)
    v_mfma_f32_16x16x32_bf16 v[24:27], v[136:139], v[60:63], v[24:27]
    v_mfma_f32_16x16x32_bf16 v[28:31], v[140:143], v[60:63], v[28:31]
    s_waitcnt lgkmcnt(4)
    v_mfma_f32_16x16x32_bf16 v[32:35], v[136:139], v[64:67], v[32:35]
    v_mfma_f32_16x16x32_bf16 v[36:39], v[140:143], v[64:67], v[36:39]
    v_add_u32 v6, 36864, v6
    v_add_u32 v7, 36864, v7
    v_add_u32 v8, 36864, v8
    v_add_u32 v9, 36864, v9
    s_waitcnt vmcnt(4)
    s_barrier
    ds_read_b128 v[144:147], v6 offset:0
    ds_read_b128 v[148:151], v6 offset:2048
    ds_read_b64_tr_b16 v[56:57], v8 offset:16384
    ds_read_b64_tr_b16 v[58:59], v8 offset:17664
    ds_read_b64_tr_b16 v[60:61], v8 offset:16424
    ds_read_b64_tr_b16 v[62:63], v8 offset:17704
    ds_read_b64_tr_b16 v[64:65], v8 offset:26624
    ds_read_b64_tr_b16 v[66:67], v8 offset:27904
    s_waitcnt lgkmcnt(10)
    s_add_u32 m0, s71, 36864
    v_mfma_f32_16x16x32_bf16 v[40:43], v[136:139], v[68:71], v[40:43]
    v_mfma_f32_16x16x32_bf16 v[44:47], v[140:143], v[68:71], v[44:47]
    buffer_load_dwordx4 v1, s[16:19], s55 offen lds
    ds_read_b64_tr_b16 v[68:69], v8 offset:26664
    ds_read_b64_tr_b16 v[70:71], v8 offset:27944
    s_waitcnt lgkmcnt(10)
    s_add_u32 m0, s71, 37888
    v_mfma_f32_16x16x32_bf16 v[48:51], v[136:139], v[72:75], v[48:51]
    v_mfma_f32_16x16x32_bf16 v[52:55], v[140:143], v[72:75], v[52:55]
    buffer_load_dwordx4 v2, s[16:19], s55 offen lds
    ds_read_b64_tr_b16 v[72:73], v9 offset:16384
    ds_read_b64_tr_b16 v[74:75], v9 offset:17664
    s_waitcnt lgkmcnt(8)
    s_add_u32 m0, s70, 53248
    v_mfma_f32_16x16x32_bf16 v[16:19], v[144:147], v[56:59], v[16:19]
    v_mfma_f32_16x16x32_bf16 v[20:23], v[148:151], v[56:59], v[20:23]
    buffer_load_dwordx4 v3, s[20:23], s65 offen lds
    ds_read_b128 v[152:155], v7 offset:0
    ds_read_b128 v[156:159], v7 offset:2048
    ds_read_b64_tr_b16 v[56:57], v8 offset:21504
    ds_read_b64_tr_b16 v[58:59], v8 offset:22784
    s_waitcnt lgkmcnt(10)
    s_add_u32 m0, s70, 61440
    v_mfma_f32_16x16x32_bf16 v[24:27], v[144:147], v[60:63], v[24:27]
    v_mfma_f32_16x16x32_bf16 v[28:31], v[148:151], v[60:63], v[28:31]
    buffer_load_dwordx4 v4, s[20:23], s65 offen lds
    ds_read_b64_tr_b16 v[60:61], v8 offset:21544
    ds_read_b64_tr_b16 v[62:63], v8 offset:22824
    s_waitcnt lgkmcnt(10)
    v_mfma_f32_16x16x32_bf16 v[32:35], v[144:147], v[64:67], v[32:35]
    v_mfma_f32_16x16x32_bf16 v[36:39], v[148:151], v[64:67], v[36:39]
    s_lshl_b32 s3, s41, 3
    s_add_u32 s3, s3, s42
    s_mul_i32 s3, s3, 50
    s_mul_i32 s6, s44, 13
    s_add_u32 s3, s3, s6
    v_add_u32 v86, s3, v10
    v_lshlrev_b32 v86, 7, v86
    s_mov_b64 exec, 8191
    buffer_load_dword v95, v86, s[24:27], 0 offen
    s_mov_b64 exec, -1
    ds_read_b64_tr_b16 v[64:65], v8 offset:31744
    ds_read_b64_tr_b16 v[66:67], v8 offset:33024
    s_waitcnt lgkmcnt(10)
    v_mfma_f32_16x16x32_bf16 v[40:43], v[144:147], v[68:71], v[40:43]
    v_mfma_f32_16x16x32_bf16 v[44:47], v[148:151], v[68:71], v[44:47]
    ds_read_b64_tr_b16 v[68:69], v8 offset:31784
    ds_read_b64_tr_b16 v[70:71], v8 offset:33064
    s_waitcnt lgkmcnt(10)
    v_mfma_f32_16x16x32_bf16 v[48:51], v[144:147], v[72:75], v[48:51]
    v_mfma_f32_16x16x32_bf16 v[52:55], v[148:151], v[72:75], v[52:55]
    ds_read_b64_tr_b16 v[72:73], v9 offset:21504
    ds_read_b64_tr_b16 v[74:75], v9 offset:22784
    s_waitcnt lgkmcnt(8)
    v_mfma_f32_16x16x32_bf16 v[16:19], v[152:155], v[56:59], v[16:19]
    v_mfma_f32_16x16x32_bf16 v[20:23], v[156:159], v[56:59], v[20:23]
    s_waitcnt lgkmcnt(6)
    v_mfma_f32_16x16x32_bf16 v[24:27], v[152:155], v[60:63], v[24:27]
    v_mfma_f32_16x16x32_bf16 v[28:31], v[156:159], v[60:63], v[28:31]
    s_waitcnt lgkmcnt(4)
    v_mfma_f32_16x16x32_bf16 v[32:35], v[152:155], v[64:67], v[32:35]
    v_mfma_f32_16x16x32_bf16 v[36:39], v[156:159], v[64:67], v[36:39]
    v_add_u32 v6, -110592, v6
    v_add_u32 v7, -110592, v7
    v_add_u32 v8, -110592, v8
    v_add_u32 v9, -110592, v9
    s_waitcnt vmcnt(5)
    s_barrier
    ds_read_b128 v[160:163], v6 offset:0
    ds_read_b128 v[164:167], v6 offset:2048
    ds_read_b64_tr_b16 v[56:57], v8 offset:16384
    ds_read_b64_tr_b16 v[58:59], v8 offset:17664
    ds_read_b64_tr_b16 v[60:61], v8 offset:16424
    ds_read_b64_tr_b16 v[62:63], v8 offset:17704
    ds_read_b64_tr_b16 v[64:65], v8 offset:26624
    ds_read_b64_tr_b16 v[66:67], v8 offset:27904
    s_waitcnt lgkmcnt(10)
    v_mfma_f32_16x16x32_bf16 v[40:43], v[152:155], v[68:71], v[40:43]
    v_mfma_f32_16x16x32_bf16 v[44:47], v[156:159], v[68:71], v[44:47]
    ds_read_b64_tr_b16 v[68:69], v8 offset:26664
    ds_read_b64_tr_b16 v[70:71], v8 offset:27944
    s_waitcnt lgkmcnt(10)
    s_add_u32 m0, s71, 73728
    v_mfma_f32_16x16x32_bf16 v[48:51], v[152:155], v[72:75], v[48:51]
    v_mfma_f32_16x16x32_bf16 v[52:55], v[156:159], v[72:75], v[52:55]
    buffer_load_dwordx4 v1, s[16:19], s56 offen lds
    ds_read_b64_tr_b16 v[72:73], v9 offset:16384
    ds_read_b64_tr_b16 v[74:75], v9 offset:17664
    s_waitcnt lgkmcnt(8)
    v_mfma_f32_16x16x32_bf16 v[16:19], v[160:163], v[56:59], v[16:19]
    v_mfma_f32_16x16x32_bf16 v[20:23], v[164:167], v[56:59], v[20:23]
    ds_read_b128 v[168:171], v7 offset:0
    ds_read_b128 v[172:175], v7 offset:2048
    ds_read_b64_tr_b16 v[56:57], v8 offset:21504
    ds_read_b64_tr_b16 v[58:59], v8 offset:22784
    s_waitcnt lgkmcnt(10)
    s_add_u32 m0, s71, 74752
    v_mfma_f32_16x16x32_bf16 v[24:27], v[160:163], v[60:63], v[24:27]
    v_mfma_f32_16x16x32_bf16 v[28:31], v[164:167], v[60:63], v[28:31]
    buffer_load_dwordx4 v2, s[16:19], s56 offen lds
    ds_read_b64_tr_b16 v[60:61], v8 offset:21544
    ds_read_b64_tr_b16 v[62:63], v8 offset:22824
    s_waitcnt lgkmcnt(10)
    v_mfma_f32_16x16x32_bf16 v[32:35], v[160:163], v[64:67], v[32:35]
    v_mfma_f32_16x16x32_bf16 v[36:39], v[164:167], v[64:67], v[36:39]
    ds_read_b64_tr_b16 v[64:65], v8 offset:31744
    ds_read_b64_tr_b16 v[66:67], v8 offset:33024
    s_waitcnt lgkmcnt(10)
    s_add_u32 m0, s70, 90112
    v_mfma_f32_16x16x32_bf16 v[40:43], v[160:163], v[68:71], v[40:43]
    v_mfma_f32_16x16x32_bf16 v[44:47], v[164:167], v[68:71], v[44:47]
    buffer_load_dwordx4 v3, s[20:23], s66 offen lds
    ds_read_b64_tr_b16 v[68:69], v8 offset:31784
    ds_read_b64_tr_b16 v[70:71], v8 offset:33064
    s_waitcnt lgkmcnt(10)
    v_mfma_f32_16x16x32_bf16 v[48:51], v[160:163], v[72:75], v[48:51]
    v_mfma_f32_16x16x32_bf16 v[52:55], v[164:167], v[72:75], v[52:55]
    ds_read_b64_tr_b16 v[72:73], v9 offset:21504
    ds_read_b64_tr_b16 v[74:75], v9 offset:22784
    s_waitcnt lgkmcnt(8)
    s_add_u32 m0, s70, 98304
    v_mfma_f32_16x16x32_bf16 v[16:19], v[168:171], v[56:59], v[16:19]
    v_mfma_f32_16x16x32_bf16 v[20:23], v[172:175], v[56:59], v[20:23]
    buffer_load_dwordx4 v4, s[20:23], s66 offen lds
    s_waitcnt lgkmcnt(6)
    v_mfma_f32_16x16x32_bf16 v[24:27], v[168:171], v[60:63], v[24:27]
    v_mfma_f32_16x16x32_bf16 v[28:31], v[172:175], v[60:63], v[28:31]
    s_waitcnt lgkmcnt(4)
    v_mfma_f32_16x16x32_bf16 v[32:35], v[168:171], v[64:67], v[32:35]
    v_mfma_f32_16x16x32_bf16 v[36:39], v[172:175], v[64:67], v[36:39]
    v_add_u32 v6, 36864, v6
    v_add_u32 v7, 36864, v7
    v_add_u32 v8, 36864, v8
    v_add_u32 v9, 36864, v9
    s_waitcnt vmcnt(5)
    s_barrier
    ds_read_b128 v[176:179], v6 offset:0
    ds_read_b128 v[180:183], v6 offset:2048
    ds_read_b64_tr_b16 v[56:57], v8 offset:16384
    ds_read_b64_tr_b16 v[58:59], v8 offset:17664
    ds_read_b64_tr_b16 v[60:61], v8 offset:16424
    ds_read_b64_tr_b16 v[62:63], v8 offset:17704
    ds_read_b64_tr_b16 v[64:65], v8 offset:26624
    ds_read_b64_tr_b16 v[66:67], v8 offset:27904
    s_waitcnt lgkmcnt(10)
    v_mfma_f32_16x16x32_bf16 v[40:43], v[168:171], v[68:71], v[40:43]
    v_mfma_f32_16x16x32_bf16 v[44:47], v[172:175], v[68:71], v[44:47]
    ds_read_b64_tr_b16 v[68:69], v8 offset:26664
    ds_read_b64_tr_b16 v[70:71], v8 offset:27944
    s_waitcnt lgkmcnt(10)
    s_add_u32 m0, s71, 110592
    v_mfma_f32_16x16x32_bf16 v[48:51], v[168:171], v[72:75], v[48:51]
    v_mfma_f32_16x16x32_bf16 v[52:55], v[172:175], v[72:75], v[52:55]
    buffer_load_dwordx4 v1, s[16:19], s57 offen lds
    ds_read_b64_tr_b16 v[72:73], v9 offset:16384
    ds_read_b64_tr_b16 v[74:75], v9 offset:17664
    s_waitcnt lgkmcnt(8)
    v_mfma_f32_16x16x32_bf16 v[16:19], v[176:179], v[56:59], v[16:19]
    v_mfma_f32_16x16x32_bf16 v[20:23], v[180:183], v[56:59], v[20:23]
    ds_read_b128 v[184:187], v7 offset:0
    ds_read_b128 v[188:191], v7 offset:2048
    ds_read_b64_tr_b16 v[56:57], v8 offset:21504
    ds_read_b64_tr_b16 v[58:59], v8 offset:22784
    s_waitcnt lgkmcnt(10)
    s_add_u32 m0, s71, 111616
    v_mfma_f32_16x16x32_bf16 v[24:27], v[176:179], v[60:63], v[24:27]
    v_mfma_f32_16x16x32_bf16 v[28:31], v[180:183], v[60:63], v[28:31]
    buffer_load_dwordx4 v2, s[16:19], s57 offen lds
    ds_read_b64_tr_b16 v[60:61], v8 offset:21544
    ds_read_b64_tr_b16 v[62:63], v8 offset:22824
    s_waitcnt lgkmcnt(10)
    v_mfma_f32_16x16x32_bf16 v[32:35], v[176:179], v[64:67], v[32:35]
    v_mfma_f32_16x16x32_bf16 v[36:39], v[180:183], v[64:67], v[36:39]
    ds_read_b64_tr_b16 v[64:65], v8 offset:31744
    ds_read_b64_tr_b16 v[66:67], v8 offset:33024
    s_waitcnt lgkmcnt(10)
    s_add_u32 m0, s70, 126976
    v_mfma_f32_16x16x32_bf16 v[40:43], v[176:179], v[68:71], v[40:43]
    v_mfma_f32_16x16x32_bf16 v[44:47], v[180:183], v[68:71], v[44:47]
    buffer_load_dwordx4 v3, s[20:23], s67 offen lds
    ds_read_b64_tr_b16 v[68:69], v8 offset:31784
    ds_read_b64_tr_b16 v[70:71], v8 offset:33064
    s_waitcnt lgkmcnt(10)
    v_mfma_f32_16x16x32_bf16 v[48:51], v[176:179], v[72:75], v[48:51]
    v_mfma_f32_16x16x32_bf16 v[52:55], v[180:183], v[72:75], v[52:55]
    ds_read_b64_tr_b16 v[72:73], v9 offset:21504
    ds_read_b64_tr_b16 v[74:75], v9 offset:22784
    s_waitcnt lgkmcnt(8)
    s_add_u32 m0, s70, 135168
    v_mfma_f32_16x16x32_bf16 v[16:19], v[184:187], v[56:59], v[16:19]
    v_mfma_f32_16x16x32_bf16 v[20:23], v[188:191], v[56:59], v[20:23]
    buffer_load_dwordx4 v4, s[20:23], s67 offen lds
    s_waitcnt lgkmcnt(6)
    v_mfma_f32_16x16x32_bf16 v[24:27], v[184:187], v[60:63], v[24:27]
    v_mfma_f32_16x16x32_bf16 v[28:31], v[188:191], v[60:63], v[28:31]
    s_waitcnt lgkmcnt(4)
    v_mfma_f32_16x16x32_bf16 v[32:35], v[184:187], v[64:67], v[32:35]
    v_mfma_f32_16x16x32_bf16 v[36:39], v[188:191], v[64:67], v[36:39]
    v_add_u32 v6, 36864, v6
    v_add_u32 v7, 36864, v7
    v_add_u32 v8, 36864, v8
    v_add_u32 v9, 36864, v9
    s_waitcnt vmcnt(4)
    s_barrier
    ds_read_b128 v[192:195], v6 offset:0
    ds_read_b128 v[196:199], v6 offset:2048
    ds_read_b64_tr_b16 v[56:57], v8 offset:16384
    ds_read_b64_tr_b16 v[58:59], v8 offset:17664
    ds_read_b64_tr_b16 v[60:61], v8 offset:16424
    ds_read_b64_tr_b16 v[62:63], v8 offset:17704
    ds_read_b64_tr_b16 v[64:65], v8 offset:26624
    ds_read_b64_tr_b16 v[66:67], v8 offset:27904
    s_waitcnt lgkmcnt(10)
    v_mfma_f32_16x16x32_bf16 v[40:43], v[184:187], v[68:71], v[40:43]
    v_mfma_f32_16x16x32_bf16 v[44:47], v[188:191], v[68:71], v[44:47]
    ds_read_b64_tr_b16 v[68:69], v8 offset:26664
    ds_read_b64_tr_b16 v[70:71], v8 offset:27944
    s_waitcnt lgkmcnt(10)
    s_add_u32 m0, s71, 0
    v_mfma_f32_16x16x32_bf16 v[48:51], v[184:187], v[72:75], v[48:51]
    v_mfma_f32_16x16x32_bf16 v[52:55], v[188:191], v[72:75], v[52:55]
    buffer_load_dwordx4 v1, s[16:19], s58 offen lds
    ds_read_b64_tr_b16 v[72:73], v9 offset:16384
    ds_read_b64_tr_b16 v[74:75], v9 offset:17664
    s_waitcnt lgkmcnt(8)
    v_mfma_f32_16x16x32_bf16 v[16:19], v[192:195], v[56:59], v[16:19]
    v_mfma_f32_16x16x32_bf16 v[20:23], v[196:199], v[56:59], v[20:23]
    ds_read_b128 v[200:203], v7 offset:0
    ds_read_b128 v[204:207], v7 offset:2048
    ds_read_b64_tr_b16 v[56:57], v8 offset:21504
    ds_read_b64_tr_b16 v[58:59], v8 offset:22784
    s_waitcnt lgkmcnt(10)
    s_add_u32 m0, s71, 1024
    v_mfma_f32_16x16x32_bf16 v[24:27], v[192:195], v[60:63], v[24:27]
    v_mfma_f32_16x16x32_bf16 v[28:31], v[196:199], v[60:63], v[28:31]
    buffer_load_dwordx4 v2, s[16:19], s58 offen lds
    ds_read_b64_tr_b16 v[60:61], v8 offset:21544
    ds_read_b64_tr_b16 v[62:63], v8 offset:22824
    s_waitcnt lgkmcnt(10)
    v_mfma_f32_16x16x32_bf16 v[32:35], v[192:195], v[64:67], v[32:35]
    v_mfma_f32_16x16x32_bf16 v[36:39], v[196:199], v[64:67], v[36:39]
    ds_read_b64_tr_b16 v[64:65], v8 offset:31744
    ds_read_b64_tr_b16 v[66:67], v8 offset:33024
    s_waitcnt lgkmcnt(10)
    s_add_u32 m0, s70, 16384
    v_mfma_f32_16x16x32_bf16 v[40:43], v[192:195], v[68:71], v[40:43]
    v_mfma_f32_16x16x32_bf16 v[44:47], v[196:199], v[68:71], v[44:47]
    buffer_load_dwordx4 v3, s[20:23], s68 offen lds
    ds_read_b64_tr_b16 v[68:69], v8 offset:31784
    ds_read_b64_tr_b16 v[70:71], v8 offset:33064
    s_waitcnt lgkmcnt(10)
    v_mfma_f32_16x16x32_bf16 v[48:51], v[192:195], v[72:75], v[48:51]
    v_mfma_f32_16x16x32_bf16 v[52:55], v[196:199], v[72:75], v[52:55]
    ds_read_b64_tr_b16 v[72:73], v9 offset:21504
    ds_read_b64_tr_b16 v[74:75], v9 offset:22784
    s_waitcnt lgkmcnt(8)
    s_add_u32 m0, s70, 24576
    v_mfma_f32_16x16x32_bf16 v[16:19], v[200:203], v[56:59], v[16:19]
    v_mfma_f32_16x16x32_bf16 v[20:23], v[204:207], v[56:59], v[20:23]
    buffer_load_dwordx4 v4, s[20:23], s68 offen lds
    s_waitcnt lgkmcnt(6)
    v_mfma_f32_16x16x32_bf16 v[24:27], v[200:203], v[60:63], v[24:27]
    v_mfma_f32_16x16x32_bf16 v[28:31], v[204:207], v[60:63], v[28:31]
    s_waitcnt lgkmcnt(4)
    v_mfma_f32_16x16x32_bf16 v[32:35], v[200:203], v[64:67], v[32:35]
    v_mfma_f32_16x16x32_bf16 v[36:39], v[204:207], v[64:67], v[36:39]
    v_add_u32 v6, 36864, v6
    v_add_u32 v7, 36864, v7
    v_add_u32 v8, 36864, v8
    v_add_u32 v9, 36864, v9
    s_waitcnt vmcnt(4)
    s_barrier
    ds_read_b128 v[208:211], v6 offset:0
    ds_read_b128 v[212:215], v6 offset:2048
    ds_read_b64_tr_b16 v[56:57], v8 offset:16384
    ds_read_b64_tr_b16 v[58:59], v8 offset:17664
    ds_read_b64_tr_b16 v[60:61], v8 offset:16424
    ds_read_b64_tr_b16 v[62:63], v8 offset:17704
    ds_read_b64_tr_b16 v[64:65], v8 offset:26624
    ds_read_b64_tr_b16 v[66:67], v8 offset:27904
    s_waitcnt lgkmcnt(10)
    v_mfma_f32_16x16x32_bf16 v[40:43], v[200:203], v[68:71], v[40:43]
    v_mfma_f32_16x16x32_bf16 v[44:47], v[204:207], v[68:71], v[44:47]
    v_mov_b32 v84, 147520
    ds_read_b32 v85, v84
    ds_read_b64_tr_b16 v[68:69], v8 offset:26664
    ds_read_b64_tr_b16 v[70:71], v8 offset:27944
    s_waitcnt lgkmcnt(11)
    s_add_u32 m0, s71, 36864
    v_mfma_f32_16x16x32_bf16 v[48:51], v[200:203], v[72:75], v[48:51]
    v_mfma_f32_16x16x32_bf16 v[52:55], v[204:207], v[72:75], v[52:55]
    buffer_load_dwordx4 v1, s[16:19], s59 offen lds
    ds_read_b64_tr_b16 v[72:73], v9 offset:16384
    ds_read_b64_tr_b16 v[74:75], v9 offset:17664
    s_waitcnt lgkmcnt(9)
    s_add_u32 m0, s71, 37888
    v_mfma_f32_16x16x32_bf16 v[16:19], v[208:211], v[56:59], v[16:19]
    v_mfma_f32_16x16x32_bf16 v[20:23], v[212:215], v[56:59], v[20:23]
    buffer_load_dwordx4 v2, s[16:19], s59 offen lds
    ds_read_b128 v[216:219], v7 offset:0
    ds_read_b128 v[220:223], v7 offset:2048
    ds_read_b64_tr_b16 v[56:57], v8 offset:21504
    ds_read_b64_tr_b16 v[58:59], v8 offset:22784
    s_waitcnt lgkmcnt(11)
    s_add_u32 m0, s70, 53248
    v_mfma_f32_16x16x32_bf16 v[24:27], v[208:211], v[60:63], v[24:27]
    v_mfma_f32_16x16x32_bf16 v[28:31], v[212:215], v[60:63], v[28:31]
    buffer_load_dwordx4 v3, s[20:23], s69 offen lds
    ds_read_b64_tr_b16 v[60:61], v8 offset:21544
    ds_read_b64_tr_b16 v[62:63], v8 offset:22824
    s_waitcnt lgkmcnt(11)
    s_add_u32 m0, s70, 61440
    v_mfma_f32_16x16x32_bf16 v[32:35], v[208:211], v[64:67], v[32:35]
    v_mfma_f32_16x16x32_bf16 v[36:39], v[212:215], v[64:67], v[36:39]
    buffer_load_dwordx4 v4, s[20:23], s69 offen lds
    ds_read_b64_tr_b16 v[64:65], v8 offset:31744
    ds_read_b64_tr_b16 v[66:67], v8 offset:33024
    s_waitcnt lgkmcnt(10)
    v_mfma_f32_16x16x32_bf16 v[40:43], v[208:211], v[68:71], v[40:43]
    v_mfma_f32_16x16x32_bf16 v[44:47], v[212:215], v[68:71], v[44:47]
    v_readfirstlane_b32 s3, v85
    s_nop 0
    s_and_b32 s48, s3, 1
    s_andn2_b32 s47, s3, 7
    ds_read_b64_tr_b16 v[68:69], v8 offset:31784
    ds_read_b64_tr_b16 v[70:71], v8 offset:33064
    s_waitcnt lgkmcnt(10)
    v_mfma_f32_16x16x32_bf16 v[48:51], v[208:211], v[72:75], v[48:51]
    v_mfma_f32_16x16x32_bf16 v[52:55], v[212:215], v[72:75], v[52:55]
    ds_read_b64_tr_b16 v[72:73], v9 offset:21504
    ds_read_b64_tr_b16 v[74:75], v9 offset:22784
    s_waitcnt lgkmcnt(8)
    v_mfma_f32_16x16x32_bf16 v[16:19], v[216:219], v[56:59], v[16:19]
    v_mfma_f32_16x16x32_bf16 v[20:23], v[220:223], v[56:59], v[20:23]
    s_waitcnt lgkmcnt(6)
    v_mfma_f32_16x16x32_bf16 v[24:27], v[216:219], v[60:63], v[24:27]
    v_mfma_f32_16x16x32_bf16 v[28:31], v[220:223], v[60:63], v[28:31]
    s_waitcnt lgkmcnt(4)
    v_mfma_f32_16x16x32_bf16 v[32:35], v[216:219], v[64:67], v[32:35]
    v_mfma_f32_16x16x32_bf16 v[36:39], v[220:223], v[64:67], v[36:39]
    v_add_u32 v6, -110592, v6
    v_add_u32 v7, -110592, v7
    v_add_u32 v8, -110592, v8
    v_add_u32 v9, -110592, v9
    s_waitcnt vmcnt(4)
    s_barrier
    ds_read_b128 v[224:227], v6 offset:0
    ds_read_b128 v[228:231], v6 offset:2048
    ds_read_b64_tr_b16 v[56:57], v8 offset:16384
    ds_read_b64_tr_b16 v[58:59], v8 offset:17664
    ds_read_b64_tr_b16 v[60:61], v8 offset:16424
    ds_read_b64_tr_b16 v[62:63], v8 offset:17704
    ds_read_b64_tr_b16 v[64:65], v8 offset:26624
    ds_read_b64_tr_b16 v[66:67], v8 offset:27904
    s_waitcnt lgkmcnt(10)
    v_mfma_f32_16x16x32_bf16 v[40:43], v[216:219], v[68:71], v[40:43]
    v_mfma_f32_16x16x32_bf16 v[44:47], v[220:223], v[68:71], v[44:47]
    ds_read_b64_tr_b16 v[68:69], v8 offset:26664
    ds_read_b64_tr_b16 v[70:71], v8 offset:27944
    s_waitcnt lgkmcnt(10)
    v_mfma_f32_16x16x32_bf16 v[48:51], v[216:219], v[72:75], v[48:51]
    v_mfma_f32_16x16x32_bf16 v[52:55], v[220:223], v[72:75], v[52:55]
    ds_read_b64_tr_b16 v[72:73], v9 offset:16384
    ds_read_b64_tr_b16 v[74:75], v9 offset:17664
    s_waitcnt lgkmcnt(8)
    v_mfma_f32_16x16x32_bf16 v[16:19], v[224:227], v[56:59], v[16:19]
    v_mfma_f32_16x16x32_bf16 v[20:23], v[228:231], v[56:59], v[20:23]
    v_subrev_u32 v4, 1280, v4
    ds_read_b128 v[232:235], v7 offset:0
    ds_read_b128 v[236:239], v7 offset:2048
    ds_read_b64_tr_b16 v[56:57], v8 offset:21504
    ds_read_b64_tr_b16 v[58:59], v8 offset:22784
    s_waitcnt lgkmcnt(10)
    v_mfma_f32_16x16x32_bf16 v[24:27], v[224:227], v[60:63], v[24:27]
    v_mfma_f32_16x16x32_bf16 v[28:31], v[228:231], v[60:63], v[28:31]
    ds_read_b64_tr_b16 v[60:61], v8 offset:21544
    ds_read_b64_tr_b16 v[62:63], v8 offset:22824
    s_waitcnt lgkmcnt(10)
    v_mfma_f32_16x16x32_bf16 v[32:35], v[224:227], v[64:67], v[32:35]
    v_mfma_f32_16x16x32_bf16 v[36:39], v[228:231], v[64:67], v[36:39]
    ds_read_b64_tr_b16 v[64:65], v8 offset:31744
    ds_read_b64_tr_b16 v[66:67], v8 offset:33024
    s_waitcnt lgkmcnt(10)
    s_sub_u32 s75, s60, 1280
    s_add_u32 m0, s70, 81920
    v_mfma_f32_16x16x32_bf16 v[40:43], v[224:227], v[68:71], v[40:43]
    v_mfma_f32_16x16x32_bf16 v[44:47], v[228:231], v[68:71], v[44:47]
    buffer_load_dwordx4 v3, s[20:23], s75 offen lds
    ds_read_b64_tr_b16 v[68:69], v8 offset:31784
    ds_read_b64_tr_b16 v[70:71], v8 offset:33064
    s_waitcnt lgkmcnt(10)
    v_mfma_f32_16x16x32_bf16 v[48:51], v[224:227], v[72:75], v[48:51]
    v_mfma_f32_16x16x32_bf16 v[52:55], v[228:231], v[72:75], v[52:55]
    ds_read_b64_tr_b16 v[72:73], v9 offset:21504
    ds_read_b64_tr_b16 v[74:75], v9 offset:22784
    s_waitcnt lgkmcnt(8)
    v_mfma_f32_16x16x32_bf16 v[16:19], v[232:235], v[56:59], v[16:19]
    v_mfma_f32_16x16x32_bf16 v[20:23], v[236:239], v[56:59], v[20:23]
    s_waitcnt lgkmcnt(6)
    s_sub_u32 s75, s61, 1280
    s_add_u32 m0, s70, 90112
    v_mfma_f32_16x16x32_bf16 v[24:27], v[232:235], v[60:63], v[24:27]
    v_mfma_f32_16x16x32_bf16 v[28:31], v[236:239], v[60:63], v[28:31]
    buffer_load_dwordx4 v4, s[20:23], s75 offen lds
    s_waitcnt lgkmcnt(4)
    v_mfma_f32_16x16x32_bf16 v[32:35], v[232:235], v[64:67], v[32:35]
    v_mfma_f32_16x16x32_bf16 v[36:39], v[236:239], v[64:67], v[36:39]
    v_add_u32 v6, 36864, v6
    v_add_u32 v7, 36864, v7
    v_add_u32 v8, 36864, v8
    v_add_u32 v9, 36864, v9
    s_waitcnt vmcnt(2) lgkmcnt(0)
    s_barrier
    ds_read_b128 v[240:243], v6 offset:0
    ds_read_b128 v[244:247], v6 offset:2048
    ds_read_b64_tr_b16 v[56:57], v8 offset:16384
    ds_read_b64_tr_b16 v[58:59], v8 offset:17664
    ds_read_b64_tr_b16 v[60:61], v9 offset:16384
    ds_read_b64_tr_b16 v[62:63], v9 offset:17664
    ds_read_b64_tr_b16 v[64:65], v8 offset:16424
    ds_read_b64_tr_b16 v[66:67], v8 offset:17704
    v_mfma_f32_16x16x32_bf16 v[40:43], v[232:235], v[68:71], v[40:43]
    v_mfma_f32_16x16x32_bf16 v[44:47], v[236:239], v[68:71], v[44:47]
    ds_read_b128 v[248:251], v7 offset:0
    ds_read_b128 v[252:255], v7 offset:2048
    ds_read_b64_tr_b16 v[68:69], v8 offset:21504
    ds_read_b64_tr_b16 v[70:71], v8 offset:22784
    s_sub_u32 s75, s62, 1280
    s_add_u32 m0, s70, 102400
    v_mfma_f32_16x16x32_bf16 v[48:51], v[232:235], v[72:75], v[48:51]
    v_mfma_f32_16x16x32_bf16 v[52:55], v[236:239], v[72:75], v[52:55]
    buffer_load_dwordx4 v3, s[20:23], s75 offen lds
    ds_read_b64_tr_b16 v[72:73], v9 offset:21504
    ds_read_b64_tr_b16 v[74:75], v9 offset:22784
    s_waitcnt lgkmcnt(10)
    v_mfma_f32_16x16x32_bf16 v[16:19], v[240:243], v[56:59], v[16:19]
    v_mfma_f32_16x16x32_bf16 v[20:23], v[244:247], v[56:59], v[20:23]
    ds_read_b64_tr_b16 v[56:57], v8 offset:21544
    ds_read_b64_tr_b16 v[58:59], v8 offset:22824
    s_waitcnt lgkmcnt(10)
    s_sub_u32 s75, s63, 1280
    s_add_u32 m0, s70, 110592
    v_mfma_f32_16x16x32_bf16 v[48:51], v[240:243], v[60:63], v[48:51]
    v_mfma_f32_16x16x32_bf16 v[52:55], v[244:247], v[60:63], v[52:55]
    buffer_load_dwordx4 v4, s[20:23], s75 offen lds
    ds_read_b64_tr_b16 v[60:61], v8 offset:26624
    ds_read_b64_tr_b16 v[62:63], v8 offset:27904
    s_waitcnt lgkmcnt(10)
    v_mfma_f32_16x16x32_bf16 v[24:27], v[240:243], v[64:67], v[24:27]
    v_mfma_f32_16x16x32_bf16 v[28:31], v[244:247], v[64:67], v[28:31]
    ds_read_b64_tr_b16 v[64:65], v8 offset:26664
    ds_read_b64_tr_b16 v[66:67], v8 offset:27944
    s_waitcnt lgkmcnt(8)
    s_sub_u32 s75, s64, 1280
    s_add_u32 m0, s70, 122880
    v_mfma_f32_16x16x32_bf16 v[16:19], v[248:251], v[68:71], v[16:19]
    v_mfma_f32_16x16x32_bf16 v[20:23], v[252:255], v[68:71], v[20:23]
    buffer_load_dwordx4 v3, s[20:23], s75 offen lds
    ds_read_b64_tr_b16 v[68:69], v8 offset:31744
    ds_read_b64_tr_b16 v[70:71], v8 offset:33024
    s_waitcnt lgkmcnt(8)
    v_mfma_f32_16x16x32_bf16 v[48:51], v[248:251], v[72:75], v[48:51]
    v_mfma_f32_16x16x32_bf16 v[52:55], v[252:255], v[72:75], v[52:55]
    ds_read_b64_tr_b16 v[72:73], v8 offset:31784
    ds_read_b64_tr_b16 v[74:75], v8 offset:33064
    s_waitcnt lgkmcnt(8)
    s_sub_u32 s75, s65, 1280
    s_add_u32 m0, s70, 131072
    v_mfma_f32_16x16x32_bf16 v[24:27], v[248:251], v[56:59], v[24:27]
    v_mfma_f32_16x16x32_bf16 v[28:31], v[252:255], v[56:59], v[28:31]
    buffer_load_dwordx4 v4, s[20:23], s75 offen lds
    s_waitcnt lgkmcnt(6)
    v_mfma_f32_16x16x32_bf16 v[32:35], v[240:243], v[60:63], v[32:35]
    v_mfma_f32_16x16x32_bf16 v[36:39], v[244:247], v[60:63], v[36:39]
    s_waitcnt lgkmcnt(4)
    v_mfma_f32_16x16x32_bf16 v[40:43], v[240:243], v[64:67], v[40:43]
    v_mfma_f32_16x16x32_bf16 v[44:47], v[244:247], v[64:67], v[44:47]
    s_waitcnt lgkmcnt(2)
    v_mfma_f32_16x16x32_bf16 v[32:35], v[248:251], v[68:71], v[32:35]
    v_mfma_f32_16x16x32_bf16 v[36:39], v[252:255], v[68:71], v[36:39]
    s_waitcnt lgkmcnt(0)
    v_mfma_f32_16x16x32_bf16 v[40:43], v[248:251], v[72:75], v[40:43]
    v_mfma_f32_16x16x32_bf16 v[44:47], v[252:255], v[72:75], v[44:47]
    v_lshlrev_b32 v6, 4, v10
    v_lshlrev_b32 v7, 3, v10
    v_add_u32 v8, 45056, v8
    v_add_u32 v9, 34816, v9
    s_lshl_b32 s3, s43, 12
    v_add_u32 v11, s3, v6
    v_add_u32 v12, s70, v6
    v_add_u32 v12, 154624, v12
    v_mul_f32 v76, s94, v16
    v_mul_f32 v77, s94, v17
    v_mul_f32 v78, s94, v18
    v_mul_f32 v79, s94, v19
    v_mul_f32 v80, s94, v20
    v_mul_f32 v81, s94, v21
    v_mul_f32 v82, s94, v22
    v_mul_f32 v83, s94, v23
    v_exp_f32_e64 v76, v76 clamp
    v_max_f32 v16, s95, v16
    v_exp_f32_e64 v77, v77 clamp
    v_max_f32 v17, s95, v17
    v_exp_f32_e64 v78, v78 clamp
    v_max_f32 v18, s95, v18
    v_exp_f32_e64 v79, v79 clamp
    v_max_f32 v19, s95, v19
    v_exp_f32_e64 v80, v80 clamp
    v_max_f32 v20, s95, v20
    v_exp_f32_e64 v81, v81 clamp
    v_max_f32 v21, s95, v21
    v_exp_f32_e64 v82, v82 clamp
    v_max_f32 v22, s95, v22
    v_exp_f32_e64 v83, v83 clamp
    v_max_f32 v23, s95, v23
    v_add_f32 v16, v16, v76
    v_add_f32 v17, v17, v77
    v_add_f32 v18, v18, v78
    v_add_f32 v19, v19, v79
    v_add_f32 v20, v20, v80
    v_add_f32 v21, v21, v81
    v_add_f32 v22, v22, v82
    v_add_f32 v23, v23, v83
    v_cvt_pk_bf16_f32 v56, v16, v17
    v_cvt_pk_bf16_f32 v57, v18, v19
    v_cvt_pk_bf16_f32 v58, v20, v21
    v_cvt_pk_bf16_f32 v59, v22, v23
    ds_write_b128 v11, v[56:59] offset:0
    v_cvt_pk_bf16_f32 v72, v48, v49
    v_cvt_pk_bf16_f32 v73, v50, v51
    v_cvt_pk_bf16_f32 v74, v52, v53
    v_cvt_pk_bf16_f32 v75, v54, v55
    ds_write_b128 v12, v[72:75]
    v_mul_f32 v76, s94, v24
    v_mul_f32 v77, s94, v25
    v_mul_f32 v78, s94, v26
    v_mul_f32 v79, s94, v27
    v_mul_f32 v80, s94, v28
    v_mul_f32 v81, s94, v29
    v_mul_f32 v82, s94, v30
    v_mul_f32 v83, s94, v31
    v_exp_f32_e64 v76, v76 clamp
    v_max_f32 v24, s95, v24
    v_exp_f32_e64 v77, v77 clamp
    v_max_f32 v25, s95, v25
    v_exp_f32_e64 v78, v78 clamp
    v_max_f32 v26, s95, v26
    v_exp_f32_e64 v79, v79 clamp
    v_max_f32 v27, s95, v27
    v_exp_f32_e64 v80, v80 clamp
    v_max_f32 v28, s95, v28
    v_exp_f32_e64 v81, v81 clamp
    v_max_f32 v29, s95, v29
    v_exp_f32_e64 v82, v82 clamp
    v_max_f32 v30, s95, v30
    v_exp_f32_e64 v83, v83 clamp
    v_max_f32 v31, s95, v31
    v_add_f32 v24, v24, v76
    v_add_f32 v25, v25, v77
    v_add_f32 v26, v26, v78
    v_add_f32 v27, v27, v79
    v_add_f32 v28, v28, v80
    v_add_f32 v29, v29, v81
    v_add_f32 v30, v30, v82
    v_add_f32 v31, v31, v83
    v_cvt_pk_bf16_f32 v60, v24, v25
    v_cvt_pk_bf16_f32 v61, v26, v27
    v_cvt_pk_bf16_f32 v62, v28, v29
    v_cvt_pk_bf16_f32 v63, v30, v31
    ds_write_b128 v11, v[60:63] offset:1024
    v_cvt_pk_bf16_f32 v64, v32, v33
    v_cvt_pk_bf16_f32 v65, v34, v35
    v_cvt_pk_bf16_f32 v66, v36, v37
    v_cvt_pk_bf16_f32 v67, v38, v39
    ds_write_b128 v11, v[64:67] offset:2048
    v_cvt_pk_bf16_f32 v68, v40, v41
    v_cvt_pk_bf16_f32 v69, v42, v43
    v_cvt_pk_bf16_f32 v70, v44, v45
    v_cvt_pk_bf16_f32 v71, v46, v47
    ds_write_b128 v11, v[68:71] offset:3072
    v_add_u32 v11, 16384, v6
    v_add_u32 v12, 154624, v6
    v_and_b32 v13, 0x31, v10
    v_bfe_u32 v14, v10, 2, 2
    v_lshl_add_u32 v13, v14, 1, v13
    v_lshlrev_b32 v13, 4, v13
    v_add_u32 v13, 158848, v13
    v_mov_b32 v89, 0x3f803f80
    v_mov_b32 v80, s95
    v_mov_b32 v81, s95
    v_mov_b32 v82, s95
    v_mov_b32 v83, s95
    s_waitcnt vmcnt(4) lgkmcnt(0)
    s_barrier
    s_cmp_lt_u32 s86, 2
    s_cbranch_scc0 L_t23_01
    s_lshl_b32 s3, s86, 10
    v_add_u32 v11, s3, v11
    ds_read_b128 v[16:19], v11 offset:0
    ds_read_b128 v[20:23], v11 offset:2048
    ds_read_b128 v[24:27], v11 offset:4096
    ds_read_b128 v[28:31], v11 offset:6144
    ds_read_b128 v[32:35], v11 offset:8192
    ds_read_b128 v[36:39], v11 offset:10240
    ds_read_b128 v[40:43], v11 offset:12288
    ds_read_b128 v[44:47], v11 offset:14336
    s_waitcnt lgkmcnt(6)
    v_mfma_f32_16x16x32_bf16 v[84:87], v[16:19], v[20:23], 0
    s_waitcnt lgkmcnt(4)
    v_mfma_f32_16x16x32_bf16 v[84:87], v[24:27], v[28:31], v[84:87]
    s_waitcnt lgkmcnt(2)
    v_mfma_f32_16x16x32_bf16 v[84:87], v[32:35], v[36:39], v[84:87]
    s_waitcnt lgkmcnt(0)
    v_mfma_f32_16x16x32_bf16 v[84:87], v[40:43], v[44:47], v[84:87]
    s_nop 7
    s_branch L_tdone_01
L_t23_01:
    s_mov_b32 vcc_lo, 0x33333333
    s_mov_b32 vcc_hi, 0x33333333
    s_cmp_eq_u32 s86, 2
    s_cbranch_scc0 L_t3_01
    ds_read_b128 v[16:19], v13 offset:0
    ds_read_b128 v[20:23], v11 offset:0
    ds_read_b128 v[24:27], v11 offset:1024
    ds_read_b128 v[28:31], v13 offset:1024
    ds_read_b128 v[32:35], v11 offset:4096
    ds_read_b128 v[36:39], v11 offset:5120
    ds_read_b128 v[40:43], v13 offset:2048
    ds_read_b128 v[44:47], v11 offset:8192
    ds_read_b128 v[48:51], v11 offset:9216
    ds_read_b128 v[52:55], v13 offset:3072
    ds_read_b128 v[56:59], v11 offset:12288
    ds_read_b128 v[60:63], v11 offset:13312
    s_waitcnt lgkmcnt(9)
    v_cndmask_b32 v16, v16, v89, vcc
    v_cndmask_b32 v17, v17, v89, vcc
    v_cndmask_b32 v18, v18, v89, vcc
    v_cndmask_b32 v19, v19, v89, vcc
    s_nop 1
    v_mfma_f32_16x16x32_bf16 v[84:87], v[20:23], v[16:19], 0
    v_mfma_f32_16x16x32_bf16 v[72:75], v[24:27], v[16:19], 0
    s_waitcnt lgkmcnt(6)
    v_cndmask_b32 v28, v28, v89, vcc
    v_cndmask_b32 v29, v29, v89, vcc
    v_cndmask_b32 v30, v30, v89, vcc
    v_cndmask_b32 v31, v31, v89, vcc
    s_nop 1
    v_mfma_f32_16x16x32_bf16 v[84:87], v[32:35], v[28:31], v[84:87]
    v_mfma_f32_16x16x32_bf16 v[72:75], v[36:39], v[28:31], v[72:75]
    s_waitcnt lgkmcnt(3)
    v_cndmask_b32 v40, v40, v89, vcc
    v_cndmask_b32 v41, v41, v89, vcc
    v_cndmask_b32 v42, v42, v89, vcc
    v_cndmask_b32 v43, v43, v89, vcc
    s_nop 1
    v_mfma_f32_16x16x32_bf16 v[84:87], v[44:47], v[40:43], v[84:87]
    v_mfma_f32_16x16x32_bf16 v[72:75], v[48:51], v[40:43], v[72:75]
    s_waitcnt lgkmcnt(0)
    v_cndmask_b32 v52, v52, v89, vcc
    v_cndmask_b32 v53, v53, v89, vcc
    v_cndmask_b32 v54, v54, v89, vcc
    v_cndmask_b32 v55, v55, v89, vcc
    s_nop 1
    v_mfma_f32_16x16x32_bf16 v[84:87], v[56:59], v[52:55], v[84:87]
    v_mfma_f32_16x16x32_bf16 v[72:75], v[60:63], v[52:55], v[72:75]
    s_mov_b32 vcc_lo, 0x11dd11dd
    s_mov_b32 vcc_hi, 0x11dd11dd
    s_nop 5
    v_cndmask_b32 v84, v72, v84, vcc
    v_cndmask_b32 v85, v73, v85, vcc
    v_cndmask_b32 v86, v74, v86, vcc
    v_cndmask_b32 v87, v75, v87, vcc
    s_branch L_tdone_01
L_t3_01:
    ds_read_b128 v[16:19], v13 offset:0
    ds_read_b128 v[20:23], v12 offset:0
    ds_read_b128 v[24:27], v11 offset:2048
    ds_read_b128 v[28:31], v11 offset:3072
    ds_read_b128 v[32:35], v13 offset:1024
    ds_read_b128 v[36:39], v12 offset:1024
    ds_read_b128 v[40:43], v11 offset:6144
    ds_read_b128 v[44:47], v11 offset:7168
    ds_read_b128 v[48:51], v13 offset:2048
    ds_read_b128 v[52:55], v12 offset:2048
    ds_read_b128 v[56:59], v11 offset:10240
    ds_read_b128 v[60:63], v11 offset:11264
    s_waitcnt lgkmcnt(8)
    v_cndmask_b32 v16, v16, v89, vcc
    v_cndmask_b32 v17, v17, v89, vcc
    v_cndmask_b32 v18, v18, v89, vcc
    v_cndmask_b32 v19, v19, v89, vcc
    v_mfma_f32_16x16x32_bf16 v[84:87], v[20:23], v[24:27], 0
    v_mfma_f32_16x16x32_bf16 v[72:75], v[20:23], v[28:31], 0
    v_mfma_f32_16x16x32_bf16 v[76:79], v[20:23], v[16:19], 0
    ds_read_b128 v[16:19], v13 offset:3072
    ds_read_b128 v[20:23], v12 offset:3072
    ds_read_b128 v[24:27], v11 offset:14336
    ds_read_b128 v[28:31], v11 offset:15360
    s_waitcnt lgkmcnt(8)
    v_cndmask_b32 v32, v32, v89, vcc
    v_cndmask_b32 v33, v33, v89, vcc
    v_cndmask_b32 v34, v34, v89, vcc
    v_cndmask_b32 v35, v35, v89, vcc
    v_mfma_f32_16x16x32_bf16 v[84:87], v[36:39], v[40:43], v[84:87]
    v_mfma_f32_16x16x32_bf16 v[72:75], v[36:39], v[44:47], v[72:75]
    v_mfma_f32_16x16x32_bf16 v[76:79], v[36:39], v[32:35], v[76:79]
    s_waitcnt lgkmcnt(4)
    v_cndmask_b32 v48, v48, v89, vcc
    v_cndmask_b32 v49, v49, v89, vcc
    v_cndmask_b32 v50, v50, v89, vcc
    v_cndmask_b32 v51, v51, v89, vcc
    v_mfma_f32_16x16x32_bf16 v[84:87], v[52:55], v[56:59], v[84:87]
    v_mfma_f32_16x16x32_bf16 v[72:75], v[52:55], v[60:63], v[72:75]
    v_mfma_f32_16x16x32_bf16 v[76:79], v[52:55], v[48:51], v[76:79]
    s_waitcnt lgkmcnt(0)
    v_cndmask_b32 v16, v16, v89, vcc
    v_cndmask_b32 v17, v17, v89, vcc
    v_cndmask_b32 v18, v18, v89, vcc
    v_cndmask_b32 v19, v19, v89, vcc
    v_mfma_f32_16x16x32_bf16 v[84:87], v[20:23], v[24:27], v[84:87]
    v_mfma_f32_16x16x32_bf16 v[72:75], v[20:23], v[28:31], v[72:75]
    v_mfma_f32_16x16x32_bf16 v[76:79], v[20:23], v[16:19], v[76:79]
    s_mov_b32 vcc_lo, 0x0
    s_mov_b32 vcc_hi, 0xffff
    s_nop 4
    v_cndmask_b32 v84, v72, v84, vcc
    v_cndmask_b32 v85, v73, v85, vcc
    v_cndmask_b32 v86, v74, v86, vcc
    v_cndmask_b32 v87, v75, v87, vcc
    v_permlane32_swap_b32 v76, v84
    v_permlane32_swap_b32 v77, v85
    v_permlane32_swap_b32 v78, v86
    v_permlane32_swap_b32 v79, v87
L_tdone_01:
    v_cvt_pk_bf16_f32 v88, v84, v85
    v_cvt_pk_bf16_f32 v89, v86, v87
    v_min_u32 v84, -2, v88
    v_min_u32 v85, -2, v89
    buffer_store_dwordx2 v[84:85], v7, s[32:35], s77 offen sc1
    ds_read_b64_tr_b16 v[40:41], v8 offset:0
    ds_read_b64_tr_b16 v[42:43], v8 offset:1280
    ds_read_b64_tr_b16 v[44:45], v8 offset:40
    ds_read_b64_tr_b16 v[46:47], v8 offset:1320
    ds_read_b64_tr_b16 v[48:49], v8 offset:5120
    ds_read_b64_tr_b16 v[50:51], v8 offset:6400
    ds_read_b64_tr_b16 v[52:53], v8 offset:5160
    ds_read_b64_tr_b16 v[54:55], v8 offset:6440
    ds_read_b64_tr_b16 v[32:33], v8 offset:10240
    ds_read_b64_tr_b16 v[34:35], v8 offset:11520
    ds_read_b64_tr_b16 v[36:37], v8 offset:10280
    ds_read_b64_tr_b16 v[38:39], v8 offset:11560
    s_waitcnt lgkmcnt(10)
    v_mfma_f32_16x16x32_bf16 v[16:19], v[40:43], v[96:99], v[80:83]
    v_mfma_f32_16x16x32_bf16 v[20:23], v[40:43], v[100:103], v[80:83]
    ds_read_b64_tr_b16 v[40:41], v8 offset:15360
    ds_read_b64_tr_b16 v[42:43], v8 offset:16640
    s_waitcnt lgkmcnt(10)
    v_mfma_f32_16x16x32_bf16 v[24:27], v[44:47], v[96:99], v[80:83]
    v_mfma_f32_16x16x32_bf16 v[28:31], v[44:47], v[100:103], v[80:83]
    ds_read_b64_tr_b16 v[44:45], v8 offset:15400
    ds_read_b64_tr_b16 v[46:47], v8 offset:16680
    s_waitcnt lgkmcnt(10)
    v_mfma_f32_16x16x32_bf16 v[16:19], v[48:51], v[104:107], v[16:19]
    v_mfma_f32_16x16x32_bf16 v[20:23], v[48:51], v[108:111], v[20:23]
    s_waitcnt lgkmcnt(8)
    v_mfma_f32_16x16x32_bf16 v[24:27], v[52:55], v[104:107], v[24:27]
    v_mfma_f32_16x16x32_bf16 v[28:31], v[52:55], v[108:111], v[28:31]
    s_waitcnt lgkmcnt(6)
    v_mfma_f32_16x16x32_bf16 v[16:19], v[32:35], v[112:115], v[16:19]
    v_mfma_f32_16x16x32_bf16 v[20:23], v[32:35], v[116:119], v[20:23]
    v_add_u32 v8, 20480, v8
    v_add_u32 v9, 20480, v9
    s_waitcnt vmcnt(1) lgkmcnt(0)
    s_barrier
    ds_read_b64_tr_b16 v[48:49], v8 offset:0
    ds_read_b64_tr_b16 v[50:51], v8 offset:1280
    ds_read_b64_tr_b16 v[52:53], v8 offset:40
    ds_read_b64_tr_b16 v[54:55], v8 offset:1320
    ds_read_b64_tr_b16 v[32:33], v8 offset:5120
    ds_read_b64_tr_b16 v[34:35], v8 offset:6400
    s_sub_u32 s75, s66, 1280
    s_add_u32 m0, s70, 0
    v_mfma_f32_16x16x32_bf16 v[24:27], v[36:39], v[112:115], v[24:27]
    v_mfma_f32_16x16x32_bf16 v[28:31], v[36:39], v[116:119], v[28:31]
    buffer_load_dwordx4 v3, s[20:23], s75 offen lds
    ds_read_b64_tr_b16 v[36:37], v8 offset:5160
    ds_read_b64_tr_b16 v[38:39], v8 offset:6440
    s_sub_u32 s75, s67, 1280
    s_add_u32 m0, s70, 8192
    v_mfma_f32_16x16x32_bf16 v[16:19], v[40:43], v[120:123], v[16:19]
    v_mfma_f32_16x16x32_bf16 v[20:23], v[40:43], v[124:127], v[20:23]
    buffer_load_dwordx4 v4, s[20:23], s75 offen lds
    ds_read_b64_tr_b16 v[40:41], v8 offset:10240
    ds_read_b64_tr_b16 v[42:43], v8 offset:11520
    s_sub_u32 s75, s68, 1280
    s_add_u32 m0, s70, 20480
    v_mfma_f32_16x16x32_bf16 v[24:27], v[44:47], v[120:123], v[24:27]
    v_mfma_f32_16x16x32_bf16 v[28:31], v[44:47], v[124:127], v[28:31]
    buffer_load_dwordx4 v3, s[20:23], s75 offen lds
    ds_read_b64_tr_b16 v[44:45], v8 offset:10280
    ds_read_b64_tr_b16 v[46:47], v8 offset:11560
    s_waitcnt lgkmcnt(10)
    s_sub_u32 s75, s69, 1280
    s_add_u32 m0, s70, 28672
    v_mfma_f32_16x16x32_bf16 v[16:19], v[48:51], v[128:131], v[16:19]
    v_mfma_f32_16x16x32_bf16 v[20:23], v[48:51], v[132:135], v[20:23]
    buffer_load_dwordx4 v4, s[20:23], s75 offen lds
    ds_read_b64_tr_b16 v[48:49], v8 offset:15360
    ds_read_b64_tr_b16 v[50:51], v8 offset:16640
    s_waitcnt lgkmcnt(10)
    v_mfma_f32_16x16x32_bf16 v[24:27], v[52:55], v[128:131], v[24:27]
    v_mfma_f32_16x16x32_bf16 v[28:31], v[52:55], v[132:135], v[28:31]
    s_mov_b64 exec, 0xfffff
    buffer_load_dword v95, v93, s[32:35], s76 offen
    s_mov_b64 exec, 1
    buffer_load_dword v95, off, s[32:35], s8
    s_mov_b64 exec, -1
    v_add_u32 v126, 148480, v6
    ds_read_b128 v[96:99], v126 offset:0
    ds_read_b128 v[100:103], v126 offset:1024
    ds_read_b128 v[104:107], v126 offset:2048
    ds_read_b64_tr_b16 v[52:53], v8 offset:15400
    ds_read_b64_tr_b16 v[54:55], v8 offset:16680
    s_waitcnt lgkmcnt(13)
    v_mfma_f32_16x16x32_bf16 v[16:19], v[32:35], v[136:139], v[16:19]
    v_mfma_f32_16x16x32_bf16 v[20:23], v[32:35], v[140:143], v[20:23]
    s_lshl_b32 s4, s44, 10
    v_add_u32 v124, s4, v7
    s_waitcnt lgkmcnt(11)
    v_mfma_f32_16x16x32_bf16 v[24:27], v[36:39], v[136:139], v[24:27]
    v_mfma_f32_16x16x32_bf16 v[28:31], v[36:39], v[140:143], v[28:31]
    s_waitcnt lgkmcnt(9)
    v_mfma_f32_16x16x32_bf16 v[16:19], v[40:43], v[144:147], v[16:19]
    v_mfma_f32_16x16x32_bf16 v[20:23], v[40:43], v[148:151], v[20:23]
    v_add_u32 v8, 20480, v8
    v_add_u32 v9, 20480, v9
    ds_read_b64_tr_b16 v[32:33], v8 offset:0
    ds_read_b64_tr_b16 v[34:35], v8 offset:1280
    ds_read_b64_tr_b16 v[36:37], v8 offset:40
    ds_read_b64_tr_b16 v[38:39], v8 offset:1320
    ds_read_b64_tr_b16 v[40:41], v8 offset:5120
    ds_read_b64_tr_b16 v[42:43], v8 offset:6400
    s_waitcnt lgkmcnt(13)
    v_mfma_f32_16x16x32_bf16 v[24:27], v[44:47], v[144:147], v[24:27]
    v_mfma_f32_16x16x32_bf16 v[28:31], v[44:47], v[148:151], v[28:31]
    ds_read_b64_tr_b16 v[44:45], v8 offset:5160
    ds_read_b64_tr_b16 v[46:47], v8 offset:6440
    s_waitcnt lgkmcnt(13)
    v_mfma_f32_16x16x32_bf16 v[16:19], v[48:51], v[152:155], v[16:19]
    v_mfma_f32_16x16x32_bf16 v[20:23], v[48:51], v[156:159], v[20:23]
    ds_read_b64_tr_b16 v[48:49], v8 offset:10240
    ds_read_b64_tr_b16 v[50:51], v8 offset:11520
    s_waitcnt lgkmcnt(10)
    s_add_u32 s75, s93, 0
    s_add_u32 m0, s70, 61440
    v_mfma_f32_16x16x32_bf16 v[24:27], v[52:55], v[152:155], v[24:27]
    v_mfma_f32_16x16x32_bf16 v[28:31], v[52:55], v[156:159], v[28:31]
    buffer_load_dwordx4 v90, s[24:27], s75 offen lds
    s_waitcnt lgkmcnt(0)
    v_mov_b32 v126, v104
    v_mov_b32 v127, v105
    ds_read_b64_tr_b16 v[52:53], v8 offset:10280
    ds_read_b64_tr_b16 v[54:55], v8 offset:11560
    v_mfma_f32_16x16x32_bf16 v[16:19], v[32:35], v[160:163], v[16:19]
    v_mfma_f32_16x16x32_bf16 v[20:23], v[32:35], v[164:167], v[20:23]
    ds_read_b64_tr_b16 v[32:33], v8 offset:15360
    ds_read_b64_tr_b16 v[34:35], v8 offset:16640
    ds_read_b64_tr_b16 v[128:129], v8 offset:15400
    ds_read_b64_tr_b16 v[130:131], v8 offset:16680
    v_mfma_f32_16x16x32_bf16 v[24:27], v[36:39], v[160:163], v[24:27]
    v_mfma_f32_16x16x32_bf16 v[28:31], v[36:39], v[164:167], v[28:31]
    s_add_u32 s75, s93, 0
    s_add_u32 m0, s70, 69632
    v_mfma_f32_16x16x32_bf16 v[16:19], v[40:43], v[168:171], v[16:19]
    v_mfma_f32_16x16x32_bf16 v[20:23], v[40:43], v[172:175], v[20:23]
    buffer_load_dwordx4 v91, s[24:27], s75 offen lds
    v_mfma_f32_16x16x32_bf16 v[24:27], v[44:47], v[168:171], v[24:27]
    v_mfma_f32_16x16x32_bf16 v[28:31], v[44:47], v[172:175], v[28:31]
    v_mfma_f32_16x16x32_bf16 v[16:19], v[48:51], v[176:179], v[16:19]
    v_mfma_f32_16x16x32_bf16 v[20:23], v[48:51], v[180:183], v[20:23]
    v_add_u32 v8, -122880, v8
    v_add_u32 v9, -122880, v9
    s_waitcnt vmcnt(4) lgkmcnt(0)
    s_barrier
    ds_read_b64_tr_b16 v[132:133], v8 offset:0
    ds_read_b64_tr_b16 v[134:135], v8 offset:1280
    ds_read_b64_tr_b16 v[136:137], v8 offset:40
    ds_read_b64_tr_b16 v[138:139], v8 offset:1320
    ds_read_b64_tr_b16 v[140:141], v8 offset:5120
    ds_read_b64_tr_b16 v[142:143], v8 offset:6400
    ds_read_b64_tr_b16 v[144:145], v8 offset:5160
    ds_read_b64_tr_b16 v[146:147], v8 offset:6440
    ds_read_b64_tr_b16 v[148:149], v8 offset:10240
    ds_read_b64_tr_b16 v[150:151], v8 offset:11520
    ds_read_b64_tr_b16 v[152:153], v8 offset:10280
    ds_read_b64_tr_b16 v[154:155], v8 offset:11560
    s_add_u32 s3, s78, 0
    v_mfma_f32_16x16x32_bf16 v[24:27], v[52:55], v[176:179], v[24:27]
    v_mfma_f32_16x16x32_bf16 v[28:31], v[52:55], v[180:183], v[28:31]
    buffer_load_dwordx4 v[56:59], v94, s[32:35], s3 offen sc1
    ds_read_b64_tr_b16 v[36:37], v8 offset:15360
    ds_read_b64_tr_b16 v[38:39], v8 offset:16640
    s_add_u32 s3, s78, 4096
    v_mfma_f32_16x16x32_bf16 v[16:19], v[32:35], v[184:187], v[16:19]
    v_mfma_f32_16x16x32_bf16 v[20:23], v[32:35], v[188:191], v[20:23]
    buffer_load_dwordx4 v[60:63], v94, s[32:35], s3 offen sc1
    ds_read_b64_tr_b16 v[40:41], v8 offset:15400
    s_waitcnt lgkmcnt(12)
    ds_read_b64_tr_b16 v[42:43], v8 offset:16680
    s_add_u32 s3, s78, 8192
    v_mfma_f32_16x16x32_bf16 v[24:27], v[128:131], v[184:187], v[24:27]
    v_mfma_f32_16x16x32_bf16 v[28:31], v[128:131], v[188:191], v[28:31]
    buffer_load_dwordx4 v[64:67], v94, s[32:35], s3 offen sc1
    s_add_u32 s3, s78, 12288
    v_mfma_f32_16x16x32_bf16 v[16:19], v[132:135], v[192:195], v[16:19]
    v_mfma_f32_16x16x32_bf16 v[20:23], v[132:135], v[196:199], v[20:23]
    buffer_load_dwordx4 v[68:71], v94, s[32:35], s3 offen sc1
    s_waitcnt lgkmcnt(12)
    v_mfma_f32_16x16x32_bf16 v[24:27], v[136:139], v[192:195], v[24:27]
    v_mfma_f32_16x16x32_bf16 v[28:31], v[136:139], v[196:199], v[28:31]
    s_waitcnt lgkmcnt(10)
    v_mfma_f32_16x16x32_bf16 v[16:19], v[140:143], v[200:203], v[16:19]
    v_mfma_f32_16x16x32_bf16 v[20:23], v[140:143], v[204:207], v[20:23]
    s_waitcnt lgkmcnt(8)
    v_mfma_f32_16x16x32_bf16 v[24:27], v[144:147], v[200:203], v[24:27]
    v_mfma_f32_16x16x32_bf16 v[28:31], v[144:147], v[204:207], v[28:31]
    s_waitcnt lgkmcnt(6)
    v_mfma_f32_16x16x32_bf16 v[16:19], v[148:151], v[208:211], v[16:19]
    v_mfma_f32_16x16x32_bf16 v[20:23], v[148:151], v[212:215], v[20:23]
    v_add_u32 v8, 20480, v8
    v_add_u32 v9, 20480, v9
    ds_read_b64_tr_b16 v[44:45], v8 offset:0
    ds_read_b64_tr_b16 v[46:47], v8 offset:1280
    ds_read_b64_tr_b16 v[48:49], v8 offset:5120
    ds_read_b64_tr_b16 v[50:51], v8 offset:6400
    ds_read_b64_tr_b16 v[52:53], v8 offset:10240
    ds_read_b64_tr_b16 v[54:55], v8 offset:11520
    ds_read_b64_tr_b16 v[32:33], v8 offset:15360
    ds_read_b64_tr_b16 v[34:35], v8 offset:16640
    ds_read_b64_tr_b16 v[128:129], v8 offset:40
    s_waitcnt lgkmcnt(12)
    ds_read_b64_tr_b16 v[130:131], v8 offset:1320
    ds_read_b64_tr_b16 v[132:133], v8 offset:5160
    ds_read_b64_tr_b16 v[134:135], v8 offset:6440
    s_add_u32 s3, s78, 16384
    v_mfma_f32_16x16x32_bf16 v[24:27], v[152:155], v[208:211], v[24:27]
    v_mfma_f32_16x16x32_bf16 v[28:31], v[152:155], v[212:215], v[28:31]
    buffer_load_dwordx4 v[72:75], v94, s[32:35], s3 offen sc1
    s_waitcnt lgkmcnt(12)
    ds_read_b64_tr_b16 v[136:137], v8 offset:10280
    ds_read_b64_tr_b16 v[138:139], v8 offset:11560
    s_add_u32 s3, s78, 20480
    v_mfma_f32_16x16x32_bf16 v[16:19], v[36:39], v[216:219], v[16:19]
    v_mfma_f32_16x16x32_bf16 v[20:23], v[36:39], v[220:223], v[20:23]
    buffer_load_dwordx4 v[76:79], v94, s[32:35], s3 offen sc1
    ds_read_b64_tr_b16 v[140:141], v8 offset:15400
    s_waitcnt lgkmcnt(12)
    ds_read_b64_tr_b16 v[142:143], v8 offset:16680
    s_add_u32 s3, s78, 24576
    v_mfma_f32_16x16x32_bf16 v[24:27], v[40:43], v[216:219], v[24:27]
    v_mfma_f32_16x16x32_bf16 v[28:31], v[40:43], v[220:223], v[28:31]
    buffer_load_dwordx4 v[80:83], v94, s[32:35], s3 offen sc1
    s_add_u32 s3, s78, 28672
    v_mfma_f32_16x16x32_bf16 v[16:19], v[44:47], v[224:227], v[16:19]
    v_mfma_f32_16x16x32_bf16 v[20:23], v[44:47], v[228:231], v[20:23]
    buffer_load_dwordx4 v[84:87], v94, s[32:35], s3 offen sc1
    s_waitcnt lgkmcnt(12)
    s_add_u32 s75, s93, 163840
    s_add_u32 m0, s70, 81920
    v_mfma_f32_16x16x32_bf16 v[16:19], v[48:51], v[232:235], v[16:19]
    v_mfma_f32_16x16x32_bf16 v[20:23], v[48:51], v[236:239], v[20:23]
    buffer_load_dwordx4 v90, s[24:27], s75 offen lds
    s_waitcnt lgkmcnt(10)
    s_add_u32 s75, s93, 163840
    s_add_u32 m0, s70, 90112
    v_mfma_f32_16x16x32_bf16 v[16:19], v[52:55], v[240:243], v[16:19]
    v_mfma_f32_16x16x32_bf16 v[20:23], v[52:55], v[244:247], v[20:23]
    buffer_load_dwordx4 v91, s[24:27], s75 offen lds
    s_waitcnt vmcnt(2)
    v_mfma_f32_16x16x32_bf16 v[108:111], v[96:99], v[56:59], 0
    v_mfma_f32_16x16x32_bf16 v[108:111], v[96:99], v[60:63], v[108:111]
    v_mfma_f32_16x16x32_bf16 v[108:111], v[96:99], v[64:67], v[108:111]
    v_mfma_f32_16x16x32_bf16 v[108:111], v[96:99], v[68:71], v[108:111]
    v_mfma_f32_16x16x32_bf16 v[108:111], v[96:99], v[72:75], v[108:111]
    v_mfma_f32_16x16x32_bf16 v[108:111], v[96:99], v[76:79], v[108:111]
    v_mfma_f32_16x16x32_bf16 v[108:111], v[96:99], v[80:83], v[108:111]
    v_mfma_f32_16x16x32_bf16 v[108:111], v[96:99], v[84:87], v[108:111]
    s_waitcnt lgkmcnt(8)
    v_mfma_f32_16x16x32_bf16 v[16:19], v[32:35], v[248:251], v[16:19]
    v_mfma_f32_16x16x32_bf16 v[20:23], v[32:35], v[252:255], v[20:23]
    s_waitcnt lgkmcnt(6)
    v_mfma_f32_16x16x32_bf16 v[24:27], v[128:131], v[224:227], v[24:27]
    v_mfma_f32_16x16x32_bf16 v[28:31], v[128:131], v[228:231], v[28:31]
    s_nop 3
    v_mul_f32 v112, s94, v16
    v_mul_f32 v113, s94, v17
    v_mul_f32 v114, s94, v18
    v_mul_f32 v115, s94, v19
    s_waitcnt lgkmcnt(4)
    v_mfma_f32_16x16x32_bf16 v[24:27], v[132:135], v[232:235], v[24:27]
    v_mfma_f32_16x16x32_bf16 v[28:31], v[132:135], v[236:239], v[28:31]
    v_mul_f32 v116, s94, v20
    v_mul_f32 v117, s94, v21
    v_mul_f32 v118, s94, v22
    v_mul_f32 v119, s94, v23
    s_waitcnt lgkmcnt(2)
    v_mfma_f32_16x16x32_bf16 v[24:27], v[136:139], v[240:243], v[24:27]
    v_mfma_f32_16x16x32_bf16 v[28:31], v[136:139], v[244:247], v[28:31]
    v_exp_f32_e64 v112, v112 clamp
    v_max_f32 v16, s95, v16
    v_exp_f32_e64 v113, v113 clamp
    v_max_f32 v17, s95, v17
    s_waitcnt lgkmcnt(0)
    v_mfma_f32_16x16x32_bf16 v[24:27], v[140:143], v[248:251], v[24:27]
    v_mfma_f32_16x16x32_bf16 v[28:31], v[140:143], v[252:255], v[28:31]
    v_exp_f32_e64 v114, v114 clamp
    v_max_f32 v18, s95, v18
    v_exp_f32_e64 v115, v115 clamp
    v_max_f32 v19, s95, v19
    v_exp_f32_e64 v116, v116 clamp
    v_max_f32 v20, s95, v20
    v_exp_f32_e64 v117, v117 clamp
    v_max_f32 v21, s95, v21
    v_exp_f32_e64 v118, v118 clamp
    v_max_f32 v22, s95, v22
    v_exp_f32_e64 v119, v119 clamp
    v_max_f32 v23, s95, v23
    v_add_f32 v16, v16, v112
    v_add_f32 v17, v17, v113
    v_add_f32 v18, v18, v114
    v_add_f32 v19, v19, v115
    v_add_f32 v20, v20, v116
    v_add_f32 v21, v21, v117
    v_add_f32 v22, v22, v118
    v_add_f32 v23, v23, v119
    v_cvt_pk_bf16_f32 v160, v16, v17
    v_cvt_pk_bf16_f32 v161, v18, v19
    v_cvt_pk_bf16_f32 v168, v20, v21
    v_cvt_pk_bf16_f32 v169, v22, v23
    v_add_f32 v88, v108, v109
    v_add_f32 v89, v110, v111
    v_add_f32 v88, v88, v89
    v_cmp_u_f32 vcc, v88, v88
    s_cbranch_vccz L_gok_01
    s_mov_b32 s92, 0
L_gsp_01:
    v_max3_u32 v88, v56, v57, v58
    v_max3_u32 v88, v88, v59, v60
    v_max3_u32 v88, v88, v61, v62
    v_max3_u32 v88, v88, v63, v64
    v_max3_u32 v88, v88, v65, v66
    v_max3_u32 v88, v88, v67, v68
    v_max3_u32 v88, v88, v69, v70
    v_max3_u32 v88, v88, v71, v72
    v_max3_u32 v88, v88, v73, v74
    v_max3_u32 v88, v88, v75, v76
    v_max3_u32 v88, v88, v77, v78
    v_max3_u32 v88, v88, v79, v80
    v_max3_u32 v88, v88, v81, v82
    v_max3_u32 v88, v88, v83, v84
    v_max3_u32 v88, v88, v85, v86
    v_max_u32 v88, v88, v87
    v_cmp_eq_u32 vcc, -1, v88
    s_cbranch_vccz L_gre_01
    s_add_u32 s3, s78, 0
    buffer_load_dwordx4 v[56:59], v94, s[32:35], s3 offen sc1
    s_add_u32 s3, s78, 4096
    buffer_load_dwordx4 v[60:63], v94, s[32:35], s3 offen sc1
    s_add_u32 s3, s78, 8192
    buffer_load_dwordx4 v[64:67], v94, s[32:35], s3 offen sc1
    s_add_u32 s3, s78, 12288
    buffer_load_dwordx4 v[68:71], v94, s[32:35], s3 offen sc1
    s_add_u32 s3, s78, 16384
    buffer_load_dwordx4 v[72:75], v94, s[32:35], s3 offen sc1
    s_add_u32 s3, s78, 20480
    buffer_load_dwordx4 v[76:79], v94, s[32:35], s3 offen sc1
    s_add_u32 s3, s78, 24576
    buffer_load_dwordx4 v[80:83], v94, s[32:35], s3 offen sc1
    s_add_u32 s3, s78, 28672
    buffer_load_dwordx4 v[84:87], v94, s[32:35], s3 offen sc1
    s_waitcnt vmcnt(0)
    s_add_u32 s92, s92, 1
    s_cmp_lt_u32 s92, 200000
    s_cbranch_scc1 L_gsp_01
L_gre_01:
    v_mfma_f32_16x16x32_bf16 v[108:111], v[96:99], v[56:59], 0
    v_mfma_f32_16x16x32_bf16 v[108:111], v[96:99], v[60:63], v[108:111]
    v_mfma_f32_16x16x32_bf16 v[108:111], v[96:99], v[64:67], v[108:111]
    v_mfma_f32_16x16x32_bf16 v[108:111], v[96:99], v[68:71], v[108:111]
    v_mfma_f32_16x16x32_bf16 v[108:111], v[96:99], v[72:75], v[108:111]
    v_mfma_f32_16x16x32_bf16 v[108:111], v[96:99], v[76:79], v[108:111]
    v_mfma_f32_16x16x32_bf16 v[108:111], v[96:99], v[80:83], v[108:111]
    v_mfma_f32_16x16x32_bf16 v[108:111], v[96:99], v[84:87], v[108:111]
    s_nop 7
L_gok_01:
    v_cvt_pk_bf16_f32 v88, v108, v109
    v_cvt_pk_bf16_f32 v89, v110, v111
    s_cmp_lt_u32 s86, 2
    s_cbranch_scc0 L_w23_01
    s_lshl_b32 s4, s86, 10
    v_add_u32 v108, s4, v126
    ds_write_b64 v108, v[88:89] offset:45056
    s_branch L_wd_01
L_w23_01:
    s_cmp_eq_u32 s86, 2
    s_cbranch_scc0 L_w3_01
    s_mov_b32 vcc_lo, 0xa0a5f5f
    s_mov_b32 vcc_hi, 0xa0a5f5f
    v_cndmask_b32 v108, v106, v88, vcc
    v_cndmask_b32 v109, v106, v89, vcc
    ds_write_b64 v126, v[108:109] offset:47104
    s_mov_b32 vcc_lo, 0xf5f5a0a0
    s_mov_b32 vcc_hi, 0xf5f5a0a0
    v_cndmask_b32 v110, v106, v88, vcc
    v_cndmask_b32 v111, v106, v89, vcc
    ds_write_b64 v126, v[110:111] offset:48128
    s_branch L_wd_01
L_w3_01:
    s_mov_b32 vcc_lo, 0xf50aa05f
    s_mov_b32 vcc_hi, 0x0
    v_cndmask_b32 v108, v106, v88, vcc
    v_cndmask_b32 v109, v106, v89, vcc
    ds_write_b64 v127, v[108:109] offset:47112
    s_mov_b32 vcc_lo, 0x0
    s_mov_b32 vcc_hi, 0xff00ff
    v_cndmask_b32 v110, v106, v88, vcc
    v_cndmask_b32 v111, v106, v89, vcc
    ds_write_b64 v126, v[110:111] offset:45064
    s_mov_b32 vcc_lo, 0x0
    s_mov_b32 vcc_hi, 0xff00ff00
    v_cndmask_b32 v108, v106, v88, vcc
    v_cndmask_b32 v109, v106, v89, vcc
    ds_write_b64 v126, v[108:109] offset:46088
L_wd_01:
    s_add_u32 s75, s93, 327680
    s_add_u32 m0, s70, 102400
    s_nop 0
    buffer_load_dwordx4 v90, s[24:27], s75 offen lds
    s_add_u32 s75, s93, 327680
    s_add_u32 m0, s70, 110592
    s_nop 0
    buffer_load_dwordx4 v91, s[24:27], s75 offen lds
    s_add_u32 s75, s93, 491520
    s_add_u32 m0, s70, 122880
    s_nop 0
    buffer_load_dwordx4 v90, s[24:27], s75 offen lds
    v_mul_f32 v136, s94, v24
    v_mul_f32 v137, s94, v25
    v_mul_f32 v138, s94, v26
    v_mul_f32 v139, s94, v27
    v_mul_f32 v140, s94, v28
    v_mul_f32 v141, s94, v29
    v_mul_f32 v142, s94, v30
    v_mul_f32 v143, s94, v31
    v_exp_f32_e64 v136, v136 clamp
    v_max_f32 v24, s95, v24
    v_exp_f32_e64 v137, v137 clamp
    v_max_f32 v25, s95, v25
    v_exp_f32_e64 v138, v138 clamp
    v_max_f32 v26, s95, v26
    v_exp_f32_e64 v139, v139 clamp
    v_max_f32 v27, s95, v27
    v_exp_f32_e64 v140, v140 clamp
    v_max_f32 v28, s95, v28
    v_exp_f32_e64 v141, v141 clamp
    v_max_f32 v29, s95, v29
    v_exp_f32_e64 v142, v142 clamp
    v_max_f32 v30, s95, v30
    v_exp_f32_e64 v143, v143 clamp
    v_max_f32 v31, s95, v31
    v_add_f32 v24, v24, v136
    v_add_f32 v25, v25, v137
    v_add_f32 v26, v26, v138
    v_add_f32 v27, v27, v139
    v_add_f32 v28, v28, v140
    v_add_f32 v29, v29, v141
    v_add_f32 v30, v30, v142
    v_add_f32 v31, v31, v143
    v_cvt_pk_bf16_f32 v164, v24, v25
    v_cvt_pk_bf16_f32 v165, v26, v27
    v_cvt_pk_bf16_f32 v172, v28, v29
    v_cvt_pk_bf16_f32 v173, v30, v31
    s_add_u32 s75, s93, 491520
    s_add_u32 m0, s70, 131072
    s_nop 0
    buffer_load_dwordx4 v91, s[24:27], s75 offen lds
    s_add_u32 s75, s93, 655360
    s_add_u32 m0, s70, 143360
    s_nop 0
    buffer_load_dwordx4 v90, s[24:27], s75 offen lds
    s_add_u32 s75, s93, 655360
    s_add_u32 m0, s70, 151552
    s_nop 0
    buffer_load_dwordx4 v91, s[24:27], s75 offen lds
    s_waitcnt lgkmcnt(0)
    s_barrier
    ds_read_b64 v[162:163], v124 offset:49152
    ds_read_b64 v[166:167], v124 offset:49152
    ds_read_b64 v[170:171], v124 offset:49664
    ds_read_b64 v[174:175], v124 offset:49664
    ds_read_b128 v[136:139], v6 offset:47104
    ds_read_b128 v[128:131], v6 offset:45056
    ds_read_b64 v[104:105], v6 offset:48128
    ds_read_b128 v[132:135], v6 offset:46080
    s_waitcnt lgkmcnt(3)
    v_mfma_f32_16x16x32_bf16 v[28:31], v[136:139], v[168:171], v[100:103]
    v_mfma_f32_16x16x32_bf16 v[16:19], v[136:139], v[160:163], v[100:103]
    s_waitcnt lgkmcnt(2)
    v_mfma_f32_16x16x32_bf16 v[32:35], v[128:131], v[168:171], 0
    v_mfma_f32_16x16x32_bf16 v[20:23], v[128:131], v[160:163], 0
    s_waitcnt lgkmcnt(1)
    v_mfma_f32_16x16x32_bf16 v[28:31], v[104:107], v[172:175], v[28:31]
    v_mfma_f32_16x16x32_bf16 v[16:19], v[104:107], v[164:167], v[16:19]
    s_waitcnt lgkmcnt(0)
    v_mfma_f32_16x16x32_bf16 v[36:39], v[132:135], v[172:175], 0
    v_mfma_f32_16x16x32_bf16 v[24:27], v[132:135], v[164:167], 0
    s_mov_b32 vcc_lo, 0xffffffff
    s_mov_b32 vcc_hi, 0x0
    s_nop 1
    v_rcp_f32 v28, v28
    v_rcp_f32 v29, v29
    v_rcp_f32 v16, v16
    v_rcp_f32 v17, v17
    v_mul_f32 v32, v32, v28
    v_mul_f32 v33, v33, v28
    v_mul_f32 v34, v34, v28
    v_mul_f32 v35, v35, v28
    v_mul_f32 v36, v36, v29
    v_mul_f32 v37, v37, v29
    v_mul_f32 v38, v38, v29
    v_mul_f32 v39, v39, v29
    v_cndmask_b32 v28, v29, v28, vcc
    v_cvt_pk_bf16_f32 v180, v32, v33
    v_cvt_pk_bf16_f32 v181, v34, v35
    v_cvt_pk_bf16_f32 v182, v36, v37
    v_cvt_pk_bf16_f32 v183, v38, v39
    v_mul_f32 v30, v30, v28
    v_mul_f32 v31, v31, v28
    v_cvt_pk_bf16_f32 v186, v30, v31
    v_mul_f32 v20, v20, v16
    v_mul_f32 v21, v21, v16
    v_mul_f32 v22, v22, v16
    v_mul_f32 v23, v23, v16
    v_mul_f32 v24, v24, v17
    v_mul_f32 v25, v25, v17
    v_mul_f32 v26, v26, v17
    v_mul_f32 v27, v27, v17
    v_cndmask_b32 v16, v17, v16, vcc
    v_cvt_pk_bf16_f32 v176, v20, v21
    v_cvt_pk_bf16_f32 v177, v22, v23
    v_cvt_pk_bf16_f32 v178, v24, v25
    v_cvt_pk_bf16_f32 v179, v26, v27
    v_mul_f32 v18, v18, v16
    v_mul_f32 v19, v19, v16
    v_cvt_pk_bf16_f32 v184, v18, v19
    s_mul_i32 s3, s42, 2560
    s_add_u32 s3, s3, s76
    s_add_u32 s3, s3, 1280
    s_add_u32 s4, s3, 20480
    s_lshr_b32 s5, s42, 1
    s_mul_i32 s5, s5, 5120
    s_and_b32 s6, s42, 1
    s_lshl_b32 s6, s6, 3
    s_add_u32 s5, s5, s6
    s_add_u32 s5, s5, s76
    s_add_u32 s6, s5, 20480
    v_lshrrev_b32 v14, 4, v10
    v_mul_u32_u24 v14, 1024, v14
    v_add_u32 v14, v14, v6
    v_mov_b32 v11, s47
    s_cmp_eq_u32 s48, 1
    s_cbranch_scc1 L_fast_01
    buffer_store_dwordx4 v[176:179], v6, s[32:35], s3 offen sc1
    buffer_store_dwordx4 v[180:183], v6, s[32:35], s4 offen sc1
    buffer_store_dword v184, v14, s[32:35], s5 offen offset:1028 sc1
    buffer_store_dword v186, v14, s[32:35], s6 offen offset:1028 sc1
    s_branch L_pubd_01
L_fast_01:
    buffer_store_dwordx4 v[176:179], v6, s[32:35], s3 offen nt
    buffer_store_dwordx4 v[180:183], v6, s[32:35], s4 offen nt
    buffer_store_dword v184, v14, s[32:35], s5 offen offset:1028 nt
    buffer_store_dword v186, v14, s[32:35], s6 offen offset:1028 nt
L_pubd_01:
    s_mov_b64 exec, -1
    s_mul_i32 s7, s85, 51200
    s_add_u32 s7, s7, 61440
    v_and_b32 v0, 3, v10
    v_lshrrev_b32 v1, 2, v10
    v_mul_u32_u24 v1, 160, v1
    v_lshl_add_u32 v1, v0, 3, v1
    v_add_u32 v1, s7, v1
    v_bfe_u32 v2, v10, 3, 1
    v_mul_u32_u24 v2, 40, v2
    v_lshrrev_b32 v3, 5, v10
    v_mad_u32_u24 v2, v3, 20, v2
    v_bfe_u32 v3, v10, 4, 1
    v_lshl_add_u32 v2, v3, 1, v2
    v_bfe_u32 v3, v10, 2, 1
    v_add_u32 v2, v2, v3
    v_mul_u32_u24 v2, 160, v2
    v_lshl_add_u32 v2, v0, 3, v2
    v_add_u32 v2, s7, v2
    v_lshlrev_b32 v3, 2, v10
    s_mul_i32 s7, s43, 5120
    v_add_u32 v7, s7, v6
    s_xor_b32 s7, s43, 1
    s_mul_i32 s7, s7, 5120
    v_add_u32 v4, s7, v6
    s_waitcnt vmcnt(4) lgkmcnt(0)
    s_branch L_phase2
L_phase2:
    s_barrier
    ds_read_b64_tr_b16 v[56:57], v1 offset:0
    ds_read_b64_tr_b16 v[58:59], v1 offset:3200
    ds_read_b64_tr_b16 v[60:61], v1 offset:32
    ds_read_b64_tr_b16 v[62:63], v1 offset:3232
    ds_read_b64_tr_b16 v[64:65], v1 offset:64
    ds_read_b64_tr_b16 v[66:67], v1 offset:3264
    ds_read_b64_tr_b16 v[68:69], v1 offset:96
    ds_read_b64_tr_b16 v[70:71], v1 offset:3296
    ds_read_b64_tr_b16 v[72:73], v1 offset:128
    ds_read_b64_tr_b16 v[74:75], v1 offset:3328
    ds_read_b64_tr_b16 v[76:77], v1 offset:6400
    ds_read_b64_tr_b16 v[78:79], v1 offset:9600
    v_mov_b32 v94, s47
    s_cmp_eq_u32 s48, 1
    s_mov_b64 exec, 1
    s_waitcnt vmcnt(0)
    s_cbranch_scc1 L_fl1
    buffer_store_dword v94, off, s[32:35], s9 sc1
    s_branch L_fl2
L_fl1:
    buffer_store_dword v94, off, s[32:35], s9
L_fl2:
    s_mov_b64 exec, -1
    s_mov_b64 exec, 0xff
    buffer_load_dword v0, v3, s[32:35], s8 offen sc1
    s_mov_b64 exec, -1
    ds_read_b64_tr_b16 v[80:81], v1 offset:6432
    ds_read_b64_tr_b16 v[82:83], v1 offset:9632
    ds_read_b64_tr_b16 v[84:85], v1 offset:6464
    s_waitcnt lgkmcnt(12)
    ds_read_b64_tr_b16 v[86:87], v1 offset:9664
    ds_read_b64_tr_b16 v[88:89], v1 offset:6496
    ds_read_b64_tr_b16 v[90:91], v1 offset:9696
    s_waitcnt lgkmcnt(12)
    ds_read_b64_tr_b16 v[96:97], v1 offset:6528
    ds_read_b64_tr_b16 v[98:99], v1 offset:9728
    ds_read_b64_tr_b16 v[100:101], v1 offset:12800
    s_waitcnt lgkmcnt(12)
    ds_read_b64_tr_b16 v[102:103], v1 offset:16000
    ds_read_b64_tr_b16 v[104:105], v1 offset:12832
    ds_read_b64_tr_b16 v[106:107], v1 offset:16032
    s_waitcnt lgkmcnt(12)
    ds_read_b64_tr_b16 v[108:109], v1 offset:12864
    ds_read_b64_tr_b16 v[110:111], v1 offset:16064
    ds_read_b64_tr_b16 v[112:113], v1 offset:12896
    s_waitcnt lgkmcnt(12)
    ds_read_b64_tr_b16 v[114:115], v1 offset:16096
    ds_read_b64_tr_b16 v[116:117], v1 offset:12928
    ds_read_b64_tr_b16 v[118:119], v1 offset:16128
    s_waitcnt lgkmcnt(12)
    ds_read_b64_tr_b16 v[120:121], v1 offset:19200
    ds_read_b64_tr_b16 v[122:123], v1 offset:22400
    s_mul_i32 s7, s43, 2560
    s_add_u32 s7, s7, 40960
    v_add_u32 v8, 0, v10
    v_mul_u32_u24 v12, 6554, v8
    v_lshrrev_b32 v12, 16, v12
    v_mul_u32_u24 v5, 2400, v12
    v_lshlrev_b32 v8, 4, v8
    v_add_u32 v12, v5, v8
    v_add_u32 v8, s7, v8
    v_add_u32 v9, 64, v10
    v_mul_u32_u24 v13, 6554, v9
    v_lshrrev_b32 v13, 16, v13
    v_mul_u32_u24 v5, 2400, v13
    v_lshlrev_b32 v9, 4, v9
    v_add_u32 v13, v5, v9
    v_add_u32 v9, s7, v9
    v_add_u32 v11, 128, v10
    v_mul_u32_u24 v95, 6554, v11
    v_lshrrev_b32 v95, 16, v95
    v_mul_u32_u24 v5, 2400, v95
    v_lshlrev_b32 v11, 4, v11
    v_add_u32 v95, v5, v11
    v_add_u32 v11, s7, v11
    v_and_b32 v5, 15, v10
    v_mul_u32_u24 v5, 160, v5
    v_lshrrev_b32 v16, 4, v10
    v_lshlrev_b32 v16, 3, v16
    v_add3_u32 v5, v5, v16, s7
    s_waitcnt vmcnt(0)
    v_cmp_ne_u32 vcc, s47, v0
    s_nop 0
    s_and_b32 vcc_lo, vcc_lo, 0xff
    s_cbranch_scc0 L_go0
    s_mov_b64 exec, 0xff
    buffer_load_dword v0, v3, s[32:35], s8 offen sc1
    s_mov_b64 exec, -1
    ds_read_b64_tr_b16 v[124:125], v1 offset:19232
    s_waitcnt lgkmcnt(12)
    ds_read_b64_tr_b16 v[126:127], v1 offset:22432
    ds_read_b64_tr_b16 v[128:129], v1 offset:19264
    ds_read_b64_tr_b16 v[130:131], v1 offset:22464
    s_waitcnt lgkmcnt(12)
    ds_read_b64_tr_b16 v[132:133], v1 offset:19296
    ds_read_b64_tr_b16 v[134:135], v1 offset:22496
    ds_read_b64_tr_b16 v[136:137], v1 offset:19328
    s_waitcnt lgkmcnt(12)
    ds_read_b64_tr_b16 v[138:139], v1 offset:22528
    ds_read_b64_tr_b16 v[140:141], v1 offset:25600
    ds_read_b64_tr_b16 v[142:143], v1 offset:28800
    s_waitcnt lgkmcnt(12)
    ds_read_b64_tr_b16 v[144:145], v1 offset:25632
    ds_read_b64_tr_b16 v[146:147], v1 offset:28832
    ds_read_b64_tr_b16 v[148:149], v1 offset:25664
    s_waitcnt lgkmcnt(12)
    ds_read_b64_tr_b16 v[150:151], v1 offset:28864
    ds_read_b64_tr_b16 v[152:153], v1 offset:25696
    ds_read_b64_tr_b16 v[154:155], v1 offset:28896
    s_waitcnt lgkmcnt(12)
    ds_read_b64_tr_b16 v[156:157], v1 offset:25728
    ds_read_b64_tr_b16 v[158:159], v1 offset:28928
    ds_read_b64_tr_b16 v[160:161], v1 offset:32000
    s_waitcnt lgkmcnt(12)
    ds_read_b64_tr_b16 v[162:163], v1 offset:35200
    ds_read_b64_tr_b16 v[164:165], v1 offset:32032
    ds_read_b64_tr_b16 v[166:167], v1 offset:35232
    s_waitcnt vmcnt(0)
    v_cmp_ne_u32 vcc, s47, v0
    s_nop 0
    s_and_b32 vcc_lo, vcc_lo, 0xff
    s_cbranch_scc0 L_go1
    s_mov_b32 s92, 0
L_poll:
    s_mov_b64 exec, 0xff
    buffer_load_dword v0, v3, s[32:35], s8 offen sc1
    s_mov_b64 exec, -1
    s_waitcnt vmcnt(0)
    v_cmp_ne_u32 vcc, s47, v0
    s_nop 0
    s_and_b32 vcc_lo, vcc_lo, 0xff
    s_cbranch_scc0 L_go1
    s_add_u32 s92, s92, 1
    s_cmp_lt_u32 s92, 200000
    s_cbranch_scc1 L_poll
L_pollx:
L_go1:
    s_add_u32 s3, s98, 0
    buffer_load_dwordx4 v[176:179], v6, s[32:35], s3 offen offset:0 sc1
    s_add_u32 s4, s98, 20480
    buffer_load_dwordx4 v[180:183], v6, s[32:35], s4 offen offset:0 sc1
    buffer_load_dwordx4 v[184:187], v6, s[32:35], s3 offen offset:1280 sc1
    buffer_load_dwordx4 v[188:191], v6, s[32:35], s4 offen offset:1280 sc1
    s_add_u32 s3, s98, 2560
    buffer_load_dwordx4 v[192:195], v6, s[32:35], s3 offen offset:0 sc1
    s_add_u32 s4, s98, 23040
    buffer_load_dwordx4 v[196:199], v6, s[32:35], s4 offen offset:0 sc1
    buffer_load_dwordx4 v[200:203], v6, s[32:35], s3 offen offset:1280 sc1
    buffer_load_dwordx4 v[204:207], v6, s[32:35], s4 offen offset:1280 sc1
    s_add_u32 s3, s98, 5120
    buffer_load_dwordx4 v[208:211], v6, s[32:35], s3 offen offset:0 sc1
    s_branch L_conv
L_go0:
    s_add_u32 s3, s98, 0
    buffer_load_dwordx4 v[176:179], v6, s[32:35], s3 offen offset:0 sc1
    s_add_u32 s4, s98, 20480
    buffer_load_dwordx4 v[180:183], v6, s[32:35], s4 offen offset:0 sc1
    buffer_load_dwordx4 v[184:187], v6, s[32:35], s3 offen offset:1280 sc1
    buffer_load_dwordx4 v[188:191], v6, s[32:35], s4 offen offset:1280 sc1
    s_add_u32 s3, s98, 2560
    buffer_load_dwordx4 v[192:195], v6, s[32:35], s3 offen offset:0 sc1
    s_add_u32 s4, s98, 23040
    buffer_load_dwordx4 v[196:199], v6, s[32:35], s4 offen offset:0 sc1
    buffer_load_dwordx4 v[200:203], v6, s[32:35], s3 offen offset:1280 sc1
    buffer_load_dwordx4 v[204:207], v6, s[32:35], s4 offen offset:1280 sc1
    ds_read_b64_tr_b16 v[124:125], v1 offset:19232
    s_waitcnt lgkmcnt(12)
    ds_read_b64_tr_b16 v[126:127], v1 offset:22432
    ds_read_b64_tr_b16 v[128:129], v1 offset:19264
    ds_read_b64_tr_b16 v[130:131], v1 offset:22464
    s_waitcnt lgkmcnt(12)
    ds_read_b64_tr_b16 v[132:133], v1 offset:19296
    ds_read_b64_tr_b16 v[134:135], v1 offset:22496
    ds_read_b64_tr_b16 v[136:137], v1 offset:19328
    s_waitcnt lgkmcnt(12)
    ds_read_b64_tr_b16 v[138:139], v1 offset:22528
    ds_read_b64_tr_b16 v[140:141], v1 offset:25600
    ds_read_b64_tr_b16 v[142:143], v1 offset:28800
    s_waitcnt lgkmcnt(12)
    ds_read_b64_tr_b16 v[144:145], v1 offset:25632
    ds_read_b64_tr_b16 v[146:147], v1 offset:28832
    ds_read_b64_tr_b16 v[148:149], v1 offset:25664
    s_waitcnt lgkmcnt(12)
    ds_read_b64_tr_b16 v[150:151], v1 offset:28864
    ds_read_b64_tr_b16 v[152:153], v1 offset:25696
    ds_read_b64_tr_b16 v[154:155], v1 offset:28896
    s_waitcnt lgkmcnt(12)
    ds_read_b64_tr_b16 v[156:157], v1 offset:25728
    ds_read_b64_tr_b16 v[158:159], v1 offset:28928
    ds_read_b64_tr_b16 v[160:161], v1 offset:32000
    s_waitcnt lgkmcnt(12)
    ds_read_b64_tr_b16 v[162:163], v1 offset:35200
    ds_read_b64_tr_b16 v[164:165], v1 offset:32032
    ds_read_b64_tr_b16 v[166:167], v1 offset:35232
    s_add_u32 s3, s98, 5120
    buffer_load_dwordx4 v[208:211], v6, s[32:35], s3 offen offset:0 sc1
L_conv:
    s_waitcnt lgkmcnt(12)
    s_waitcnt vmcnt(7)
    v_mfma_f32_16x16x32_bf16 v[16:19], v[56:59], v[176:179], 0
    v_mfma_f32_16x16x32_bf16 v[36:39], v[56:59], v[180:183], 0
    s_add_u32 s4, s98, 25600
    buffer_load_dwordx4 v[212:215], v6, s[32:35], s4 offen offset:0 sc1
    ds_read_b64_tr_b16 v[56:57], v1 offset:32064
    ds_read_b64_tr_b16 v[58:59], v1 offset:35264
    v_mfma_f32_16x16x32_bf16 v[20:23], v[60:63], v[176:179], 0
    v_mfma_f32_16x16x32_bf16 v[40:43], v[60:63], v[180:183], 0
    ds_read_b64_tr_b16 v[60:61], v1 offset:32096
    s_waitcnt lgkmcnt(12)
    ds_read_b64_tr_b16 v[62:63], v1 offset:35296
    v_mfma_f32_16x16x32_bf16 v[24:27], v[64:67], v[176:179], 0
    v_mfma_f32_16x16x32_bf16 v[44:47], v[64:67], v[180:183], 0
    buffer_load_dwordx4 v[216:219], v6, s[32:35], s3 offen offset:1280 sc1
    ds_read_b64_tr_b16 v[64:65], v1 offset:32128
    ds_read_b64_tr_b16 v[66:67], v1 offset:35328
    v_mfma_f32_16x16x32_bf16 v[28:31], v[68:71], v[176:179], 0
    v_mfma_f32_16x16x32_bf16 v[48:51], v[68:71], v[180:183], 0
    s_waitcnt lgkmcnt(12)
    ds_read_b64_tr_b16 v[68:69], v1 offset:38400
    ds_read_b64_tr_b16 v[70:71], v1 offset:41600
    v_mfma_f32_16x16x32_bf16 v[32:35], v[72:75], v[176:179], 0
    v_mfma_f32_16x16x32_bf16 v[52:55], v[72:75], v[180:183], 0
    ds_read_b64_tr_b16 v[72:73], v1 offset:38432
    s_waitcnt lgkmcnt(12)
    ds_read_b64_tr_b16 v[74:75], v1 offset:41632
    s_waitcnt vmcnt(7)
    v_mfma_f32_16x16x32_bf16 v[16:19], v[76:79], v[184:187], v[16:19]
    v_mfma_f32_16x16x32_bf16 v[36:39], v[76:79], v[188:191], v[36:39]
    buffer_load_dwordx4 v[220:223], v6, s[32:35], s4 offen offset:1280 sc1
    ds_read_b64_tr_b16 v[76:77], v1 offset:38464
    ds_read_b64_tr_b16 v[78:79], v1 offset:41664
    v_mfma_f32_16x16x32_bf16 v[20:23], v[80:83], v[184:187], v[20:23]
    v_mfma_f32_16x16x32_bf16 v[40:43], v[80:83], v[188:191], v[40:43]
    s_waitcnt lgkmcnt(12)
    ds_read_b64_tr_b16 v[80:81], v1 offset:38496
    ds_read_b64_tr_b16 v[82:83], v1 offset:41696
    v_mfma_f32_16x16x32_bf16 v[24:27], v[84:87], v[184:187], v[24:27]
    v_mfma_f32_16x16x32_bf16 v[44:47], v[84:87], v[188:191], v[44:47]
    s_add_u32 s3, s98, 7680
    buffer_load_dwordx4 v[224:227], v6, s[32:35], s3 offen offset:0 sc1
    ds_read_b64_tr_b16 v[84:85], v1 offset:38528
    s_waitcnt lgkmcnt(12)
    ds_read_b64_tr_b16 v[86:87], v1 offset:41728
    v_mfma_f32_16x16x32_bf16 v[28:31], v[88:91], v[184:187], v[28:31]
    v_mfma_f32_16x16x32_bf16 v[48:51], v[88:91], v[188:191], v[48:51]
    ds_read_b64_tr_b16 v[88:89], v1 offset:44800
    ds_read_b64_tr_b16 v[90:91], v1 offset:48000
    v_mfma_f32_16x16x32_bf16 v[32:35], v[96:99], v[184:187], v[32:35]
    v_mfma_f32_16x16x32_bf16 v[52:55], v[96:99], v[188:191], v[52:55]
    s_waitcnt lgkmcnt(12)
    ds_read_b64_tr_b16 v[96:97], v1 offset:44832
    ds_read_b64_tr_b16 v[98:99], v1 offset:48032
    s_waitcnt vmcnt(7)
    v_mfma_f32_16x16x32_bf16 v[16:19], v[100:103], v[192:195], v[16:19]
    v_mfma_f32_16x16x32_bf16 v[36:39], v[100:103], v[196:199], v[36:39]
    s_add_u32 s4, s98, 28160
    buffer_load_dwordx4 v[228:231], v6, s[32:35], s4 offen offset:0 sc1
    ds_read_b64_tr_b16 v[100:101], v1 offset:44864
    s_waitcnt lgkmcnt(12)
    ds_read_b64_tr_b16 v[102:103], v1 offset:48064
    v_mfma_f32_16x16x32_bf16 v[20:23], v[104:107], v[192:195], v[20:23]
    v_mfma_f32_16x16x32_bf16 v[40:43], v[104:107], v[196:199], v[40:43]
    ds_read_b64_tr_b16 v[104:105], v1 offset:44896
    ds_read_b64_tr_b16 v[106:107], v1 offset:48096
    v_mfma_f32_16x16x32_bf16 v[24:27], v[108:111], v[192:195], v[24:27]
    v_mfma_f32_16x16x32_bf16 v[44:47], v[108:111], v[196:199], v[44:47]
    buffer_load_dwordx4 v[232:235], v6, s[32:35], s3 offen offset:1280 sc1
    s_waitcnt lgkmcnt(12)
    ds_read_b64_tr_b16 v[108:109], v1 offset:44928
    ds_read_b64_tr_b16 v[110:111], v1 offset:48128
    v_mfma_f32_16x16x32_bf16 v[28:31], v[112:115], v[192:195], v[28:31]
    v_mfma_f32_16x16x32_bf16 v[48:51], v[112:115], v[196:199], v[48:51]
    ds_read_b64_tr_b16 v[112:113], v2 offset:2560
    s_waitcnt lgkmcnt(12)
    ds_read_b64_tr_b16 v[114:115], v2 offset:15360
    v_mfma_f32_16x16x32_bf16 v[32:35], v[116:119], v[192:195], v[32:35]
    v_mfma_f32_16x16x32_bf16 v[52:55], v[116:119], v[196:199], v[52:55]
    ds_read_b64_tr_b16 v[116:117], v2 offset:2592
    ds_read_b64_tr_b16 v[118:119], v2 offset:15392
    s_waitcnt vmcnt(7)
    v_mfma_f32_16x16x32_bf16 v[16:19], v[120:123], v[200:203], v[16:19]
    v_mfma_f32_16x16x32_bf16 v[36:39], v[120:123], v[204:207], v[36:39]
    buffer_load_dwordx4 v[236:239], v6, s[32:35], s4 offen offset:1280 sc1
    s_waitcnt lgkmcnt(12)
    ds_read_b64_tr_b16 v[120:121], v2 offset:2624
    ds_read_b64_tr_b16 v[122:123], v2 offset:15424
    v_mfma_f32_16x16x32_bf16 v[20:23], v[124:127], v[200:203], v[20:23]
    v_mfma_f32_16x16x32_bf16 v[40:43], v[124:127], v[204:207], v[40:43]
    ds_read_b64_tr_b16 v[124:125], v2 offset:2656
    s_waitcnt lgkmcnt(12)
    ds_read_b64_tr_b16 v[126:127], v2 offset:15456
    v_mfma_f32_16x16x32_bf16 v[24:27], v[128:131], v[200:203], v[24:27]
    v_mfma_f32_16x16x32_bf16 v[44:47], v[128:131], v[204:207], v[44:47]
    s_add_u32 s3, s91, 0
    buffer_load_dwordx4 v[240:243], v14, s[32:35], s3 offen offset:1024 sc1
    ds_read_b64_tr_b16 v[128:129], v2 offset:2688
    ds_read_b64_tr_b16 v[130:131], v2 offset:15488
    v_mfma_f32_16x16x32_bf16 v[28:31], v[132:135], v[200:203], v[28:31]
    v_mfma_f32_16x16x32_bf16 v[48:51], v[132:135], v[204:207], v[48:51]
    s_waitcnt lgkmcnt(12)
    ds_read_b64_tr_b16 v[132:133], v2 offset:28160
    ds_read_b64_tr_b16 v[134:135], v2 offset:40960
    v_mfma_f32_16x16x32_bf16 v[32:35], v[136:139], v[200:203], v[32:35]
    v_mfma_f32_16x16x32_bf16 v[52:55], v[136:139], v[204:207], v[52:55]
    ds_read_b64_tr_b16 v[136:137], v2 offset:28192
    s_waitcnt lgkmcnt(12)
    ds_read_b64_tr_b16 v[138:139], v2 offset:40992
    s_waitcnt vmcnt(7)
    v_mfma_f32_16x16x32_bf16 v[16:19], v[140:143], v[208:211], v[16:19]
    v_mfma_f32_16x16x32_bf16 v[36:39], v[140:143], v[212:215], v[36:39]
    s_add_u32 s4, s91, 20480
    buffer_load_dwordx4 v[244:247], v14, s[32:35], s4 offen offset:1024 sc1
    ds_read_b64_tr_b16 v[140:141], v2 offset:28224
    ds_read_b64_tr_b16 v[142:143], v2 offset:41024
    v_mfma_f32_16x16x32_bf16 v[20:23], v[144:147], v[208:211], v[20:23]
    v_mfma_f32_16x16x32_bf16 v[40:43], v[144:147], v[212:215], v[40:43]
    s_waitcnt lgkmcnt(12)
    ds_read_b64_tr_b16 v[144:145], v2 offset:28256
    ds_read_b64_tr_b16 v[146:147], v2 offset:41056
    v_mfma_f32_16x16x32_bf16 v[24:27], v[148:151], v[208:211], v[24:27]
    v_mfma_f32_16x16x32_bf16 v[44:47], v[148:151], v[212:215], v[44:47]
    s_add_u32 s3, s91, 5120
    buffer_load_dwordx4 v[248:251], v14, s[32:35], s3 offen offset:1024 sc1
    ds_read_b64_tr_b16 v[148:149], v2 offset:28288
    s_waitcnt lgkmcnt(12)
    ds_read_b64_tr_b16 v[150:151], v2 offset:41088
    v_mfma_f32_16x16x32_bf16 v[28:31], v[152:155], v[208:211], v[28:31]
    v_mfma_f32_16x16x32_bf16 v[48:51], v[152:155], v[212:215], v[48:51]
    v_mfma_f32_16x16x32_bf16 v[32:35], v[156:159], v[208:211], v[32:35]
    v_mfma_f32_16x16x32_bf16 v[52:55], v[156:159], v[212:215], v[52:55]
    s_waitcnt vmcnt(7)
    v_mfma_f32_16x16x32_bf16 v[16:19], v[160:163], v[216:219], v[16:19]
    v_mfma_f32_16x16x32_bf16 v[36:39], v[160:163], v[220:223], v[36:39]
    s_add_u32 s4, s91, 25600
    buffer_load_dwordx4 v[252:255], v14, s[32:35], s4 offen offset:1024 sc1
    v_mfma_f32_16x16x32_bf16 v[20:23], v[164:167], v[216:219], v[20:23]
    v_mfma_f32_16x16x32_bf16 v[40:43], v[164:167], v[220:223], v[40:43]
    v_mfma_f32_16x16x32_bf16 v[24:27], v[56:59], v[216:219], v[24:27]
    v_mfma_f32_16x16x32_bf16 v[44:47], v[56:59], v[220:223], v[44:47]
    v_mfma_f32_16x16x32_bf16 v[28:31], v[60:63], v[216:219], v[28:31]
    v_mfma_f32_16x16x32_bf16 v[48:51], v[60:63], v[220:223], v[48:51]
    v_mfma_f32_16x16x32_bf16 v[32:35], v[64:67], v[216:219], v[32:35]
    v_mfma_f32_16x16x32_bf16 v[52:55], v[64:67], v[220:223], v[52:55]
    s_waitcnt vmcnt(6)
    v_mfma_f32_16x16x32_bf16 v[16:19], v[68:71], v[224:227], v[16:19]
    v_mfma_f32_16x16x32_bf16 v[36:39], v[68:71], v[228:231], v[36:39]
    v_mfma_f32_16x16x32_bf16 v[20:23], v[72:75], v[224:227], v[20:23]
    v_mfma_f32_16x16x32_bf16 v[40:43], v[72:75], v[228:231], v[40:43]
    v_mfma_f32_16x16x32_bf16 v[24:27], v[76:79], v[224:227], v[24:27]
    v_mfma_f32_16x16x32_bf16 v[44:47], v[76:79], v[228:231], v[44:47]
    v_mfma_f32_16x16x32_bf16 v[28:31], v[80:83], v[224:227], v[28:31]
    v_mfma_f32_16x16x32_bf16 v[48:51], v[80:83], v[228:231], v[48:51]
    v_mfma_f32_16x16x32_bf16 v[32:35], v[84:87], v[224:227], v[32:35]
    v_mfma_f32_16x16x32_bf16 v[52:55], v[84:87], v[228:231], v[52:55]
    s_waitcnt vmcnt(4)
    v_mfma_f32_16x16x32_bf16 v[16:19], v[88:91], v[232:235], v[16:19]
    v_mfma_f32_16x16x32_bf16 v[36:39], v[88:91], v[236:239], v[36:39]
    v_mfma_f32_16x16x32_bf16 v[20:23], v[96:99], v[232:235], v[20:23]
    v_mfma_f32_16x16x32_bf16 v[40:43], v[96:99], v[236:239], v[40:43]
    v_mfma_f32_16x16x32_bf16 v[24:27], v[100:103], v[232:235], v[24:27]
    v_mfma_f32_16x16x32_bf16 v[44:47], v[100:103], v[236:239], v[44:47]
    v_mfma_f32_16x16x32_bf16 v[28:31], v[104:107], v[232:235], v[28:31]
    v_mfma_f32_16x16x32_bf16 v[48:51], v[104:107], v[236:239], v[48:51]
    v_mfma_f32_16x16x32_bf16 v[32:35], v[108:111], v[232:235], v[32:35]
    v_mfma_f32_16x16x32_bf16 v[52:55], v[108:111], v[236:239], v[52:55]
    s_waitcnt vmcnt(2)
    v_mfma_f32_16x16x32_bf16 v[16:19], v[112:115], v[240:243], v[16:19]
    v_mfma_f32_16x16x32_bf16 v[36:39], v[112:115], v[244:247], v[36:39]
    v_mfma_f32_16x16x32_bf16 v[20:23], v[116:119], v[240:243], v[20:23]
    v_mfma_f32_16x16x32_bf16 v[40:43], v[116:119], v[244:247], v[40:43]
    v_mfma_f32_16x16x32_bf16 v[24:27], v[120:123], v[240:243], v[24:27]
    v_mfma_f32_16x16x32_bf16 v[44:47], v[120:123], v[244:247], v[44:47]
    s_waitcnt lgkmcnt(12)
    v_mfma_f32_16x16x32_bf16 v[28:31], v[124:127], v[240:243], v[28:31]
    v_mfma_f32_16x16x32_bf16 v[48:51], v[124:127], v[244:247], v[48:51]
    s_waitcnt lgkmcnt(10)
    v_mfma_f32_16x16x32_bf16 v[32:35], v[128:131], v[240:243], v[32:35]
    v_mfma_f32_16x16x32_bf16 v[52:55], v[128:131], v[244:247], v[52:55]
    s_waitcnt vmcnt(0) lgkmcnt(8)
    v_mfma_f32_16x16x32_bf16 v[16:19], v[132:135], v[248:251], v[16:19]
    v_mfma_f32_16x16x32_bf16 v[36:39], v[132:135], v[252:255], v[36:39]
    s_waitcnt lgkmcnt(6)
    v_mfma_f32_16x16x32_bf16 v[20:23], v[136:139], v[248:251], v[20:23]
    v_mfma_f32_16x16x32_bf16 v[40:43], v[136:139], v[252:255], v[40:43]
    s_waitcnt lgkmcnt(4)
    v_mfma_f32_16x16x32_bf16 v[24:27], v[140:143], v[248:251], v[24:27]
    v_mfma_f32_16x16x32_bf16 v[44:47], v[140:143], v[252:255], v[44:47]
    s_waitcnt lgkmcnt(2)
    v_mfma_f32_16x16x32_bf16 v[28:31], v[144:147], v[248:251], v[28:31]
    v_mfma_f32_16x16x32_bf16 v[48:51], v[144:147], v[252:255], v[48:51]
    s_waitcnt lgkmcnt(0)
    v_mfma_f32_16x16x32_bf16 v[32:35], v[148:151], v[248:251], v[32:35]
    v_mfma_f32_16x16x32_bf16 v[52:55], v[148:151], v[252:255], v[52:55]
    s_nop 2
    s_xor_b32 s7, s43, 1
    s_mul_i32 s7, s7, 2560
    s_add_u32 s7, s7, 40960
    v_mov_b32 v94, s47
    v_mov_b32 v92, s7
    s_mul_i32 s7, s43, 2560
    s_add_u32 s7, s7, 40960
    v_mov_b32 v93, s7
    s_cmp_eq_u32 s85, 0
    s_cbranch_scc0 L_red1
    ds_write_b128 v4, v[36:39] offset:0
    ds_write_b128 v4, v[40:43] offset:1024
    ds_write_b128 v4, v[44:47] offset:2048
    ds_write_b128 v4, v[48:51] offset:3072
    ds_write_b128 v4, v[52:55] offset:4096
    s_waitcnt lgkmcnt(0)
    v_mov_b32 v94, s47
    ds_write_b32 v92, v94
    s_mov_b32 s92, 0
L_pw0:
    ds_read_b32 v91, v93
    s_waitcnt lgkmcnt(0)
    v_cmp_eq_u32 vcc, s47, v91
    s_cbranch_vccnz L_pwok0
    s_add_u32 s92, s92, 1
    s_cmp_lt_u32 s92, 200000
    s_cbranch_scc1 L_pw0
L_pwok0:
    ds_read_b128 v[56:59], v7 offset:0
    ds_read_b128 v[60:63], v7 offset:1024
    ds_read_b128 v[64:67], v7 offset:2048
    ds_read_b128 v[68:71], v7 offset:3072
    ds_read_b128 v[72:75], v7 offset:4096
    s_waitcnt lgkmcnt(4)
    v_add_f32 v56, v56, v16
    v_add_f32 v57, v57, v17
    v_add_f32 v58, v58, v18
    v_add_f32 v59, v59, v19
    v_cvt_pk_bf16_f32 v80, v56, v57
    v_cvt_pk_bf16_f32 v81, v58, v59
    ds_write_b64 v5, v[80:81] offset:0
    s_waitcnt lgkmcnt(4)
    v_add_f32 v60, v60, v20
    v_add_f32 v61, v61, v21
    v_add_f32 v62, v62, v22
    v_add_f32 v63, v63, v23
    v_cvt_pk_bf16_f32 v82, v60, v61
    v_cvt_pk_bf16_f32 v83, v62, v63
    ds_write_b64 v5, v[82:83] offset:32
    s_waitcnt lgkmcnt(4)
    v_add_f32 v64, v64, v24
    v_add_f32 v65, v65, v25
    v_add_f32 v66, v66, v26
    v_add_f32 v67, v67, v27
    v_cvt_pk_bf16_f32 v84, v64, v65
    v_cvt_pk_bf16_f32 v85, v66, v67
    ds_write_b64 v5, v[84:85] offset:64
    s_waitcnt lgkmcnt(4)
    v_add_f32 v68, v68, v28
    v_add_f32 v69, v69, v29
    v_add_f32 v70, v70, v30
    v_add_f32 v71, v71, v31
    v_cvt_pk_bf16_f32 v86, v68, v69
    v_cvt_pk_bf16_f32 v87, v70, v71
    ds_write_b64 v5, v[86:87] offset:96
    s_waitcnt lgkmcnt(4)
    v_add_f32 v72, v72, v32
    v_add_f32 v73, v73, v33
    v_add_f32 v74, v74, v34
    v_add_f32 v75, v75, v35
    v_cvt_pk_bf16_f32 v88, v72, v73
    v_cvt_pk_bf16_f32 v89, v74, v75
    ds_write_b64 v5, v[88:89] offset:128
    s_branch L_red2
L_red1:
    ds_write_b128 v4, v[16:19] offset:0
    ds_write_b128 v4, v[20:23] offset:1024
    ds_write_b128 v4, v[24:27] offset:2048
    ds_write_b128 v4, v[28:31] offset:3072
    ds_write_b128 v4, v[32:35] offset:4096
    s_waitcnt lgkmcnt(0)
    v_mov_b32 v94, s47
    ds_write_b32 v92, v94
    s_mov_b32 s92, 0
L_pw1:
    ds_read_b32 v91, v93
    s_waitcnt lgkmcnt(0)
    v_cmp_eq_u32 vcc, s47, v91
    s_cbranch_vccnz L_pwok1
    s_add_u32 s92, s92, 1
    s_cmp_lt_u32 s92, 200000
    s_cbranch_scc1 L_pw1
L_pwok1:
    ds_read_b128 v[56:59], v7 offset:0
    ds_read_b128 v[60:63], v7 offset:1024
    ds_read_b128 v[64:67], v7 offset:2048
    ds_read_b128 v[68:71], v7 offset:3072
    ds_read_b128 v[72:75], v7 offset:4096
    s_waitcnt lgkmcnt(4)
    v_add_f32 v56, v56, v36
    v_add_f32 v57, v57, v37
    v_add_f32 v58, v58, v38
    v_add_f32 v59, v59, v39
    v_cvt_pk_bf16_f32 v80, v56, v57
    v_cvt_pk_bf16_f32 v81, v58, v59
    ds_write_b64 v5, v[80:81] offset:0
    s_waitcnt lgkmcnt(4)
    v_add_f32 v60, v60, v40
    v_add_f32 v61, v61, v41
    v_add_f32 v62, v62, v42
    v_add_f32 v63, v63, v43
    v_cvt_pk_bf16_f32 v82, v60, v61
    v_cvt_pk_bf16_f32 v83, v62, v63
    ds_write_b64 v5, v[82:83] offset:32
    s_waitcnt lgkmcnt(4)
    v_add_f32 v64, v64, v44
    v_add_f32 v65, v65, v45
    v_add_f32 v66, v66, v46
    v_add_f32 v67, v67, v47
    v_cvt_pk_bf16_f32 v84, v64, v65
    v_cvt_pk_bf16_f32 v85, v66, v67
    ds_write_b64 v5, v[84:85] offset:64
    s_waitcnt lgkmcnt(4)
    v_add_f32 v68, v68, v48
    v_add_f32 v69, v69, v49
    v_add_f32 v70, v70, v50
    v_add_f32 v71, v71, v51
    v_cvt_pk_bf16_f32 v86, v68, v69
    v_cvt_pk_bf16_f32 v87, v70, v71
    ds_write_b64 v5, v[86:87] offset:96
    s_waitcnt lgkmcnt(4)
    v_add_f32 v72, v72, v52
    v_add_f32 v73, v73, v53
    v_add_f32 v74, v74, v54
    v_add_f32 v75, v75, v55
    v_cvt_pk_bf16_f32 v88, v72, v73
    v_cvt_pk_bf16_f32 v89, v74, v75
    ds_write_b64 v5, v[88:89] offset:128
L_red2:
    ds_read_b128 v[96:99], v8
    ds_read_b128 v[100:103], v9
    s_mov_b32 exec_hi, 0
    ds_read_b128 v[104:107], v11
    s_mov_b64 exec, -1
    s_waitcnt lgkmcnt(2)
    buffer_store_dwordx4 v[96:99], v12, s[28:31], s99 offen nt
    s_waitcnt lgkmcnt(1)
    buffer_store_dwordx4 v[100:103], v13, s[28:31], s99 offen nt
    s_waitcnt lgkmcnt(0)
    s_mov_b32 exec_hi, 0
    buffer_store_dwordx4 v[104:107], v95, s[28:31], s99 offen nt
L_end:
    s_endpgm
L_path_10:
    s_cmp_eq_u32 s44, 0
    s_cselect_b32 s87, s41, 0
    s_bfe_u32 s75, s84, 0x40004
    s_add_u32 s75, s75, s83
    s_cmp_ge_u32 s75, 10
    s_cselect_b32 s73, 10, 0
    s_sub_u32 s75, s75, s73
    s_mul_i32 s62, s75, 245760
    s_add_u32 s62, s62, s5
    s_lshl_b32 s52, s75, 7
    s_add_u32 s52, s52, s4
    s_bfe_u32 s75, s84, 0x40008
    s_add_u32 s75, s75, s83
    s_cmp_ge_u32 s75, 10
    s_cselect_b32 s73, 10, 0
    s_sub_u32 s75, s75, s73
    s_mul_i32 s63, s75, 245760
    s_add_u32 s63, s63, s5
    s_lshl_b32 s53, s75, 7
    s_add_u32 s53, s53, s4
    s_bfe_u32 s75, s84, 0x4000c
    s_add_u32 s75, s75, s83
    s_cmp_ge_u32 s75, 10
    s_cselect_b32 s73, 10, 0
    s_sub_u32 s75, s75, s73
    s_mul_i32 s64, s75, 245760
    s_add_u32 s64, s64, s5
    s_lshl_b32 s54, s75, 7
    s_add_u32 s54, s54, s4
    s_bfe_u32 s75, s84, 0x40010
    s_add_u32 s75, s75, s83
    s_cmp_ge_u32 s75, 10
    s_cselect_b32 s73, 10, 0
    s_sub_u32 s75, s75, s73
    s_mul_i32 s65, s75, 245760
    s_add_u32 s65, s65, s5
    s_lshl_b32 s55, s75, 7
    s_add_u32 s55, s55, s4
    s_bfe_u32 s75, s84, 0x40014
    s_add_u32 s75, s75, s83
    s_cmp_ge_u32 s75, 10
    s_cselect_b32 s73, 10, 0
    s_sub_u32 s75, s75, s73
    s_mul_i32 s66, s75, 245760
    s_add_u32 s66, s66, s5
    s_lshl_b32 s56, s75, 7
    s_add_u32 s56, s56, s4
    s_bfe_u32 s75, s84, 0x40018
    s_add_u32 s75, s75, s83
    s_cmp_ge_u32 s75, 10
    s_cselect_b32 s73, 10, 0
    s_sub_u32 s75, s75, s73
    s_mul_i32 s67, s75, 245760
    s_add_u32 s67, s67, s5
    s_lshl_b32 s57, s75, 7
    s_add_u32 s57, s57, s4
    s_bfe_u32 s75, s84, 0x4001c
    s_add_u32 s75, s75, s83
    s_cmp_ge_u32 s75, 10
    s_cselect_b32 s73, 10, 0
    s_sub_u32 s75, s75, s73
    s_mul_i32 s68, s75, 245760
    s_add_u32 s68, s68, s5
    s_lshl_b32 s58, s75, 7
    s_add_u32 s58, s58, s4
    s_mov_b32 s75, s85
    s_add_u32 s75, s75, s83
    s_cmp_ge_u32 s75, 10
    s_cselect_b32 s73, 10, 0
    s_sub_u32 s75, s75, s73
    s_mul_i32 s69, s75, 245760
    s_add_u32 s69, s69, s5
    s_lshl_b32 s59, s75, 7
    s_add_u32 s59, s59, s4
    s_mov_b32 s24, s8
    s_mov_b32 s25, s9
    s_mov_b32 s26, 819200
    s_mov_b32 s27, 0x20000
    s_mov_b32 s28, s12
    s_mov_b32 s29, s13
    s_mov_b32 s30, 5242880
    s_mov_b32 s31, 0x20000
    s_load_dwordx2 s[12:13], s[0:1], 8
    s_load_dwordx2 s[14:15], s[0:1], 0
    s_waitcnt lgkmcnt(0)
    s_lshl_b32 s3, s41, 3
    s_add_u32 s3, s3, s42
    s_lshl_b32 s3, s3, 3
    s_add_u32 s3, s3, s43
    s_mul_i32 s3, s3, 2560
    s_lshr_b32 s6, s41, 2
    s_mul_i32 s6, s6, 5
    s_add_u32 s6, s6, 1
    s_lshr_b32 s6, s6, 1
    s_add_u32 s6, s6, 5
    v_cmp_le_u32 vcc, 5, v10
    v_add_u32 v86, s6, v10
    v_subrev_u32 v87, 5, v86
    v_cndmask_b32 v86, v86, v87, vcc
    v_subrev_u32 v87, 10, v86
    v_min_u32 v86, v86, v87
    v_lshlrev_b32 v86, 7, v86
    v_add_u32 v87, 1280, v86
    v_cndmask_b32 v86, v86, v87, vcc
    s_mov_b32 s4, s14
    s_mov_b32 s5, s15
    s_mov_b32 s6, 2621440
    s_mov_b32 s7, 0x20000
    s_mov_b64 exec, 1023
    buffer_load_dword v95, v86, s[4:7], s3 offen
    s_mov_b64 exec, -1
    s_getreg_b32 s46, hwreg(HW_REG_XCC_ID, 0, 3)
    s_mul_i32 s93, s42, 160
    v_and_b32 v11, 15, v10
    v_lshrrev_b32 v12, 4, v10
    v_lshrrev_b32 v13, 1, v11
    v_xor_b32 v13, v13, v12
    v_lshlrev_b32 v13, 4, v13
    v_lshl_add_u32 v13, v11, 7, v13
    s_lshl_b32 s3, s44, 12
    v_add_u32 v6, s3, v13
    v_xor_b32 v7, 64, v6
    v_lshrrev_b32 v11, 5, v10
    v_lshlrev_b32 v11, 4, v11
    v_bfe_u32 v13, v10, 2, 3
    v_add_u32 v11, v11, v13
    v_mul_u32_u24 v11, 160, v11
    v_and_b32 v12, 3, v10
    v_lshl_add_u32 v8, v12, 3, v11
    v_mad_u32_u24 v9, v12, 40, v11
    v_add_u32 v9, 32, v9
    s_lshl_b32 s3, s40, 4
    s_add_u32 s3, s3, s41
    s_lshl_b32 s4, s41, 3
    s_lshl_b32 s5, s44, 1
    s_add_u32 s5, s5, s4
    s_mul_i32 s76, s5, 20480
    s_add_u32 s76, s76, 2621440
    s_and_b32 s85, s43, 1
    s_add_u32 s5, s4, s43
    s_mul_i32 s99, s5, 40960
    s_add_u32 s99, s99, 1280
    s_sub_u32 s5, s5, s85
    s_mul_i32 s98, s5, 20480
    s_mul_i32 s5, s85, 10240
    s_add_u32 s98, s98, s5
    s_add_u32 s98, s98, 2621440
    s_mov_b32 s91, s98
    s_add_u32 s99, s99, s93
    s_lshl_b32 s4, s3, 2
    s_add_u32 s5, s4, s44
    s_lshl_b32 s5, s5, 7
    s_lshl_b32 s6, s42, 3
    s_add_u32 s5, s5, s6
    s_add_u32 s9, s5, 8388608
    s_lshr_b32 s5, s43, 1
    s_add_u32 s5, s5, s4
    s_lshl_b32 s5, s5, 7
    s_add_u32 s5, s5, 8388608
    s_add_u32 s83, s5, 64
    s_lshl_b32 s7, s85, 2
    s_add_u32 s84, s83, s6
    s_add_u32 s84, s84, s7
    s_lshl_b32 s7, s85, 5
    s_add_u32 s8, s5, s7
    s_mov_b32 s94, 0x3fb8aa3b
    s_mov_b32 s95, 0x358637bd
    v_mov_b32 v80, s95
    v_mov_b32 v81, s95
    v_mov_b32 v82, s95
    v_mov_b32 v83, s95
    v_mov_b32 v84, 0
    v_and_b32 v11, 0x1ff, v0
    v_mul_u32_u24 v12, 6554, v11
    v_lshrrev_b32 v12, 16, v12
    v_mul_u32_u24 v13, 10, v12
    v_sub_u32 v11, v11, v13
    v_mul_u32_u24 v12, 1280, v12
    v_lshlrev_b32 v11, 4, v11
    v_add_u32 v90, v11, v12
    s_add_u32 s72, s43, 8
    s_cmp_ge_u32 s72, 10
    s_cselect_b32 s73, 81920, 0
    s_cselect_b32 s74, 10, 0
    s_sub_u32 s72, s72, s74
    s_lshl_b32 s72, s72, 6
    v_add_u32 v11, s72, v10
    v_mul_u32_u24 v12, 6554, v11
    v_lshrrev_b32 v12, 16, v12
    v_mul_u32_u24 v13, 10, v12
    v_sub_u32 v11, v11, v13
    v_mul_u32_u24 v12, 1280, v12
    v_lshlrev_b32 v11, 4, v11
    v_add3_u32 v91, v11, v12, s73
    s_lshl_b32 s72, s43, 6
    s_add_u32 s72, s72, 384
    s_mov_b32 s73, 81920
    v_add_u32 v11, s72, v10
    v_mul_u32_u24 v12, 6554, v11
    v_lshrrev_b32 v12, 16, v12
    v_mul_u32_u24 v13, 10, v12
    v_sub_u32 v11, v11, v13
    v_mul_u32_u24 v12, 1280, v12
    v_lshlrev_b32 v11, 4, v11
    v_add3_u32 v92, v11, v12, s73
    v_and_b32 v11, 7, v10
    v_lshlrev_b32 v11, 7, v11
    s_mul_i32 s3, s42, 2560
    s_add_u32 s3, s3, 0
    v_add_u32 v11, s3, v11
    v_bfe_u32 v12, v10, 3, 1
    v_mul_u32_u24 v12, 20480, v12
    v_add_u32 v11, v11, v12
    v_and_b32 v12, 1, v10
    v_lshlrev_b32 v12, 7, v12
    s_add_u32 s3, s3, 1024
    v_add_u32 v12, s3, v12
    v_bfe_u32 v13, v10, 1, 1
    v_mul_u32_u24 v13, 20480, v13
    v_add_u32 v12, v12, v13
    s_mov_b32 vcc_lo, 0xffff
    s_mov_b32 vcc_hi, 0x0
    v_cndmask_b32 v93, v12, v11, vcc
    v_mov_b32 v56, 0
    v_mov_b32 v57, 0xf149f2ca
    s_mov_b32 vcc_lo, 0x55505555
    s_mov_b32 vcc_hi, 0x50005500
    v_cndmask_b32 v16, v57, v56, vcc
    s_mov_b32 vcc_lo, 0x50000
    s_mov_b32 vcc_hi, 0x5550055
    v_cndmask_b32 v20, v57, v56, vcc
    v_mov_b32 v24, 0x3f803f80
    s_mov_b32 vcc_lo, 0xaaa0aaaa
    s_mov_b32 vcc_hi, 0xa000aa00
    v_cndmask_b32 v17, v57, v56, vcc
    s_mov_b32 vcc_lo, 0xa0000
    s_mov_b32 vcc_hi, 0xaaa00aa
    v_cndmask_b32 v21, v57, v56, vcc
    v_mov_b32 v25, 0x3f803f80
    s_mov_b32 vcc_lo, 0x55405554
    s_mov_b32 vcc_hi, 0x40005400
    v_cndmask_b32 v18, v57, v56, vcc
    s_mov_b32 vcc_lo, 0x150001
    s_mov_b32 vcc_hi, 0x15550155
    v_cndmask_b32 v22, v57, v56, vcc
    v_mov_b32 v26, 0x3f803f80
    s_mov_b32 vcc_lo, 0xaa80aaa8
    s_mov_b32 vcc_hi, 0x8000a800
    v_cndmask_b32 v19, v57, v56, vcc
    s_mov_b32 vcc_lo, 0x2a0002
    s_mov_b32 vcc_hi, 0x2aaa02aa
    v_cndmask_b32 v23, v57, v56, vcc
    v_mov_b32 v27, 0x3f803f80
    v_mov_b32 v57, 0xffff
    v_mov_b32 v58, 0xffff0000
    s_mov_b32 vcc_lo, 0xaaaaaaaa
    s_mov_b32 vcc_hi, 0xaaaaaaaa
    v_cndmask_b32 v57, v57, v58, vcc
    s_mov_b32 vcc_lo, 0xf0000
    s_mov_b32 vcc_hi, 0xfff00ff
    v_cndmask_b32 v28, v56, v57, vcc
    s_mov_b32 vcc_lo, 0x3f0003
    s_mov_b32 vcc_hi, 0x3fff03ff
    v_cndmask_b32 v29, v56, v57, vcc
    s_mov_b32 vcc_lo, 0xfff0ffff
    s_mov_b32 vcc_hi, 0xf000ff00
    v_cndmask_b32 v30, v56, v57, vcc
    s_mov_b32 vcc_lo, 0xffc0fffc
    s_mov_b32 vcc_hi, 0xc000fc00
    v_cndmask_b32 v31, v56, v57, vcc
    v_lshlrev_b32 v11, 4, v10
    v_add_u32 v11, 148480, v11
    ds_write_b128 v11, v[16:19] offset:0
    ds_write_b128 v11, v[20:23] offset:1024
    ds_write_b128 v11, v[24:27] offset:2048
    ds_write_b128 v11, v[28:31] offset:3072
    s_waitcnt lgkmcnt(0)
    s_add_u32 m0, s71, 37888
    s_nop 0
    buffer_load_dwordx4 v2, s[16:19], s51 offen lds
    s_add_u32 m0, s70, 53248
    s_nop 0
    buffer_load_dwordx4 v3, s[20:23], s61 offen lds
    s_add_u32 m0, s70, 61440
    s_nop 0
    buffer_load_dwordx4 v4, s[20:23], s61 offen lds
    s_add_u32 m0, s70, 69632
    s_nop 0
    buffer_load_dwordx4 v5, s[20:23], s61 offen lds
    s_cmp_eq_u32 s44, 3
    s_cbranch_scc1 L_gw4628
    s_waitcnt vmcnt(7)
    s_branch L_gx4628
L_gw4628:
    s_waitcnt vmcnt(12)
L_gx4628:
    s_barrier
    ds_read_b128 v[96:99], v6 offset:0
    ds_read_b128 v[100:103], v6 offset:2048
    ds_read_b64_tr_b16 v[56:57], v8 offset:16384
    ds_read_b64_tr_b16 v[58:59], v8 offset:17664
    ds_read_b64_tr_b16 v[60:61], v8 offset:16424
    ds_read_b64_tr_b16 v[62:63], v8 offset:17704
    ds_read_b64_tr_b16 v[64:65], v8 offset:26624
    ds_read_b64_tr_b16 v[66:67], v8 offset:27904
    ds_read_b64_tr_b16 v[68:69], v8 offset:26664
    ds_read_b64_tr_b16 v[70:71], v8 offset:27944
    ds_read_b64_tr_b16 v[72:73], v9 offset:16384
    ds_read_b64_tr_b16 v[74:75], v9 offset:17664
    s_waitcnt lgkmcnt(8)
    v_mfma_f32_16x16x32_bf16 v[16:19], v[56:59], v[96:99], 0
    v_mfma_f32_16x16x32_bf16 v[20:23], v[56:59], v[100:103], 0
    s_cmp_eq_u32 s43, 0
    s_cbranch_scc0 L_nl_10
    v_mov_b32 v84, 0
    buffer_load_dword v85, v84, s[36:39], 0 offen sc1
L_nl_10:
    ds_read_b128 v[104:107], v7 offset:0
    ds_read_b128 v[108:111], v7 offset:2048
    ds_read_b64_tr_b16 v[56:57], v8 offset:21504
    ds_read_b64_tr_b16 v[58:59], v8 offset:22784
    s_waitcnt lgkmcnt(10)
    s_add_u32 m0, s71, 73728
    v_mfma_f32_16x16x32_bf16 v[24:27], v[60:63], v[96:99], 0
    v_mfma_f32_16x16x32_bf16 v[28:31], v[60:63], v[100:103], 0
    buffer_load_dwordx4 v1, s[16:19], s52 offen lds
    ds_read_b64_tr_b16 v[60:61], v8 offset:21544
    ds_read_b64_tr_b16 v[62:63], v8 offset:22824
    s_waitcnt lgkmcnt(10)
    s_add_u32 m0, s71, 74752
    v_mfma_f32_16x16x32_bf16 v[32:35], v[96:99], v[64:67], 0
    v_mfma_f32_16x16x32_bf16 v[36:39], v[100:103], v[64:67], 0
    buffer_load_dwordx4 v2, s[16:19], s52 offen lds
    ds_read_b64_tr_b16 v[64:65], v8 offset:31744
    ds_read_b64_tr_b16 v[66:67], v8 offset:33024
    s_waitcnt lgkmcnt(10)
    s_add_u32 m0, s70, 90112
    v_mfma_f32_16x16x32_bf16 v[40:43], v[96:99], v[68:71], 0
    v_mfma_f32_16x16x32_bf16 v[44:47], v[100:103], v[68:71], 0
    buffer_load_dwordx4 v3, s[20:23], s62 offen lds
    ds_read_b64_tr_b16 v[68:69], v8 offset:31784
    ds_read_b64_tr_b16 v[70:71], v8 offset:33064
    s_waitcnt lgkmcnt(10)
    s_add_u32 m0, s70, 98304
    v_mfma_f32_16x16x32_bf16 v[48:51], v[72:75], v[96:99], 0
    v_mfma_f32_16x16x32_bf16 v[52:55], v[72:75], v[100:103], 0
    buffer_load_dwordx4 v4, s[20:23], s62 offen lds
    ds_read_b64_tr_b16 v[72:73], v9 offset:21504
    ds_read_b64_tr_b16 v[74:75], v9 offset:22784
    s_waitcnt lgkmcnt(8)
    s_add_u32 m0, s70, 106496
    v_mfma_f32_16x16x32_bf16 v[16:19], v[56:59], v[104:107], v[16:19]
    v_mfma_f32_16x16x32_bf16 v[20:23], v[56:59], v[108:111], v[20:23]
    buffer_load_dwordx4 v5, s[20:23], s62 offen lds
    s_waitcnt lgkmcnt(6)
    v_mfma_f32_16x16x32_bf16 v[24:27], v[60:63], v[104:107], v[24:27]
    v_mfma_f32_16x16x32_bf16 v[28:31], v[60:63], v[108:111], v[28:31]
    s_waitcnt lgkmcnt(4)
    v_mfma_f32_16x16x32_bf16 v[32:35], v[104:107], v[64:67], v[32:35]
    v_mfma_f32_16x16x32_bf16 v[36:39], v[108:111], v[64:67], v[36:39]
    v_add_u32 v6, 36864, v6
    v_add_u32 v7, 36864, v7
    v_add_u32 v8, 36864, v8
    v_add_u32 v9, 36864, v9
    s_cmp_eq_u32 s43, 0
    s_cbranch_scc1 L_gw4695
    s_waitcnt vmcnt(5)
    s_branch L_gx4695
L_gw4695:
    s_waitcnt vmcnt(6)
L_gx4695:
    s_barrier
    ds_read_b128 v[112:115], v6 offset:0
    ds_read_b128 v[116:119], v6 offset:2048
    ds_read_b64_tr_b16 v[56:57], v8 offset:16384
    ds_read_b64_tr_b16 v[58:59], v8 offset:17664
    ds_read_b64_tr_b16 v[60:61], v8 offset:16424
    ds_read_b64_tr_b16 v[62:63], v8 offset:17704
    ds_read_b64_tr_b16 v[64:65], v8 offset:26624
    ds_read_b64_tr_b16 v[66:67], v8 offset:27904
    s_waitcnt lgkmcnt(10)
    v_mfma_f32_16x16x32_bf16 v[40:43], v[104:107], v[68:71], v[40:43]
    v_mfma_f32_16x16x32_bf16 v[44:47], v[108:111], v[68:71], v[44:47]
    s_cmp_eq_u32 s43, 0
    s_cbranch_scc0 L_nc_10
    s_waitcnt vmcnt(5)
    v_readfirstlane_b32 s47, v85
    s_nop 0
    s_cmp_lg_u32 s47, 0
    s_cbranch_scc1 L_nok_10
    s_mov_b32 s92, 0
L_nsp_10:
    buffer_load_dword v85, v84, s[36:39], 0 offen sc1
    s_waitcnt vmcnt(0)
    v_readfirstlane_b32 s47, v85
    s_nop 0
    s_cmp_lg_u32 s47, 0
    s_cbranch_scc1 L_nok_10
    s_add_u32 s92, s92, 1
    s_cmp_lt_u32 s92, 200000
    s_cbranch_scc1 L_nsp_10
L_nok_10:
    s_lshl_b32 s3, s40, 4
    s_add_u32 s3, s3, s41
    s_lshl_b32 s3, s3, 3
    s_add_u32 s3, s3, s42
    s_lshl_b32 s3, s3, 7
    s_add_u32 s3, s3, 8454144
    s_or_b32 s4, s47, s46
    v_mov_b32 v85, s4
    s_mov_b64 exec, 1
    buffer_store_dword v85, v84, s[32:35], s3 offen sc1
    s_mov_b64 exec, -1
L_nc_10:
    ds_read_b64_tr_b16 v[68:69], v8 offset:26664
    ds_read_b64_tr_b16 v[70:71], v8 offset:27944
    s_waitcnt lgkmcnt(10)
    s_add_u32 m0, s71, 110592
    v_mfma_f32_16x16x32_bf16 v[48:51], v[72:75], v[104:107], v[48:51]
    v_mfma_f32_16x16x32_bf16 v[52:55], v[72:75], v[108:111], v[52:55]
    buffer_load_dwordx4 v1, s[16:19], s53 offen lds
    ds_read_b64_tr_b16 v[72:73], v9 offset:16384
    ds_read_b64_tr_b16 v[74:75], v9 offset:17664
    s_waitcnt lgkmcnt(8)
    s_add_u32 m0, s71, 111616
    v_mfma_f32_16x16x32_bf16 v[16:19], v[56:59], v[112:115], v[16:19]
    v_mfma_f32_16x16x32_bf16 v[20:23], v[56:59], v[116:119], v[20:23]
    buffer_load_dwordx4 v2, s[16:19], s53 offen lds
    ds_read_b128 v[120:123], v7 offset:0
    ds_read_b128 v[124:127], v7 offset:2048
    ds_read_b64_tr_b16 v[56:57], v8 offset:21504
    ds_read_b64_tr_b16 v[58:59], v8 offset:22784
    s_waitcnt lgkmcnt(10)
    s_add_u32 m0, s70, 126976
    v_mfma_f32_16x16x32_bf16 v[24:27], v[60:63], v[112:115], v[24:27]
    v_mfma_f32_16x16x32_bf16 v[28:31], v[60:63], v[116:119], v[28:31]
    buffer_load_dwordx4 v3, s[20:23], s63 offen lds
    ds_read_b64_tr_b16 v[60:61], v8 offset:21544
    ds_read_b64_tr_b16 v[62:63], v8 offset:22824
    s_waitcnt lgkmcnt(10)
    s_add_u32 m0, s70, 135168
    v_mfma_f32_16x16x32_bf16 v[32:35], v[112:115], v[64:67], v[32:35]
    v_mfma_f32_16x16x32_bf16 v[36:39], v[116:119], v[64:67], v[36:39]
    buffer_load_dwordx4 v4, s[20:23], s63 offen lds
    ds_read_b64_tr_b16 v[64:65], v8 offset:31744
    ds_read_b64_tr_b16 v[66:67], v8 offset:33024
    s_waitcnt lgkmcnt(10)
    s_add_u32 m0, s70, 143360
    v_mfma_f32_16x16x32_bf16 v[40:43], v[112:115], v[68:71], v[40:43]
    v_mfma_f32_16x16x32_bf16 v[44:47], v[116:119], v[68:71], v[44:47]
    buffer_load_dwordx4 v5, s[20:23], s63 offen lds
    ds_read_b64_tr_b16 v[68:69], v8 offset:31784
    ds_read_b64_tr_b16 v[70:71], v8 offset:33064
    s_waitcnt lgkmcnt(10)
    v_mfma_f32_16x16x32_bf16 v[48:51], v[72:75], v[112:115], v[48:51]
    v_mfma_f32_16x16x32_bf16 v[52:55], v[72:75], v[116:119], v[52:55]
    ds_read_b64_tr_b16 v[72:73], v9 offset:21504
    ds_read_b64_tr_b16 v[74:75], v9 offset:22784
    s_waitcnt lgkmcnt(8)
    v_mfma_f32_16x16x32_bf16 v[16:19], v[56:59], v[120:123], v[16:19]
    v_mfma_f32_16x16x32_bf16 v[20:23], v[56:59], v[124:127], v[20:23]
    s_waitcnt lgkmcnt(6)
    v_mfma_f32_16x16x32_bf16 v[24:27], v[60:63], v[120:123], v[24:27]
    v_mfma_f32_16x16x32_bf16 v[28:31], v[60:63], v[124:127], v[28:31]
    s_waitcnt lgkmcnt(4)
    v_mfma_f32_16x16x32_bf16 v[32:35], v[120:123], v[64:67], v[32:35]
    v_mfma_f32_16x16x32_bf16 v[36:39], v[124:127], v[64:67], v[36:39]
    v_add_u32 v6, 36864, v6
    v_add_u32 v7, 36864, v7
    v_add_u32 v8, 36864, v8
    v_add_u32 v9, 36864, v9
    s_cmp_eq_u32 s43, 0
    s_cbranch_scc1 L_gw4789
    s_waitcnt vmcnt(5)
    s_branch L_gx4789
L_gw4789:
    s_waitcnt vmcnt(6)
L_gx4789:
    s_barrier
    ds_read_b128 v[128:131], v6 offset:0
    ds_read_b128 v[132:135], v6 offset:2048
    ds_read_b64_tr_b16 v[56:57], v8 offset:16384
    ds_read_b64_tr_b16 v[58:59], v8 offset:17664
    ds_read_b64_tr_b16 v[60:61], v8 offset:16424
    ds_read_b64_tr_b16 v[62:63], v8 offset:17704
    ds_read_b64_tr_b16 v[64:65], v8 offset:26624
    ds_read_b64_tr_b16 v[66:67], v8 offset:27904
    s_waitcnt lgkmcnt(10)
    s_add_u32 m0, s71, 0
    v_mfma_f32_16x16x32_bf16 v[40:43], v[120:123], v[68:71], v[40:43]
    v_mfma_f32_16x16x32_bf16 v[44:47], v[124:127], v[68:71], v[44:47]
    buffer_load_dwordx4 v1, s[16:19], s54 offen lds
    ds_read_b64_tr_b16 v[68:69], v8 offset:26664
    ds_read_b64_tr_b16 v[70:71], v8 offset:27944
    s_waitcnt lgkmcnt(10)
    s_add_u32 m0, s71, 1024
    v_mfma_f32_16x16x32_bf16 v[48:51], v[72:75], v[120:123], v[48:51]
    v_mfma_f32_16x16x32_bf16 v[52:55], v[72:75], v[124:127], v[52:55]
    buffer_load_dwordx4 v2, s[16:19], s54 offen lds
    ds_read_b64_tr_b16 v[72:73], v9 offset:16384
    ds_read_b64_tr_b16 v[74:75], v9 offset:17664
    s_waitcnt lgkmcnt(8)
    s_add_u32 m0, s70, 16384
    v_mfma_f32_16x16x32_bf16 v[16:19], v[56:59], v[128:131], v[16:19]
    v_mfma_f32_16x16x32_bf16 v[20:23], v[56:59], v[132:135], v[20:23]
    buffer_load_dwordx4 v3, s[20:23], s64 offen lds
    ds_read_b128 v[136:139], v7 offset:0
    ds_read_b128 v[140:143], v7 offset:2048
    ds_read_b64_tr_b16 v[56:57], v8 offset:21504
    ds_read_b64_tr_b16 v[58:59], v8 offset:22784
    s_waitcnt lgkmcnt(10)
    s_add_u32 m0, s70, 24576
    v_mfma_f32_16x16x32_bf16 v[24:27], v[60:63], v[128:131], v[24:27]
    v_mfma_f32_16x16x32_bf16 v[28:31], v[60:63], v[132:135], v[28:31]
    buffer_load_dwordx4 v4, s[20:23], s64 offen lds
    ds_read_b64_tr_b16 v[60:61], v8 offset:21544
    ds_read_b64_tr_b16 v[62:63], v8 offset:22824
    s_waitcnt lgkmcnt(10)
    s_add_u32 m0, s70, 32768
    v_mfma_f32_16x16x32_bf16 v[32:35], v[128:131], v[64:67], v[32:35]
    v_mfma_f32_16x16x32_bf16 v[36:39], v[132:135], v[64:67], v[36:39]
    buffer_load_dwordx4 v5, s[20:23], s64 offen lds
    ds_read_b64_tr_b16 v[64:65], v8 offset:31744
    ds_read_b64_tr_b16 v[66:67], v8 offset:33024
    s_waitcnt lgkmcnt(10)
    v_mfma_f32_16x16x32_bf16 v[40:43], v[128:131], v[68:71], v[40:43]
    v_mfma_f32_16x16x32_bf16 v[44:47], v[132:135], v[68:71], v[44:47]
    ds_read_b64_tr_b16 v[68:69], v8 offset:31784
    ds_read_b64_tr_b16 v[70:71], v8 offset:33064
    s_waitcnt lgkmcnt(10)
    v_mfma_f32_16x16x32_bf16 v[48:51], v[72:75], v[128:131], v[48:51]
    v_mfma_f32_16x16x32_bf16 v[52:55], v[72:75], v[132:135], v[52:55]
    ds_read_b64_tr_b16 v[72:73], v9 offset:21504
    ds_read_b64_tr_b16 v[74:75], v9 offset:22784
    s_waitcnt lgkmcnt(8)
    v_mfma_f32_16x16x32_bf16 v[16:19], v[56:59], v[136:139], v[16:19]
    v_mfma_f32_16x16x32_bf16 v[20:23], v[56:59], v[140:143], v[20:23]
    s_waitcnt lgkmcnt(6)
    v_mfma_f32_16x16x32_bf16 v[24:27], v[60:63], v[136:139], v[24:27]
    v_mfma_f32_16x16x32_bf16 v[28:31], v[60:63], v[140:143], v[28:31]
    s_waitcnt lgkmcnt(4)
    v_mfma_f32_16x16x32_bf16 v[32:35], v[136:139], v[64:67], v[32:35]
    v_mfma_f32_16x16x32_bf16 v[36:39], v[140:143], v[64:67], v[36:39]
    v_add_u32 v6, 36864, v6
    v_add_u32 v7, 36864, v7
    v_add_u32 v8, 36864, v8
    v_add_u32 v9, 36864, v9
    s_waitcnt vmcnt(5)
    s_barrier
    ds_read_b128 v[144:147], v6 offset:0
    ds_read_b128 v[148:151], v6 offset:2048
    ds_read_b64_tr_b16 v[56:57], v8 offset:16384
    ds_read_b64_tr_b16 v[58:59], v8 offset:17664
    ds_read_b64_tr_b16 v[60:61], v8 offset:16424
    ds_read_b64_tr_b16 v[62:63], v8 offset:17704
    ds_read_b64_tr_b16 v[64:65], v8 offset:26624
    ds_read_b64_tr_b16 v[66:67], v8 offset:27904
    s_waitcnt lgkmcnt(10)
    s_add_u32 m0, s71, 36864
    v_mfma_f32_16x16x32_bf16 v[40:43], v[136:139], v[68:71], v[40:43]
    v_mfma_f32_16x16x32_bf16 v[44:47], v[140:143], v[68:71], v[44:47]
    buffer_load_dwordx4 v1, s[16:19], s55 offen lds
    ds_read_b64_tr_b16 v[68:69], v8 offset:26664
    ds_read_b64_tr_b16 v[70:71], v8 offset:27944
    s_waitcnt lgkmcnt(10)
    s_add_u32 m0, s71, 37888
    v_mfma_f32_16x16x32_bf16 v[48:51], v[72:75], v[136:139], v[48:51]
    v_mfma_f32_16x16x32_bf16 v[52:55], v[72:75], v[140:143], v[52:55]
    buffer_load_dwordx4 v2, s[16:19], s55 offen lds
    ds_read_b64_tr_b16 v[72:73], v9 offset:16384
    ds_read_b64_tr_b16 v[74:75], v9 offset:17664
    s_waitcnt lgkmcnt(8)
    s_add_u32 m0, s70, 53248
    v_mfma_f32_16x16x32_bf16 v[16:19], v[56:59], v[144:147], v[16:19]
    v_mfma_f32_16x16x32_bf16 v[20:23], v[56:59], v[148:151], v[20:23]
    buffer_load_dwordx4 v3, s[20:23], s65 offen lds
    ds_read_b128 v[152:155], v7 offset:0
    ds_read_b128 v[156:159], v7 offset:2048
    ds_read_b64_tr_b16 v[56:57], v8 offset:21504
    ds_read_b64_tr_b16 v[58:59], v8 offset:22784
    s_waitcnt lgkmcnt(10)
    s_add_u32 m0, s70, 61440
    v_mfma_f32_16x16x32_bf16 v[24:27], v[60:63], v[144:147], v[24:27]
    v_mfma_f32_16x16x32_bf16 v[28:31], v[60:63], v[148:151], v[28:31]
    buffer_load_dwordx4 v4, s[20:23], s65 offen lds
    ds_read_b64_tr_b16 v[60:61], v8 offset:21544
    ds_read_b64_tr_b16 v[62:63], v8 offset:22824
    s_waitcnt lgkmcnt(10)
    s_add_u32 m0, s70, 69632
    v_mfma_f32_16x16x32_bf16 v[32:35], v[144:147], v[64:67], v[32:35]
    v_mfma_f32_16x16x32_bf16 v[36:39], v[148:151], v[64:67], v[36:39]
    buffer_load_dwordx4 v5, s[20:23], s65 offen lds
    ds_read_b64_tr_b16 v[64:65], v8 offset:31744
    ds_read_b64_tr_b16 v[66:67], v8 offset:33024
    s_waitcnt lgkmcnt(10)
    v_mfma_f32_16x16x32_bf16 v[40:43], v[144:147], v[68:71], v[40:43]
    v_mfma_f32_16x16x32_bf16 v[44:47], v[148:151], v[68:71], v[44:47]
    s_lshl_b32 s3, s41, 3
    s_add_u32 s3, s3, s42
    s_mul_i32 s3, s3, 50
    s_mul_i32 s6, s44, 13
    s_add_u32 s3, s3, s6
    v_add_u32 v86, s3, v10
    v_mul_u32_u24 v87, 52429, v86
    v_lshrrev_b32 v87, 19, v87
    v_mul_u32_u24 v88, 10, v87
    v_sub_u32 v86, v86, v88
    v_lshlrev_b32 v86, 7, v86
    v_mul_u32_u24 v87, 3840, v87
    v_add_u32 v86, v86, v87
    s_mov_b64 exec, 8191
    buffer_load_dword v95, v86, s[20:23], 0 offen
    s_mov_b64 exec, -1
    ds_read_b64_tr_b16 v[68:69], v8 offset:31784
    ds_read_b64_tr_b16 v[70:71], v8 offset:33064
    s_waitcnt lgkmcnt(10)
    v_mfma_f32_16x16x32_bf16 v[48:51], v[72:75], v[144:147], v[48:51]
    v_mfma_f32_16x16x32_bf16 v[52:55], v[72:75], v[148:151], v[52:55]
    ds_read_b64_tr_b16 v[72:73], v9 offset:21504
    ds_read_b64_tr_b16 v[74:75], v9 offset:22784
    s_waitcnt lgkmcnt(8)
    v_mfma_f32_16x16x32_bf16 v[16:19], v[56:59], v[152:155], v[16:19]
    v_mfma_f32_16x16x32_bf16 v[20:23], v[56:59], v[156:159], v[20:23]
    s_waitcnt lgkmcnt(6)
    v_mfma_f32_16x16x32_bf16 v[24:27], v[60:63], v[152:155], v[24:27]
    v_mfma_f32_16x16x32_bf16 v[28:31], v[60:63], v[156:159], v[28:31]
    s_waitcnt lgkmcnt(4)
    v_mfma_f32_16x16x32_bf16 v[32:35], v[152:155], v[64:67], v[32:35]
    v_mfma_f32_16x16x32_bf16 v[36:39], v[156:159], v[64:67], v[36:39]
    v_add_u32 v6, -110592, v6
    v_add_u32 v7, -110592, v7
    v_add_u32 v8, -110592, v8
    v_add_u32 v9, -110592, v9
    s_waitcnt vmcnt(6)
    s_barrier
    ds_read_b128 v[160:163], v6 offset:0
    ds_read_b128 v[164:167], v6 offset:2048
    ds_read_b64_tr_b16 v[56:57], v8 offset:16384
    ds_read_b64_tr_b16 v[58:59], v8 offset:17664
    ds_read_b64_tr_b16 v[60:61], v8 offset:16424
    ds_read_b64_tr_b16 v[62:63], v8 offset:17704
    ds_read_b64_tr_b16 v[64:65], v8 offset:26624
    ds_read_b64_tr_b16 v[66:67], v8 offset:27904
    s_waitcnt lgkmcnt(10)
    v_mfma_f32_16x16x32_bf16 v[40:43], v[152:155], v[68:71], v[40:43]
    v_mfma_f32_16x16x32_bf16 v[44:47], v[156:159], v[68:71], v[44:47]
    s_cmp_eq_u32 s43, 0
    s_cbranch_scc0 L_rl_10
    s_lshl_b32 s3, s40, 4
    s_add_u32 s4, s3, s41
    s_lshl_b32 s4, s4, 3
    v_add_u32 v84, s4, v10
    s_max_u32 s5, s41, 1
    s_sub_u32 s5, s5, 1
    s_add_u32 s5, s5, s3
    s_lshl_b32 s5, s5, 3
    s_add_u32 s5, s5, s42
    v_mov_b32 v85, s5
    s_mov_b32 s80, 0xff
    s_mov_b32 s81, 0x0
    v_cndmask_b32_e64 v84, v85, v84, s[80:81]
    v_lshlrev_b32 v84, 7, v84
    s_mov_b32 s3, 8454144
    s_mov_b64 exec, 511
    buffer_load_dword v85, v84, s[32:35], s3 offen sc1
    s_mov_b64 exec, -1
L_rl_10:
    ds_read_b64_tr_b16 v[68:69], v8 offset:26664
    ds_read_b64_tr_b16 v[70:71], v8 offset:27944
    s_waitcnt lgkmcnt(10)
    s_add_u32 m0, s71, 73728
    v_mfma_f32_16x16x32_bf16 v[48:51], v[72:75], v[152:155], v[48:51]
    v_mfma_f32_16x16x32_bf16 v[52:55], v[72:75], v[156:159], v[52:55]
    buffer_load_dwordx4 v1, s[16:19], s56 offen lds
    ds_read_b64_tr_b16 v[72:73], v9 offset:16384
    ds_read_b64_tr_b16 v[74:75], v9 offset:17664
    s_waitcnt lgkmcnt(8)
    s_add_u32 m0, s71, 74752
    v_mfma_f32_16x16x32_bf16 v[16:19], v[56:59], v[160:163], v[16:19]
    v_mfma_f32_16x16x32_bf16 v[20:23], v[56:59], v[164:167], v[20:23]
    buffer_load_dwordx4 v2, s[16:19], s56 offen lds
    ds_read_b128 v[168:171], v7 offset:0
    ds_read_b128 v[172:175], v7 offset:2048
    ds_read_b64_tr_b16 v[56:57], v8 offset:21504
    ds_read_b64_tr_b16 v[58:59], v8 offset:22784
    s_waitcnt lgkmcnt(10)
    s_add_u32 m0, s70, 90112
    v_mfma_f32_16x16x32_bf16 v[24:27], v[60:63], v[160:163], v[24:27]
    v_mfma_f32_16x16x32_bf16 v[28:31], v[60:63], v[164:167], v[28:31]
    buffer_load_dwordx4 v3, s[20:23], s66 offen lds
    ds_read_b64_tr_b16 v[60:61], v8 offset:21544
    ds_read_b64_tr_b16 v[62:63], v8 offset:22824
    s_waitcnt lgkmcnt(10)
    s_add_u32 m0, s70, 98304
    v_mfma_f32_16x16x32_bf16 v[32:35], v[160:163], v[64:67], v[32:35]
    v_mfma_f32_16x16x32_bf16 v[36:39], v[164:167], v[64:67], v[36:39]
    buffer_load_dwordx4 v4, s[20:23], s66 offen lds
    ds_read_b64_tr_b16 v[64:65], v8 offset:31744
    ds_read_b64_tr_b16 v[66:67], v8 offset:33024
    s_waitcnt lgkmcnt(10)
    s_add_u32 m0, s70, 106496
    v_mfma_f32_16x16x32_bf16 v[40:43], v[160:163], v[68:71], v[40:43]
    v_mfma_f32_16x16x32_bf16 v[44:47], v[164:167], v[68:71], v[44:47]
    buffer_load_dwordx4 v5, s[20:23], s66 offen lds
    ds_read_b64_tr_b16 v[68:69], v8 offset:31784
    ds_read_b64_tr_b16 v[70:71], v8 offset:33064
    s_waitcnt lgkmcnt(10)
    v_mfma_f32_16x16x32_bf16 v[48:51], v[72:75], v[160:163], v[48:51]
    v_mfma_f32_16x16x32_bf16 v[52:55], v[72:75], v[164:167], v[52:55]
    ds_read_b64_tr_b16 v[72:73], v9 offset:21504
    ds_read_b64_tr_b16 v[74:75], v9 offset:22784
    s_waitcnt lgkmcnt(8)
    v_mfma_f32_16x16x32_bf16 v[16:19], v[56:59], v[168:171], v[16:19]
    v_mfma_f32_16x16x32_bf16 v[20:23], v[56:59], v[172:175], v[20:23]
    s_waitcnt lgkmcnt(6)
    v_mfma_f32_16x16x32_bf16 v[24:27], v[60:63], v[168:171], v[24:27]
    v_mfma_f32_16x16x32_bf16 v[28:31], v[60:63], v[172:175], v[28:31]
    s_waitcnt lgkmcnt(4)
    v_mfma_f32_16x16x32_bf16 v[32:35], v[168:171], v[64:67], v[32:35]
    v_mfma_f32_16x16x32_bf16 v[36:39], v[172:175], v[64:67], v[36:39]
    v_add_u32 v6, 36864, v6
    v_add_u32 v7, 36864, v7
    v_add_u32 v8, 36864, v8
    v_add_u32 v9, 36864, v9
    s_cmp_eq_u32 s43, 0
    s_cbranch_scc1 L_gw5024
    s_waitcnt vmcnt(6)
    s_branch L_gx5024
L_gw5024:
    s_waitcnt vmcnt(7)
L_gx5024:
    s_barrier
    ds_read_b128 v[176:179], v6 offset:0
    ds_read_b128 v[180:183], v6 offset:2048
    ds_read_b64_tr_b16 v[56:57], v8 offset:16384
    ds_read_b64_tr_b16 v[58:59], v8 offset:17664
    ds_read_b64_tr_b16 v[60:61], v8 offset:16424
    ds_read_b64_tr_b16 v[62:63], v8 offset:17704
    ds_read_b64_tr_b16 v[64:65], v8 offset:26624
    ds_read_b64_tr_b16 v[66:67], v8 offset:27904
    s_waitcnt lgkmcnt(10)
    s_add_u32 m0, s71, 110592
    v_mfma_f32_16x16x32_bf16 v[40:43], v[168:171], v[68:71], v[40:43]
    v_mfma_f32_16x16x32_bf16 v[44:47], v[172:175], v[68:71], v[44:47]
    buffer_load_dwordx4 v1, s[16:19], s57 offen lds
    ds_read_b64_tr_b16 v[68:69], v8 offset:26664
    ds_read_b64_tr_b16 v[70:71], v8 offset:27944
    s_waitcnt lgkmcnt(10)
    s_add_u32 m0, s71, 111616
    v_mfma_f32_16x16x32_bf16 v[48:51], v[72:75], v[168:171], v[48:51]
    v_mfma_f32_16x16x32_bf16 v[52:55], v[72:75], v[172:175], v[52:55]
    buffer_load_dwordx4 v2, s[16:19], s57 offen lds
    ds_read_b64_tr_b16 v[72:73], v9 offset:16384
    ds_read_b64_tr_b16 v[74:75], v9 offset:17664
    s_waitcnt lgkmcnt(8)
    s_add_u32 m0, s70, 126976
    v_mfma_f32_16x16x32_bf16 v[16:19], v[56:59], v[176:179], v[16:19]
    v_mfma_f32_16x16x32_bf16 v[20:23], v[56:59], v[180:183], v[20:23]
    buffer_load_dwordx4 v3, s[20:23], s67 offen lds
    ds_read_b128 v[184:187], v7 offset:0
    ds_read_b128 v[188:191], v7 offset:2048
    ds_read_b64_tr_b16 v[56:57], v8 offset:21504
    ds_read_b64_tr_b16 v[58:59], v8 offset:22784
    s_waitcnt lgkmcnt(10)
    s_add_u32 m0, s70, 135168
    v_mfma_f32_16x16x32_bf16 v[24:27], v[60:63], v[176:179], v[24:27]
    v_mfma_f32_16x16x32_bf16 v[28:31], v[60:63], v[180:183], v[28:31]
    buffer_load_dwordx4 v4, s[20:23], s67 offen lds
    ds_read_b64_tr_b16 v[60:61], v8 offset:21544
    ds_read_b64_tr_b16 v[62:63], v8 offset:22824
    s_waitcnt lgkmcnt(10)
    s_add_u32 m0, s70, 143360
    v_mfma_f32_16x16x32_bf16 v[32:35], v[176:179], v[64:67], v[32:35]
    v_mfma_f32_16x16x32_bf16 v[36:39], v[180:183], v[64:67], v[36:39]
    buffer_load_dwordx4 v5, s[20:23], s67 offen lds
    ds_read_b64_tr_b16 v[64:65], v8 offset:31744
    ds_read_b64_tr_b16 v[66:67], v8 offset:33024
    s_waitcnt lgkmcnt(10)
    v_mfma_f32_16x16x32_bf16 v[40:43], v[176:179], v[68:71], v[40:43]
    v_mfma_f32_16x16x32_bf16 v[44:47], v[180:183], v[68:71], v[44:47]
    ds_read_b64_tr_b16 v[68:69], v8 offset:31784
    ds_read_b64_tr_b16 v[70:71], v8 offset:33064
    s_waitcnt lgkmcnt(10)
    v_mfma_f32_16x16x32_bf16 v[48:51], v[72:75], v[176:179], v[48:51]
    v_mfma_f32_16x16x32_bf16 v[52:55], v[72:75], v[180:183], v[52:55]
    ds_read_b64_tr_b16 v[72:73], v9 offset:21504
    ds_read_b64_tr_b16 v[74:75], v9 offset:22784
    s_waitcnt lgkmcnt(8)
    v_mfma_f32_16x16x32_bf16 v[16:19], v[56:59], v[184:187], v[16:19]
    v_mfma_f32_16x16x32_bf16 v[20:23], v[56:59], v[188:191], v[20:23]
    s_waitcnt lgkmcnt(6)
    v_mfma_f32_16x16x32_bf16 v[24:27], v[60:63], v[184:187], v[24:27]
    v_mfma_f32_16x16x32_bf16 v[28:31], v[60:63], v[188:191], v[28:31]
    s_waitcnt lgkmcnt(4)
    v_mfma_f32_16x16x32_bf16 v[32:35], v[184:187], v[64:67], v[32:35]
    v_mfma_f32_16x16x32_bf16 v[36:39], v[188:191], v[64:67], v[36:39]
    v_add_u32 v6, 36864, v6
    v_add_u32 v7, 36864, v7
    v_add_u32 v8, 36864, v8
    v_add_u32 v9, 36864, v9
    s_waitcnt vmcnt(5)
    s_barrier
    ds_read_b128 v[192:195], v6 offset:0
    ds_read_b128 v[196:199], v6 offset:2048
    ds_read_b64_tr_b16 v[56:57], v8 offset:16384
    ds_read_b64_tr_b16 v[58:59], v8 offset:17664
    ds_read_b64_tr_b16 v[60:61], v8 offset:16424
    ds_read_b64_tr_b16 v[62:63], v8 offset:17704
    ds_read_b64_tr_b16 v[64:65], v8 offset:26624
    ds_read_b64_tr_b16 v[66:67], v8 offset:27904
    s_waitcnt lgkmcnt(10)
    v_mfma_f32_16x16x32_bf16 v[40:43], v[184:187], v[68:71], v[40:43]
    v_mfma_f32_16x16x32_bf16 v[44:47], v[188:191], v[68:71], v[44:47]
    s_cmp_eq_u32 s43, 0
    s_cbranch_scc0 L_rc_10
    v_and_b32 v86, -8, v85
    s_mov_b64 exec, 511
    v_cmp_ne_u32 vcc, s47, v86
    s_mov_b64 exec, -1
    s_cbranch_vccz L_rok_10
    s_mov_b32 s92, 0
L_rsp_10:
    s_mov_b32 s3, 8454144
    s_mov_b64 exec, 511
    buffer_load_dword v85, v84, s[32:35], s3 offen sc1
    s_waitcnt vmcnt(0)
    v_and_b32 v86, -8, v85
    s_mov_b64 exec, 511
    v_cmp_ne_u32 vcc, s47, v86
    s_mov_b64 exec, -1
    s_cbranch_vccz L_rok_10
    s_add_u32 s92, s92, 1
    s_cmp_lt_u32 s92, 200000
    s_cbranch_scc1 L_rsp_10
L_rok_10:
    s_or_b32 s3, s47, s46
    s_mov_b64 exec, 0xff
    v_cmp_ne_u32 vcc, s3, v85
    s_mov_b64 exec, -1
    s_cmp_eq_u32 vcc_lo, 0
    s_cselect_b32 s3, 1, 0
    s_or_b32 s3, s3, s47
    v_mov_b32 v85, s3
    v_mov_b32 v84, 147520
    ds_write_b32 v84, v85
L_rc_10:
    ds_read_b64_tr_b16 v[68:69], v8 offset:26664
    ds_read_b64_tr_b16 v[70:71], v8 offset:27944
    s_waitcnt lgkmcnt(10)
    s_add_u32 m0, s71, 0
    v_mfma_f32_16x16x32_bf16 v[48:51], v[72:75], v[184:187], v[48:51]
    v_mfma_f32_16x16x32_bf16 v[52:55], v[72:75], v[188:191], v[52:55]
    buffer_load_dwordx4 v1, s[16:19], s58 offen lds
    ds_read_b64_tr_b16 v[72:73], v9 offset:16384
    ds_read_b64_tr_b16 v[74:75], v9 offset:17664
    s_waitcnt lgkmcnt(8)
    s_add_u32 m0, s71, 1024
    v_mfma_f32_16x16x32_bf16 v[16:19], v[56:59], v[192:195], v[16:19]
    v_mfma_f32_16x16x32_bf16 v[20:23], v[56:59], v[196:199], v[20:23]
    buffer_load_dwordx4 v2, s[16:19], s58 offen lds
    ds_read_b128 v[200:203], v7 offset:0
    ds_read_b128 v[204:207], v7 offset:2048
    ds_read_b64_tr_b16 v[56:57], v8 offset:21504
    ds_read_b64_tr_b16 v[58:59], v8 offset:22784
    s_waitcnt lgkmcnt(10)
    s_add_u32 m0, s70, 16384
    v_mfma_f32_16x16x32_bf16 v[24:27], v[60:63], v[192:195], v[24:27]
    v_mfma_f32_16x16x32_bf16 v[28:31], v[60:63], v[196:199], v[28:31]
    buffer_load_dwordx4 v3, s[20:23], s68 offen lds
    ds_read_b64_tr_b16 v[60:61], v8 offset:21544
    ds_read_b64_tr_b16 v[62:63], v8 offset:22824
    s_waitcnt lgkmcnt(10)
    s_add_u32 m0, s70, 24576
    v_mfma_f32_16x16x32_bf16 v[32:35], v[192:195], v[64:67], v[32:35]
    v_mfma_f32_16x16x32_bf16 v[36:39], v[196:199], v[64:67], v[36:39]
    buffer_load_dwordx4 v4, s[20:23], s68 offen lds
    ds_read_b64_tr_b16 v[64:65], v8 offset:31744
    ds_read_b64_tr_b16 v[66:67], v8 offset:33024
    s_waitcnt lgkmcnt(10)
    s_add_u32 m0, s70, 32768
    v_mfma_f32_16x16x32_bf16 v[40:43], v[192:195], v[68:71], v[40:43]
    v_mfma_f32_16x16x32_bf16 v[44:47], v[196:199], v[68:71], v[44:47]
    buffer_load_dwordx4 v5, s[20:23], s68 offen lds
    ds_read_b64_tr_b16 v[68:69], v8 offset:31784
    ds_read_b64_tr_b16 v[70:71], v8 offset:33064
    s_waitcnt lgkmcnt(10)
    v_mfma_f32_16x16x32_bf16 v[48:51], v[72:75], v[192:195], v[48:51]
    v_mfma_f32_16x16x32_bf16 v[52:55], v[72:75], v[196:199], v[52:55]
    ds_read_b64_tr_b16 v[72:73], v9 offset:21504
    ds_read_b64_tr_b16 v[74:75], v9 offset:22784
    s_waitcnt lgkmcnt(8)
    v_mfma_f32_16x16x32_bf16 v[16:19], v[56:59], v[200:203], v[16:19]
    v_mfma_f32_16x16x32_bf16 v[20:23], v[56:59], v[204:207], v[20:23]
    s_waitcnt lgkmcnt(6)
    v_mfma_f32_16x16x32_bf16 v[24:27], v[60:63], v[200:203], v[24:27]
    v_mfma_f32_16x16x32_bf16 v[28:31], v[60:63], v[204:207], v[28:31]
    s_waitcnt lgkmcnt(4)
    v_mfma_f32_16x16x32_bf16 v[32:35], v[200:203], v[64:67], v[32:35]
    v_mfma_f32_16x16x32_bf16 v[36:39], v[204:207], v[64:67], v[36:39]
    v_add_u32 v6, 36864, v6
    v_add_u32 v7, 36864, v7
    v_add_u32 v8, 36864, v8
    v_add_u32 v9, 36864, v9
    s_waitcnt vmcnt(5)
    s_barrier
    ds_read_b128 v[208:211], v6 offset:0
    ds_read_b128 v[212:215], v6 offset:2048
    ds_read_b64_tr_b16 v[56:57], v8 offset:16384
    ds_read_b64_tr_b16 v[58:59], v8 offset:17664
    ds_read_b64_tr_b16 v[60:61], v8 offset:16424
    ds_read_b64_tr_b16 v[62:63], v8 offset:17704
    ds_read_b64_tr_b16 v[64:65], v8 offset:26624
    ds_read_b64_tr_b16 v[66:67], v8 offset:27904
    s_waitcnt lgkmcnt(10)
    v_mfma_f32_16x16x32_bf16 v[40:43], v[200:203], v[68:71], v[40:43]
    v_mfma_f32_16x16x32_bf16 v[44:47], v[204:207], v[68:71], v[44:47]
    v_mov_b32 v84, 147520
    ds_read_b32 v85, v84
    ds_read_b64_tr_b16 v[68:69], v8 offset:26664
    ds_read_b64_tr_b16 v[70:71], v8 offset:27944
    s_waitcnt lgkmcnt(11)
    s_add_u32 m0, s71, 36864
    v_mfma_f32_16x16x32_bf16 v[48:51], v[72:75], v[200:203], v[48:51]
    v_mfma_f32_16x16x32_bf16 v[52:55], v[72:75], v[204:207], v[52:55]
    buffer_load_dwordx4 v1, s[16:19], s59 offen lds
    ds_read_b64_tr_b16 v[72:73], v9 offset:16384
    ds_read_b64_tr_b16 v[74:75], v9 offset:17664
    s_waitcnt lgkmcnt(9)
    s_add_u32 m0, s71, 37888
    v_mfma_f32_16x16x32_bf16 v[16:19], v[56:59], v[208:211], v[16:19]
    v_mfma_f32_16x16x32_bf16 v[20:23], v[56:59], v[212:215], v[20:23]
    buffer_load_dwordx4 v2, s[16:19], s59 offen lds
    ds_read_b128 v[216:219], v7 offset:0
    ds_read_b128 v[220:223], v7 offset:2048
    ds_read_b64_tr_b16 v[56:57], v8 offset:21504
    ds_read_b64_tr_b16 v[58:59], v8 offset:22784
    s_waitcnt lgkmcnt(11)
    s_add_u32 m0, s70, 53248
    v_mfma_f32_16x16x32_bf16 v[24:27], v[60:63], v[208:211], v[24:27]
    v_mfma_f32_16x16x32_bf16 v[28:31], v[60:63], v[212:215], v[28:31]
    buffer_load_dwordx4 v3, s[20:23], s69 offen lds
    ds_read_b64_tr_b16 v[60:61], v8 offset:21544
    ds_read_b64_tr_b16 v[62:63], v8 offset:22824
    s_waitcnt lgkmcnt(11)
    s_add_u32 m0, s70, 61440
    v_mfma_f32_16x16x32_bf16 v[32:35], v[208:211], v[64:67], v[32:35]
    v_mfma_f32_16x16x32_bf16 v[36:39], v[212:215], v[64:67], v[36:39]
    buffer_load_dwordx4 v4, s[20:23], s69 offen lds
    ds_read_b64_tr_b16 v[64:65], v8 offset:31744
    ds_read_b64_tr_b16 v[66:67], v8 offset:33024
    s_waitcnt lgkmcnt(10)
    s_add_u32 m0, s70, 69632
    v_mfma_f32_16x16x32_bf16 v[40:43], v[208:211], v[68:71], v[40:43]
    v_mfma_f32_16x16x32_bf16 v[44:47], v[212:215], v[68:71], v[44:47]
    buffer_load_dwordx4 v5, s[20:23], s69 offen lds
    ds_read_b64_tr_b16 v[68:69], v8 offset:31784
    ds_read_b64_tr_b16 v[70:71], v8 offset:33064
    s_waitcnt lgkmcnt(10)
    v_mfma_f32_16x16x32_bf16 v[48:51], v[72:75], v[208:211], v[48:51]
    v_mfma_f32_16x16x32_bf16 v[52:55], v[72:75], v[212:215], v[52:55]
    v_readfirstlane_b32 s3, v85
    s_nop 0
    s_and_b32 s48, s3, 1
    s_andn2_b32 s47, s3, 7
    ds_read_b64_tr_b16 v[72:73], v9 offset:21504
    ds_read_b64_tr_b16 v[74:75], v9 offset:22784
    s_waitcnt lgkmcnt(8)
    v_mfma_f32_16x16x32_bf16 v[16:19], v[56:59], v[216:219], v[16:19]
    v_mfma_f32_16x16x32_bf16 v[20:23], v[56:59], v[220:223], v[20:23]
    s_waitcnt lgkmcnt(6)
    v_mfma_f32_16x16x32_bf16 v[24:27], v[60:63], v[216:219], v[24:27]
    v_mfma_f32_16x16x32_bf16 v[28:31], v[60:63], v[220:223], v[28:31]
    s_waitcnt lgkmcnt(4)
    v_mfma_f32_16x16x32_bf16 v[32:35], v[216:219], v[64:67], v[32:35]
    v_mfma_f32_16x16x32_bf16 v[36:39], v[220:223], v[64:67], v[36:39]
    v_add_u32 v6, -110592, v6
    v_add_u32 v7, -110592, v7
    v_add_u32 v8, -110592, v8
    v_add_u32 v9, -110592, v9
    s_waitcnt vmcnt(5)
    s_barrier
    ds_read_b128 v[224:227], v6 offset:0
    ds_read_b128 v[228:231], v6 offset:2048
    ds_read_b64_tr_b16 v[56:57], v8 offset:16384
    ds_read_b64_tr_b16 v[58:59], v8 offset:17664
    ds_read_b64_tr_b16 v[60:61], v8 offset:16424
    ds_read_b64_tr_b16 v[62:63], v8 offset:17704
    ds_read_b64_tr_b16 v[64:65], v8 offset:26624
    ds_read_b64_tr_b16 v[66:67], v8 offset:27904
    s_waitcnt lgkmcnt(10)
    v_mfma_f32_16x16x32_bf16 v[40:43], v[216:219], v[68:71], v[40:43]
    v_mfma_f32_16x16x32_bf16 v[44:47], v[220:223], v[68:71], v[44:47]
    ds_read_b64_tr_b16 v[68:69], v8 offset:26664
    ds_read_b64_tr_b16 v[70:71], v8 offset:27944
    s_waitcnt lgkmcnt(10)
    v_mfma_f32_16x16x32_bf16 v[48:51], v[72:75], v[216:219], v[48:51]
    v_mfma_f32_16x16x32_bf16 v[52:55], v[72:75], v[220:223], v[52:55]
    s_cmp_lt_u32 s43, 2
    s_cselect_b32 s3, 0, 1280
    v_subrev_u32 v4, s3, v4
    v_subrev_u32 v5, 1280, v5
    ds_read_b64_tr_b16 v[72:73], v9 offset:16384
    ds_read_b64_tr_b16 v[74:75], v9 offset:17664
    s_waitcnt lgkmcnt(8)
    v_mfma_f32_16x16x32_bf16 v[16:19], v[56:59], v[224:227], v[16:19]
    v_mfma_f32_16x16x32_bf16 v[20:23], v[56:59], v[228:231], v[20:23]
    ds_read_b128 v[232:235], v7 offset:0
    ds_read_b128 v[236:239], v7 offset:2048
    ds_read_b64_tr_b16 v[56:57], v8 offset:21504
    ds_read_b64_tr_b16 v[58:59], v8 offset:22784
    s_waitcnt lgkmcnt(10)
    s_sub_u32 s75, s60, 1280
    s_add_u32 m0, s70, 81920
    v_mfma_f32_16x16x32_bf16 v[24:27], v[60:63], v[224:227], v[24:27]
    v_mfma_f32_16x16x32_bf16 v[28:31], v[60:63], v[228:231], v[28:31]
    buffer_load_dwordx4 v3, s[20:23], s75 offen lds
    ds_read_b64_tr_b16 v[60:61], v8 offset:21544
    ds_read_b64_tr_b16 v[62:63], v8 offset:22824
    s_waitcnt lgkmcnt(10)
    v_mfma_f32_16x16x32_bf16 v[32:35], v[224:227], v[64:67], v[32:35]
    v_mfma_f32_16x16x32_bf16 v[36:39], v[228:231], v[64:67], v[36:39]
    ds_read_b64_tr_b16 v[64:65], v8 offset:31744
    ds_read_b64_tr_b16 v[66:67], v8 offset:33024
    s_waitcnt lgkmcnt(10)
    s_cmp_lt_u32 s43, 2
    s_cselect_b32 s75, s60, s61
    s_sub_u32 s75, s75, 1280
    s_add_u32 m0, s70, 90112
    v_mfma_f32_16x16x32_bf16 v[40:43], v[224:227], v[68:71], v[40:43]
    v_mfma_f32_16x16x32_bf16 v[44:47], v[228:231], v[68:71], v[44:47]
    buffer_load_dwordx4 v4, s[20:23], s75 offen lds
    ds_read_b64_tr_b16 v[68:69], v8 offset:31784
    ds_read_b64_tr_b16 v[70:71], v8 offset:33064
    s_waitcnt lgkmcnt(10)
    v_mfma_f32_16x16x32_bf16 v[48:51], v[72:75], v[224:227], v[48:51]
    v_mfma_f32_16x16x32_bf16 v[52:55], v[72:75], v[228:231], v[52:55]
    ds_read_b64_tr_b16 v[72:73], v9 offset:21504
    ds_read_b64_tr_b16 v[74:75], v9 offset:22784
    s_waitcnt lgkmcnt(8)
    s_sub_u32 s75, s61, 1280
    s_add_u32 m0, s70, 98304
    v_mfma_f32_16x16x32_bf16 v[16:19], v[56:59], v[232:235], v[16:19]
    v_mfma_f32_16x16x32_bf16 v[20:23], v[56:59], v[236:239], v[20:23]
    buffer_load_dwordx4 v5, s[20:23], s75 offen lds
    s_waitcnt lgkmcnt(6)
    v_mfma_f32_16x16x32_bf16 v[24:27], v[60:63], v[232:235], v[24:27]
    v_mfma_f32_16x16x32_bf16 v[28:31], v[60:63], v[236:239], v[28:31]
    s_waitcnt lgkmcnt(4)
    v_mfma_f32_16x16x32_bf16 v[32:35], v[232:235], v[64:67], v[32:35]
    v_mfma_f32_16x16x32_bf16 v[36:39], v[236:239], v[64:67], v[36:39]
    v_add_u32 v6, 36864, v6
    v_add_u32 v7, 36864, v7
    v_add_u32 v8, 36864, v8
    v_add_u32 v9, 36864, v9
    s_waitcnt vmcnt(3) lgkmcnt(0)
    s_barrier
    ds_read_b128 v[240:243], v6 offset:0
    ds_read_b128 v[244:247], v6 offset:2048
    ds_read_b64_tr_b16 v[56:57], v8 offset:16384
    ds_read_b64_tr_b16 v[58:59], v8 offset:17664
    ds_read_b64_tr_b16 v[60:61], v9 offset:16384
    ds_read_b64_tr_b16 v[62:63], v9 offset:17664
    ds_read_b64_tr_b16 v[64:65], v8 offset:16424
    ds_read_b64_tr_b16 v[66:67], v8 offset:17704
    s_sub_u32 s75, s62, 1280
    s_add_u32 m0, s70, 102400
    v_mfma_f32_16x16x32_bf16 v[40:43], v[232:235], v[68:71], v[40:43]
    v_mfma_f32_16x16x32_bf16 v[44:47], v[236:239], v[68:71], v[44:47]
    buffer_load_dwordx4 v3, s[20:23], s75 offen lds
    ds_read_b128 v[248:251], v7 offset:0
    ds_read_b128 v[252:255], v7 offset:2048
    ds_read_b64_tr_b16 v[68:69], v8 offset:21504
    ds_read_b64_tr_b16 v[70:71], v8 offset:22784
    s_cmp_lt_u32 s43, 2
    s_cselect_b32 s75, s62, s63
    s_sub_u32 s75, s75, 1280
    s_add_u32 m0, s70, 110592
    v_mfma_f32_16x16x32_bf16 v[48:51], v[72:75], v[232:235], v[48:51]
    v_mfma_f32_16x16x32_bf16 v[52:55], v[72:75], v[236:239], v[52:55]
    buffer_load_dwordx4 v4, s[20:23], s75 offen lds
    ds_read_b64_tr_b16 v[72:73], v9 offset:21504
    ds_read_b64_tr_b16 v[74:75], v9 offset:22784
    s_waitcnt lgkmcnt(10)
    s_sub_u32 s75, s63, 1280
    s_add_u32 m0, s70, 118784
    v_mfma_f32_16x16x32_bf16 v[16:19], v[56:59], v[240:243], v[16:19]
    v_mfma_f32_16x16x32_bf16 v[20:23], v[56:59], v[244:247], v[20:23]
    buffer_load_dwordx4 v5, s[20:23], s75 offen lds
    ds_read_b64_tr_b16 v[56:57], v8 offset:21544
    ds_read_b64_tr_b16 v[58:59], v8 offset:22824
    s_waitcnt lgkmcnt(10)
    s_sub_u32 s75, s64, 1280
    s_add_u32 m0, s70, 122880
    v_mfma_f32_16x16x32_bf16 v[48:51], v[60:63], v[240:243], v[48:51]
    v_mfma_f32_16x16x32_bf16 v[52:55], v[60:63], v[244:247], v[52:55]
    buffer_load_dwordx4 v3, s[20:23], s75 offen lds
    ds_read_b64_tr_b16 v[60:61], v8 offset:26624
    ds_read_b64_tr_b16 v[62:63], v8 offset:27904
    s_waitcnt lgkmcnt(10)
    s_cmp_lt_u32 s43, 2
    s_cselect_b32 s75, s64, s65
    s_sub_u32 s75, s75, 1280
    s_add_u32 m0, s70, 131072
    v_mfma_f32_16x16x32_bf16 v[24:27], v[64:67], v[240:243], v[24:27]
    v_mfma_f32_16x16x32_bf16 v[28:31], v[64:67], v[244:247], v[28:31]
    buffer_load_dwordx4 v4, s[20:23], s75 offen lds
    ds_read_b64_tr_b16 v[64:65], v8 offset:26664
    ds_read_b64_tr_b16 v[66:67], v8 offset:27944
    s_waitcnt lgkmcnt(8)
    s_sub_u32 s75, s65, 1280
    s_add_u32 m0, s70, 139264
    v_mfma_f32_16x16x32_bf16 v[16:19], v[68:71], v[248:251], v[16:19]
    v_mfma_f32_16x16x32_bf16 v[20:23], v[68:71], v[252:255], v[20:23]
    buffer_load_dwordx4 v5, s[20:23], s75 offen lds
    ds_read_b64_tr_b16 v[68:69], v8 offset:31744
    ds_read_b64_tr_b16 v[70:71], v8 offset:33024
    s_waitcnt lgkmcnt(8)
    v_mfma_f32_16x16x32_bf16 v[48:51], v[72:75], v[248:251], v[48:51]
    v_mfma_f32_16x16x32_bf16 v[52:55], v[72:75], v[252:255], v[52:55]
    ds_read_b64_tr_b16 v[72:73], v8 offset:31784
    ds_read_b64_tr_b16 v[74:75], v8 offset:33064
    s_waitcnt lgkmcnt(8)
    v_mfma_f32_16x16x32_bf16 v[24:27], v[56:59], v[248:251], v[24:27]
    v_mfma_f32_16x16x32_bf16 v[28:31], v[56:59], v[252:255], v[28:31]
    s_waitcnt lgkmcnt(6)
    v_mfma_f32_16x16x32_bf16 v[32:35], v[240:243], v[60:63], v[32:35]
    v_mfma_f32_16x16x32_bf16 v[36:39], v[244:247], v[60:63], v[36:39]
    s_waitcnt lgkmcnt(4)
    v_mfma_f32_16x16x32_bf16 v[40:43], v[240:243], v[64:67], v[40:43]
    v_mfma_f32_16x16x32_bf16 v[44:47], v[244:247], v[64:67], v[44:47]
    s_waitcnt lgkmcnt(2)
    v_mfma_f32_16x16x32_bf16 v[32:35], v[248:251], v[68:71], v[32:35]
    v_mfma_f32_16x16x32_bf16 v[36:39], v[252:255], v[68:71], v[36:39]
    s_waitcnt lgkmcnt(0)
    v_mfma_f32_16x16x32_bf16 v[40:43], v[248:251], v[72:75], v[40:43]
    v_mfma_f32_16x16x32_bf16 v[44:47], v[252:255], v[72:75], v[44:47]
    v_lshlrev_b32 v6, 4, v10
    v_lshlrev_b32 v7, 3, v10
    v_add_u32 v8, 45056, v8
    v_add_u32 v9, 45056, v9
    v_cvt_pk_bf16_f32 v64, v20, v21
    v_cvt_pk_bf16_f32 v65, v22, v23
    v_cvt_pk_bf16_f32 v68, v28, v29
    v_cvt_pk_bf16_f32 v69, v30, v31
    v_cvt_pk_bf16_f32 v66, v52, v53
    v_cvt_pk_bf16_f32 v67, v54, v55
    v_cvt_pk_bf16_f32 v70, v52, v53
    v_cvt_pk_bf16_f32 v71, v54, v55
    v_cvt_pk_bf16_f32 v76, v36, v37
    v_cvt_pk_bf16_f32 v77, v38, v39
    v_cvt_pk_bf16_f32 v82, v44, v45
    v_cvt_pk_bf16_f32 v83, v46, v47
    v_cvt_pk_bf16_f32 v56, v16, v17
    v_cvt_pk_bf16_f32 v57, v18, v19
    v_cvt_pk_bf16_f32 v60, v24, v25
    v_cvt_pk_bf16_f32 v61, v26, v27
    v_cvt_pk_bf16_f32 v58, v48, v49
    v_cvt_pk_bf16_f32 v59, v50, v51
    v_cvt_pk_bf16_f32 v62, v48, v49
    v_cvt_pk_bf16_f32 v63, v50, v51
    v_cvt_pk_bf16_f32 v74, v32, v33
    v_cvt_pk_bf16_f32 v75, v34, v35
    v_cvt_pk_bf16_f32 v80, v40, v41
    v_cvt_pk_bf16_f32 v81, v42, v43
    s_mul_i32 s3, s43, 3072
    v_add_u32 v11, s3, v7
    s_waitcnt vmcnt(6) lgkmcnt(0)
    s_barrier
    ds_write_b64 v11, v[64:65] offset:20480
    ds_write_b64 v11, v[68:69] offset:20992
    ds_write_b64 v11, v[76:77] offset:21504
    ds_write_b64 v11, v[82:83] offset:22016
    ds_write_b64 v11, v[66:67] offset:22528
    ds_write_b64 v11, v[58:59] offset:23040
    s_cmp_eq_u32 s44, 3
    s_cbranch_scc0 L_nohp_10
    v_min_u32 v64, -2, v64
    v_min_u32 v65, -2, v65
    buffer_store_dwordx2 v[64:65], v7, s[32:35], s79 offen offset:0 sc1
    v_min_u32 v68, -2, v68
    v_min_u32 v69, -2, v69
    buffer_store_dwordx2 v[68:69], v7, s[32:35], s79 offen offset:512 sc1
    v_min_u32 v76, -2, v76
    v_min_u32 v77, -2, v77
    buffer_store_dwordx2 v[76:77], v7, s[32:35], s79 offen offset:1024 sc1
    v_min_u32 v82, -2, v82
    v_min_u32 v83, -2, v83
    buffer_store_dwordx2 v[82:83], v7, s[32:35], s79 offen offset:1536 sc1
    v_min_u32 v66, -2, v66
    v_min_u32 v67, -2, v67
    buffer_store_dwordx2 v[66:67], v7, s[32:35], s79 offen offset:2048 sc1
L_nohp_10:
    ds_read_b64_tr_b16 v[40:41], v8 offset:0
    ds_read_b64_tr_b16 v[42:43], v8 offset:1280
    ds_read_b64_tr_b16 v[44:45], v8 offset:40
    ds_read_b64_tr_b16 v[46:47], v8 offset:1320
    ds_read_b64_tr_b16 v[48:49], v9 offset:0
    ds_read_b64_tr_b16 v[50:51], v9 offset:1280
    ds_read_b64_tr_b16 v[52:53], v8 offset:5120
    ds_read_b64_tr_b16 v[54:55], v8 offset:6400
    s_waitcnt lgkmcnt(6)
    v_mfma_f32_16x16x32_bf16 v[16:19], v[40:43], v[96:99], 0
    v_mfma_f32_16x16x32_bf16 v[20:23], v[40:43], v[100:103], 0
    ds_read_b64_tr_b16 v[40:41], v8 offset:5160
    ds_read_b64_tr_b16 v[42:43], v8 offset:6440
    s_waitcnt lgkmcnt(6)
    v_mfma_f32_16x16x32_bf16 v[24:27], v[44:47], v[96:99], 0
    v_mfma_f32_16x16x32_bf16 v[28:31], v[44:47], v[100:103], 0
    ds_read_b64_tr_b16 v[44:45], v9 offset:5120
    ds_read_b64_tr_b16 v[46:47], v9 offset:6400
    s_waitcnt lgkmcnt(6)
    v_mfma_f32_16x16x32_bf16 v[32:35], v[48:51], v[96:99], 0
    v_mfma_f32_16x16x32_bf16 v[36:39], v[48:51], v[100:103], 0
    ds_read_b64_tr_b16 v[48:49], v8 offset:10240
    ds_read_b64_tr_b16 v[50:51], v8 offset:11520
    s_waitcnt lgkmcnt(6)
    v_mfma_f32_16x16x32_bf16 v[16:19], v[52:55], v[104:107], v[16:19]
    v_mfma_f32_16x16x32_bf16 v[20:23], v[52:55], v[108:111], v[20:23]
    ds_read_b64_tr_b16 v[52:53], v8 offset:10280
    ds_read_b64_tr_b16 v[54:55], v8 offset:11560
    s_waitcnt lgkmcnt(6)
    v_mfma_f32_16x16x32_bf16 v[24:27], v[40:43], v[104:107], v[24:27]
    v_mfma_f32_16x16x32_bf16 v[28:31], v[40:43], v[108:111], v[28:31]
    ds_read_b64_tr_b16 v[40:41], v9 offset:10240
    ds_read_b64_tr_b16 v[42:43], v9 offset:11520
    s_waitcnt lgkmcnt(6)
    v_mfma_f32_16x16x32_bf16 v[32:35], v[44:47], v[104:107], v[32:35]
    v_mfma_f32_16x16x32_bf16 v[36:39], v[44:47], v[108:111], v[36:39]
    ds_read_b64_tr_b16 v[44:45], v8 offset:15360
    ds_read_b64_tr_b16 v[46:47], v8 offset:16640
    s_waitcnt lgkmcnt(6)
    v_mfma_f32_16x16x32_bf16 v[16:19], v[48:51], v[112:115], v[16:19]
    v_mfma_f32_16x16x32_bf16 v[20:23], v[48:51], v[116:119], v[20:23]
    ds_read_b64_tr_b16 v[48:49], v8 offset:15400
    ds_read_b64_tr_b16 v[50:51], v8 offset:16680
    s_waitcnt lgkmcnt(6)
    v_mfma_f32_16x16x32_bf16 v[24:27], v[52:55], v[112:115], v[24:27]
    v_mfma_f32_16x16x32_bf16 v[28:31], v[52:55], v[116:119], v[28:31]
    ds_read_b64_tr_b16 v[52:53], v9 offset:15360
    ds_read_b64_tr_b16 v[54:55], v9 offset:16640
    s_waitcnt lgkmcnt(6)
    v_mfma_f32_16x16x32_bf16 v[32:35], v[40:43], v[112:115], v[32:35]
    v_mfma_f32_16x16x32_bf16 v[36:39], v[40:43], v[116:119], v[36:39]
    v_add_u32 v8, 20480, v8
    v_add_u32 v9, 20480, v9
    s_cmp_eq_u32 s44, 3
    s_cbranch_scc1 L_gw5508
    s_waitcnt vmcnt(3) lgkmcnt(0)
    s_branch L_gx5508
L_gw5508:
    s_waitcnt vmcnt(8) lgkmcnt(0)
L_gx5508:
    s_barrier
    ds_read_b64_tr_b16 v[40:41], v8 offset:0
    ds_read_b64_tr_b16 v[42:43], v8 offset:1280
    v_mfma_f32_16x16x32_bf16 v[16:19], v[44:47], v[120:123], v[16:19]
    v_mfma_f32_16x16x32_bf16 v[20:23], v[44:47], v[124:127], v[20:23]
    ds_read_b64_tr_b16 v[44:45], v8 offset:40
    ds_read_b64_tr_b16 v[46:47], v8 offset:1320
    s_sub_u32 s75, s66, 1280
    s_add_u32 m0, s70, 0
    v_mfma_f32_16x16x32_bf16 v[24:27], v[48:51], v[120:123], v[24:27]
    v_mfma_f32_16x16x32_bf16 v[28:31], v[48:51], v[124:127], v[28:31]
    buffer_load_dwordx4 v3, s[20:23], s75 offen lds
    ds_read_b64_tr_b16 v[48:49], v9 offset:0
    ds_read_b64_tr_b16 v[50:51], v9 offset:1280
    v_mfma_f32_16x16x32_bf16 v[32:35], v[52:55], v[120:123], v[32:35]
    v_mfma_f32_16x16x32_bf16 v[36:39], v[52:55], v[124:127], v[36:39]
    ds_read_b64_tr_b16 v[52:53], v8 offset:5120
    ds_read_b64_tr_b16 v[54:55], v8 offset:6400
    s_waitcnt lgkmcnt(6)
    s_cmp_lt_u32 s43, 2
    s_cselect_b32 s75, s66, s67
    s_sub_u32 s75, s75, 1280
    s_add_u32 m0, s70, 8192
    v_mfma_f32_16x16x32_bf16 v[16:19], v[40:43], v[128:131], v[16:19]
    v_mfma_f32_16x16x32_bf16 v[20:23], v[40:43], v[132:135], v[20:23]
    buffer_load_dwordx4 v4, s[20:23], s75 offen lds
    ds_read_b64_tr_b16 v[40:41], v8 offset:5160
    ds_read_b64_tr_b16 v[42:43], v8 offset:6440
    s_waitcnt lgkmcnt(6)
    v_mfma_f32_16x16x32_bf16 v[24:27], v[44:47], v[128:131], v[24:27]
    v_mfma_f32_16x16x32_bf16 v[28:31], v[44:47], v[132:135], v[28:31]
    v_add_u32 v126, 148480, v6
    ds_read_b128 v[104:107], v126 offset:0
    ds_read_b128 v[108:111], v126 offset:1024
    ds_read_b64_tr_b16 v[44:45], v9 offset:5120
    ds_read_b64_tr_b16 v[46:47], v9 offset:6400
    s_waitcnt lgkmcnt(8)
    s_sub_u32 s75, s67, 1280
    s_add_u32 m0, s70, 16384
    v_mfma_f32_16x16x32_bf16 v[32:35], v[48:51], v[128:131], v[32:35]
    v_mfma_f32_16x16x32_bf16 v[36:39], v[48:51], v[132:135], v[36:39]
    buffer_load_dwordx4 v5, s[20:23], s75 offen lds
    ds_read_b128 v[112:115], v126 offset:2048
    ds_read_b128 v[116:119], v126 offset:3072
    ds_read_b128 v[120:123], v126 offset:1024
    ds_read_b64_tr_b16 v[48:49], v8 offset:10240
    ds_read_b64_tr_b16 v[50:51], v8 offset:11520
    s_waitcnt lgkmcnt(11)
    v_mfma_f32_16x16x32_bf16 v[16:19], v[52:55], v[136:139], v[16:19]
    v_mfma_f32_16x16x32_bf16 v[20:23], v[52:55], v[140:143], v[20:23]
    v_mov_b32 v127, 0
    s_lshl_b32 s4, s44, 10
    v_add_u32 v124, s4, v7
    ds_read_b64_tr_b16 v[52:53], v8 offset:10280
    ds_read_b64_tr_b16 v[54:55], v8 offset:11560
    s_waitcnt lgkmcnt(11)
    v_mfma_f32_16x16x32_bf16 v[24:27], v[40:43], v[136:139], v[24:27]
    v_mfma_f32_16x16x32_bf16 v[28:31], v[40:43], v[140:143], v[28:31]
    s_mov_b64 exec, 0xfffff
    buffer_load_dword v95, v93, s[32:35], s76 offen
    s_mov_b64 exec, 1
    buffer_load_dword v95, off, s[32:35], s8
    s_mov_b64 exec, -1
    ds_read_b64_tr_b16 v[40:41], v9 offset:10240
    ds_read_b64_tr_b16 v[42:43], v9 offset:11520
    s_waitcnt lgkmcnt(9)
    v_mfma_f32_16x16x32_bf16 v[32:35], v[44:47], v[136:139], v[32:35]
    v_mfma_f32_16x16x32_bf16 v[36:39], v[44:47], v[140:143], v[36:39]
    ds_read_b64_tr_b16 v[44:45], v8 offset:15360
    ds_read_b64_tr_b16 v[46:47], v8 offset:16640
    s_waitcnt lgkmcnt(6)
    v_mfma_f32_16x16x32_bf16 v[16:19], v[48:51], v[144:147], v[16:19]
    v_mfma_f32_16x16x32_bf16 v[20:23], v[48:51], v[148:151], v[20:23]
    s_xor_b32 s3, s43, 4
    s_mul_i32 s3, s3, 3072
    v_add_u32 v11, s3, v7
    ds_read_b64 v[86:87], v11 offset:23040
    ds_read_b64 v[88:89], v11 offset:22528
    ds_read_b64_tr_b16 v[48:49], v8 offset:15400
    ds_read_b64_tr_b16 v[50:51], v8 offset:16680
    s_waitcnt lgkmcnt(8)
    v_mfma_f32_16x16x32_bf16 v[24:27], v[52:55], v[144:147], v[24:27]
    v_mfma_f32_16x16x32_bf16 v[28:31], v[52:55], v[148:151], v[28:31]
    ds_read_b64_tr_b16 v[52:53], v9 offset:15360
    ds_read_b64_tr_b16 v[54:55], v9 offset:16640
    s_waitcnt lgkmcnt(8)
    v_mfma_f32_16x16x32_bf16 v[32:35], v[40:43], v[144:147], v[32:35]
    v_mfma_f32_16x16x32_bf16 v[36:39], v[40:43], v[148:151], v[36:39]
    v_add_u32 v8, 20480, v8
    v_add_u32 v9, 20480, v9
    s_cmp_eq_u32 s44, 3
    s_cbranch_scc1 L_gw5601
    s_waitcnt vmcnt(5) lgkmcnt(0)
    s_branch L_gx5601
L_gw5601:
    s_waitcnt vmcnt(10) lgkmcnt(0)
L_gx5601:
    s_barrier
    ds_read_b64_tr_b16 v[40:41], v8 offset:0
    ds_read_b64_tr_b16 v[42:43], v8 offset:1280
    v_mfma_f32_16x16x32_bf16 v[16:19], v[44:47], v[152:155], v[16:19]
    v_mfma_f32_16x16x32_bf16 v[20:23], v[44:47], v[156:159], v[20:23]
    ds_read_b64_tr_b16 v[44:45], v8 offset:40
    ds_read_b64_tr_b16 v[46:47], v8 offset:1320
    v_mfma_f32_16x16x32_bf16 v[24:27], v[48:51], v[152:155], v[24:27]
    v_mfma_f32_16x16x32_bf16 v[28:31], v[48:51], v[156:159], v[28:31]
    ds_read_b64_tr_b16 v[48:49], v9 offset:0
    ds_read_b64_tr_b16 v[50:51], v9 offset:1280
    s_sub_u32 s75, s68, 1280
    s_add_u32 m0, s70, 143360
    v_mfma_f32_16x16x32_bf16 v[32:35], v[52:55], v[152:155], v[32:35]
    v_mfma_f32_16x16x32_bf16 v[36:39], v[52:55], v[156:159], v[36:39]
    buffer_load_dwordx4 v3, s[20:23], s75 offen lds
    ds_read_b64_tr_b16 v[52:53], v8 offset:5120
    ds_read_b64_tr_b16 v[54:55], v8 offset:6400
    s_waitcnt lgkmcnt(6)
    v_mfma_f32_16x16x32_bf16 v[16:19], v[40:43], v[160:163], v[16:19]
    v_mfma_f32_16x16x32_bf16 v[20:23], v[40:43], v[164:167], v[20:23]
    ds_read_b64_tr_b16 v[40:41], v8 offset:5160
    ds_read_b64_tr_b16 v[42:43], v8 offset:6440
    ds_read_b64_tr_b16 v[128:129], v9 offset:5120
    ds_read_b64_tr_b16 v[130:131], v9 offset:6400
    ds_read_b64_tr_b16 v[132:133], v8 offset:10240
    ds_read_b64_tr_b16 v[134:135], v8 offset:11520
    ds_read_b64_tr_b16 v[136:137], v8 offset:10280
    ds_read_b64_tr_b16 v[138:139], v8 offset:11560
    ds_read_b64_tr_b16 v[140:141], v9 offset:10240
    s_waitcnt lgkmcnt(12)
    ds_read_b64_tr_b16 v[142:143], v9 offset:11520
    ds_read_b64_tr_b16 v[144:145], v8 offset:15360
    ds_read_b64_tr_b16 v[146:147], v8 offset:16640
    v_mfma_f32_16x16x32_bf16 v[24:27], v[44:47], v[160:163], v[24:27]
    v_mfma_f32_16x16x32_bf16 v[28:31], v[44:47], v[164:167], v[28:31]
    s_waitcnt lgkmcnt(12)
    ds_read_b64_tr_b16 v[148:149], v8 offset:15400
    ds_read_b64_tr_b16 v[150:151], v8 offset:16680
    s_cmp_lt_u32 s43, 2
    s_cselect_b32 s75, s68, s69
    s_sub_u32 s75, s75, 1280
    s_add_u32 m0, s70, 151552
    v_mfma_f32_16x16x32_bf16 v[32:35], v[48:51], v[160:163], v[32:35]
    v_mfma_f32_16x16x32_bf16 v[36:39], v[48:51], v[164:167], v[36:39]
    buffer_load_dwordx4 v4, s[20:23], s75 offen lds
    ds_read_b64_tr_b16 v[152:153], v9 offset:15360
    s_waitcnt lgkmcnt(12)
    ds_read_b64_tr_b16 v[154:155], v9 offset:16640
    v_mfma_f32_16x16x32_bf16 v[16:19], v[52:55], v[168:171], v[16:19]
    v_mfma_f32_16x16x32_bf16 v[20:23], v[52:55], v[172:175], v[20:23]
    s_cmp_eq_u32 s44, 0
    s_cbranch_scc1 L_nof2_10
    s_waitcnt lgkmcnt(6)
    s_sub_u32 s3, s44, 1
    s_mul_i32 s3, s3, 3072
    v_add_u32 v11, s3, v7
    ds_read_b64 v[96:97], v11 offset:20480
    ds_read_b64 v[100:101], v11 offset:20992
    ds_read_b64 v[72:73], v11 offset:21504
    ds_read_b64 v[78:79], v11 offset:22016
    ds_read_b64 v[98:99], v11 offset:22528
    ds_read_b64 v[102:103], v11 offset:22528
    ds_read_b64 v[84:85], v11 offset:34816
L_nof2_10:
    v_mfma_f32_16x16x32_bf16 v[24:27], v[40:43], v[168:171], v[24:27]
    v_mfma_f32_16x16x32_bf16 v[28:31], v[40:43], v[172:175], v[28:31]
    s_waitcnt lgkmcnt(12)
    s_sub_u32 s75, s69, 1280
    s_add_u32 m0, s70, 159744
    v_mfma_f32_16x16x32_bf16 v[32:35], v[128:131], v[168:171], v[32:35]
    v_mfma_f32_16x16x32_bf16 v[36:39], v[128:131], v[172:175], v[36:39]
    buffer_load_dwordx4 v5, s[20:23], s75 offen lds
    s_waitcnt lgkmcnt(10)
    v_mfma_f32_16x16x32_bf16 v[16:19], v[132:135], v[176:179], v[16:19]
    v_mfma_f32_16x16x32_bf16 v[20:23], v[132:135], v[180:183], v[20:23]
    s_waitcnt lgkmcnt(8)
    v_mfma_f32_16x16x32_bf16 v[24:27], v[136:139], v[176:179], v[24:27]
    v_mfma_f32_16x16x32_bf16 v[28:31], v[136:139], v[180:183], v[28:31]
    v_add_u32 v8, -122880, v8
    v_add_u32 v9, -122880, v9
    s_waitcnt vmcnt(5) lgkmcnt(0)
    s_barrier
    ds_read_b64_tr_b16 v[44:45], v8 offset:0
    ds_read_b64_tr_b16 v[46:47], v8 offset:1280
    ds_read_b64_tr_b16 v[48:49], v8 offset:40
    ds_read_b64_tr_b16 v[50:51], v8 offset:1320
    ds_read_b64_tr_b16 v[52:53], v9 offset:0
    ds_read_b64_tr_b16 v[54:55], v9 offset:1280
    ds_read_b64_tr_b16 v[40:41], v8 offset:5120
    ds_read_b64_tr_b16 v[42:43], v8 offset:6400
    ds_read_b64_tr_b16 v[128:129], v8 offset:5160
    ds_read_b64_tr_b16 v[130:131], v8 offset:6440
    v_mfma_f32_16x16x32_bf16 v[32:35], v[140:143], v[176:179], v[32:35]
    v_mfma_f32_16x16x32_bf16 v[36:39], v[140:143], v[180:183], v[36:39]
    ds_read_b64_tr_b16 v[132:133], v9 offset:5120
    ds_read_b64_tr_b16 v[134:135], v9 offset:6400
    v_mfma_f32_16x16x32_bf16 v[16:19], v[144:147], v[184:187], v[16:19]
    v_mfma_f32_16x16x32_bf16 v[20:23], v[144:147], v[188:191], v[20:23]
    s_cmp_eq_u32 s87, 0
    s_cbranch_scc1 L_nohl_10
    s_add_u32 s3, s49, 0
    buffer_load_dwordx2 v[96:97], v7, s[32:35], s3 offen sc1
    s_add_u32 s3, s49, 512
    buffer_load_dwordx2 v[100:101], v7, s[32:35], s3 offen sc1
    s_add_u32 s3, s49, 1024
    buffer_load_dwordx2 v[72:73], v7, s[32:35], s3 offen sc1
    s_add_u32 s3, s49, 1536
    buffer_load_dwordx2 v[78:79], v7, s[32:35], s3 offen sc1
    s_add_u32 s3, s49, 2048
    buffer_load_dwordx2 v[98:99], v7, s[32:35], s3 offen sc1
    s_add_u32 s3, s49, 5120
    buffer_load_dwordx2 v[84:85], v7, s[32:35], s3 offen sc1
    s_add_u32 s3, s49, 2048
    buffer_load_dwordx2 v[102:103], v7, s[32:35], s3 offen sc1
L_nohl_10:
    ds_read_b64_tr_b16 v[136:137], v8 offset:10240
    ds_read_b64_tr_b16 v[138:139], v8 offset:11520
    v_mfma_f32_16x16x32_bf16 v[24:27], v[148:151], v[184:187], v[24:27]
    v_mfma_f32_16x16x32_bf16 v[28:31], v[148:151], v[188:191], v[28:31]
    ds_read_b64_tr_b16 v[140:141], v8 offset:10280
    s_waitcnt lgkmcnt(12)
    ds_read_b64_tr_b16 v[142:143], v8 offset:11560
    s_add_u32 s75, s93, 0
    s_add_u32 m0, s70, 61440
    v_mfma_f32_16x16x32_bf16 v[32:35], v[152:155], v[184:187], v[32:35]
    v_mfma_f32_16x16x32_bf16 v[36:39], v[152:155], v[188:191], v[36:39]
    buffer_load_dwordx4 v90, s[24:27], s75 offen lds
    ds_read_b64_tr_b16 v[144:145], v9 offset:10240
    ds_read_b64_tr_b16 v[146:147], v9 offset:11520
    v_mfma_f32_16x16x32_bf16 v[16:19], v[44:47], v[192:195], v[16:19]
    v_mfma_f32_16x16x32_bf16 v[20:23], v[44:47], v[196:199], v[20:23]
    s_waitcnt lgkmcnt(12)
    ds_read_b64_tr_b16 v[148:149], v8 offset:15360
    ds_read_b64_tr_b16 v[150:151], v8 offset:16640
    s_add_u32 s75, s93, 0
    s_add_u32 m0, s70, 69632
    v_mfma_f32_16x16x32_bf16 v[24:27], v[48:51], v[192:195], v[24:27]
    v_mfma_f32_16x16x32_bf16 v[28:31], v[48:51], v[196:199], v[28:31]
    buffer_load_dwordx4 v91, s[24:27], s75 offen lds
    ds_read_b64_tr_b16 v[152:153], v8 offset:15400
    s_waitcnt lgkmcnt(12)
    ds_read_b64_tr_b16 v[154:155], v8 offset:16680
    v_mfma_f32_16x16x32_bf16 v[32:35], v[52:55], v[192:195], v[32:35]
    v_mfma_f32_16x16x32_bf16 v[36:39], v[52:55], v[196:199], v[36:39]
    ds_read_b64_tr_b16 v[44:45], v9 offset:15360
    ds_read_b64_tr_b16 v[46:47], v9 offset:16640
    s_add_u32 s75, s93, 0
    s_add_u32 m0, s70, 77824
    v_mfma_f32_16x16x32_bf16 v[16:19], v[40:43], v[200:203], v[16:19]
    v_mfma_f32_16x16x32_bf16 v[20:23], v[40:43], v[204:207], v[20:23]
    buffer_load_dwordx4 v92, s[24:27], s75 offen lds
    s_waitcnt lgkmcnt(14)
    v_mfma_f32_16x16x32_bf16 v[24:27], v[128:131], v[200:203], v[24:27]
    v_mfma_f32_16x16x32_bf16 v[28:31], v[128:131], v[204:207], v[28:31]
    s_waitcnt lgkmcnt(12)
    v_mfma_f32_16x16x32_bf16 v[32:35], v[132:135], v[200:203], v[32:35]
    v_mfma_f32_16x16x32_bf16 v[36:39], v[132:135], v[204:207], v[36:39]
    s_waitcnt lgkmcnt(10)
    v_mfma_f32_16x16x32_bf16 v[16:19], v[136:139], v[208:211], v[16:19]
    v_mfma_f32_16x16x32_bf16 v[20:23], v[136:139], v[212:215], v[20:23]
    s_waitcnt lgkmcnt(8)
    v_mfma_f32_16x16x32_bf16 v[24:27], v[140:143], v[208:211], v[24:27]
    v_mfma_f32_16x16x32_bf16 v[28:31], v[140:143], v[212:215], v[28:31]
    v_add_u32 v8, 143360, v8
    v_add_u32 v9, 143360, v9
    s_cmp_lg_u32 s87, 0
    s_cbranch_scc1 L_gw5758
    s_waitcnt vmcnt(3) lgkmcnt(0)
    s_branch L_gx5758
L_gw5758:
    s_waitcnt vmcnt(10) lgkmcnt(0)
L_gx5758:
    s_barrier
    ds_read_b64_tr_b16 v[48:49], v9 offset:0
    ds_read_b64_tr_b16 v[50:51], v9 offset:1280
    ds_read_b64_tr_b16 v[52:53], v9 offset:5120
    ds_read_b64_tr_b16 v[54:55], v9 offset:6400
    ds_read_b64_tr_b16 v[40:41], v9 offset:10240
    ds_read_b64_tr_b16 v[42:43], v9 offset:11520
    ds_read_b64_tr_b16 v[128:129], v9 offset:15360
    ds_read_b64_tr_b16 v[130:131], v9 offset:16640
    ds_read_b64_tr_b16 v[132:133], v8 offset:0
    ds_read_b64_tr_b16 v[134:135], v8 offset:1280
    v_mfma_f32_16x16x32_bf16 v[32:35], v[144:147], v[208:211], v[32:35]
    v_mfma_f32_16x16x32_bf16 v[36:39], v[144:147], v[212:215], v[36:39]
    ds_read_b64_tr_b16 v[136:137], v8 offset:5120
    ds_read_b64_tr_b16 v[138:139], v8 offset:6400
    v_mfma_f32_16x16x32_bf16 v[16:19], v[148:151], v[216:219], v[16:19]
    v_mfma_f32_16x16x32_bf16 v[20:23], v[148:151], v[220:223], v[20:23]
    ds_read_b64_tr_b16 v[140:141], v8 offset:10240
    ds_read_b64_tr_b16 v[142:143], v8 offset:11520
    s_add_u32 s75, s93, 163840
    s_add_u32 m0, s70, 81920
    v_mfma_f32_16x16x32_bf16 v[24:27], v[152:155], v[216:219], v[24:27]
    v_mfma_f32_16x16x32_bf16 v[28:31], v[152:155], v[220:223], v[28:31]
    buffer_load_dwordx4 v90, s[24:27], s75 offen lds
    ds_read_b64_tr_b16 v[144:145], v8 offset:15360
    s_waitcnt lgkmcnt(12)
    ds_read_b64_tr_b16 v[146:147], v8 offset:16640
    v_mfma_f32_16x16x32_bf16 v[32:35], v[44:47], v[216:219], v[32:35]
    v_mfma_f32_16x16x32_bf16 v[36:39], v[44:47], v[220:223], v[36:39]
    ds_read_b64_tr_b16 v[148:149], v8 offset:40
    ds_read_b64_tr_b16 v[150:151], v8 offset:1320
    v_mfma_f32_16x16x32_bf16 v[32:35], v[48:51], v[224:227], v[32:35]
    v_mfma_f32_16x16x32_bf16 v[36:39], v[48:51], v[228:231], v[36:39]
    s_waitcnt lgkmcnt(12)
    ds_read_b64_tr_b16 v[152:153], v8 offset:5160
    ds_read_b64_tr_b16 v[154:155], v8 offset:6440
    s_add_u32 s75, s93, 163840
    s_add_u32 m0, s70, 90112
    v_mfma_f32_16x16x32_bf16 v[32:35], v[52:55], v[232:235], v[32:35]
    v_mfma_f32_16x16x32_bf16 v[36:39], v[52:55], v[236:239], v[36:39]
    buffer_load_dwordx4 v91, s[24:27], s75 offen lds
    ds_read_b64_tr_b16 v[44:45], v8 offset:10280
    s_waitcnt lgkmcnt(12)
    ds_read_b64_tr_b16 v[46:47], v8 offset:11560
    v_mfma_f32_16x16x32_bf16 v[32:35], v[40:43], v[240:243], v[32:35]
    v_mfma_f32_16x16x32_bf16 v[36:39], v[40:43], v[244:247], v[36:39]
    ds_read_b64_tr_b16 v[48:49], v8 offset:15400
    ds_read_b64_tr_b16 v[50:51], v8 offset:16680
    v_mfma_f32_16x16x32_bf16 v[32:35], v[128:131], v[248:251], v[32:35]
    v_mfma_f32_16x16x32_bf16 v[36:39], v[128:131], v[252:255], v[36:39]
    s_waitcnt lgkmcnt(14)
    s_add_u32 s75, s93, 163840
    s_add_u32 m0, s70, 98304
    v_mfma_f32_16x16x32_bf16 v[16:19], v[132:135], v[224:227], v[16:19]
    v_mfma_f32_16x16x32_bf16 v[20:23], v[132:135], v[228:231], v[20:23]
    buffer_load_dwordx4 v92, s[24:27], s75 offen lds
    s_nop 0
    v_cvt_pk_bf16_f32 v156, v32, v33
    v_cvt_pk_bf16_f32 v157, v34, v35
    v_cvt_pk_bf16_f32 v158, v36, v37
    s_waitcnt lgkmcnt(12)
    v_mfma_f32_16x16x32_bf16 v[16:19], v[136:139], v[232:235], v[16:19]
    v_mfma_f32_16x16x32_bf16 v[20:23], v[136:139], v[236:239], v[20:23]
    v_cvt_pk_bf16_f32 v159, v38, v39
    ds_write_b64 v124, v[156:157] offset:49152
    ds_write_b64 v124, v[158:159] offset:49664
    s_waitcnt lgkmcnt(12)
    v_mfma_f32_16x16x32_bf16 v[16:19], v[140:143], v[240:243], v[16:19]
    v_mfma_f32_16x16x32_bf16 v[20:23], v[140:143], v[244:247], v[20:23]
    s_waitcnt lgkmcnt(10)
    v_mfma_f32_16x16x32_bf16 v[16:19], v[144:147], v[248:251], v[16:19]
    v_mfma_f32_16x16x32_bf16 v[20:23], v[144:147], v[252:255], v[20:23]
    s_waitcnt lgkmcnt(8)
    v_mfma_f32_16x16x32_bf16 v[24:27], v[148:151], v[224:227], v[24:27]
    v_mfma_f32_16x16x32_bf16 v[28:31], v[148:151], v[228:231], v[28:31]
    s_nop 3
    v_cvt_pk_bf16_f32 v160, v16, v17
    v_cvt_pk_bf16_f32 v161, v18, v19
    v_cvt_pk_bf16_f32 v168, v20, v21
    s_waitcnt lgkmcnt(6)
    v_mfma_f32_16x16x32_bf16 v[24:27], v[152:155], v[232:235], v[24:27]
    v_mfma_f32_16x16x32_bf16 v[28:31], v[152:155], v[236:239], v[28:31]
    v_cvt_pk_bf16_f32 v169, v22, v23
    s_waitcnt lgkmcnt(4)
    v_mfma_f32_16x16x32_bf16 v[24:27], v[44:47], v[240:243], v[24:27]
    v_mfma_f32_16x16x32_bf16 v[28:31], v[44:47], v[244:247], v[28:31]
    s_waitcnt lgkmcnt(2)
    v_mfma_f32_16x16x32_bf16 v[24:27], v[48:51], v[248:251], v[24:27]
    v_mfma_f32_16x16x32_bf16 v[28:31], v[48:51], v[252:255], v[28:31]
    s_add_u32 s75, s93, 327680
    s_add_u32 m0, s70, 102400
    s_nop 0
    buffer_load_dwordx4 v90, s[24:27], s75 offen lds
    s_add_u32 s75, s93, 327680
    s_add_u32 m0, s70, 110592
    s_nop 0
    buffer_load_dwordx4 v91, s[24:27], s75 offen lds
    s_add_u32 s75, s93, 327680
    s_add_u32 m0, s70, 118784
    s_nop 0
    buffer_load_dwordx4 v92, s[24:27], s75 offen lds
    v_cvt_pk_bf16_f32 v164, v24, v25
    v_cvt_pk_bf16_f32 v165, v26, v27
    v_cvt_pk_bf16_f32 v172, v28, v29
    v_cvt_pk_bf16_f32 v173, v30, v31
    s_cmp_eq_u32 s44, 0
    s_cbranch_scc0 L_hdone_10
    s_cmp_eq_u32 s41, 0
    s_cbranch_scc0 L_hwait_10
    v_mov_b32 v96, 0
    v_mov_b32 v97, 0
    v_mov_b32 v100, 0
    v_mov_b32 v101, 0
    v_mov_b32 v72, 0
    v_mov_b32 v73, 0
    v_mov_b32 v78, 0
    v_mov_b32 v79, 0
    v_mov_b32 v98, 0
    v_mov_b32 v99, 0
    v_mov_b32 v84, 0
    v_mov_b32 v85, 0
    v_mov_b32 v102, 0
    v_mov_b32 v103, 0
    v_mov_b32 v120, 0xf149f2ca
    v_mov_b32 v121, 0xf149f2ca
    v_mov_b32 v122, 0xf149f2ca
    v_mov_b32 v123, 0xf149f2ca
    s_branch L_hok_10
L_hwait_10:
    s_waitcnt vmcnt(9)
    v_max3_u32 v228, v96, v97, v100
    v_max3_u32 v228, v228, v101, v72
    v_max3_u32 v228, v228, v73, v78
    v_max3_u32 v228, v228, v79, v98
    v_max3_u32 v228, v228, v99, v84
    v_max3_u32 v228, v228, v85, v102
    v_max_u32 v228, v228, v103
    v_cmp_eq_u32 vcc, -1, v228
    s_cbranch_vccz L_hok_10
    s_mov_b32 s92, 0
L_hsp_10:
    s_add_u32 s3, s49, 0
    buffer_load_dwordx2 v[96:97], v7, s[32:35], s3 offen sc1
    s_add_u32 s3, s49, 512
    buffer_load_dwordx2 v[100:101], v7, s[32:35], s3 offen sc1
    s_add_u32 s3, s49, 1024
    buffer_load_dwordx2 v[72:73], v7, s[32:35], s3 offen sc1
    s_add_u32 s3, s49, 1536
    buffer_load_dwordx2 v[78:79], v7, s[32:35], s3 offen sc1
    s_add_u32 s3, s49, 2048
    buffer_load_dwordx2 v[98:99], v7, s[32:35], s3 offen sc1
    s_add_u32 s3, s49, 5120
    buffer_load_dwordx2 v[84:85], v7, s[32:35], s3 offen sc1
    s_add_u32 s3, s49, 2048
    buffer_load_dwordx2 v[102:103], v7, s[32:35], s3 offen sc1
    s_waitcnt vmcnt(0)
    v_max3_u32 v228, v96, v97, v100
    v_max3_u32 v228, v228, v101, v72
    v_max3_u32 v228, v228, v73, v78
    v_max3_u32 v228, v228, v79, v98
    v_max3_u32 v228, v228, v99, v84
    v_max3_u32 v228, v228, v85, v102
    v_max_u32 v228, v228, v103
    v_cmp_eq_u32 vcc, -1, v228
    s_cbranch_vccz L_hok_10
    s_add_u32 s92, s92, 1
    s_cmp_lt_u32 s92, 200000
    s_cbranch_scc1 L_hsp_10
L_hok_10:
L_hdone_10:
    s_mov_b32 vcc_lo, 0xffff
    s_mov_b32 vcc_hi, 0x0
    v_cndmask_b32 v162, v127, v156, vcc
    v_cndmask_b32 v163, v127, v157, vcc
    s_mov_b32 vcc_lo, 0xffff0000
    s_mov_b32 vcc_hi, 0x0
    v_cndmask_b32 v166, v127, v156, vcc
    v_cndmask_b32 v167, v127, v157, vcc
    s_mov_b32 vcc_lo, 0xffff
    s_mov_b32 vcc_hi, 0x0
    v_cndmask_b32 v170, v127, v158, vcc
    v_cndmask_b32 v171, v127, v159, vcc
    s_mov_b32 vcc_lo, 0xffff0000
    s_mov_b32 vcc_hi, 0x0
    v_cndmask_b32 v174, v127, v158, vcc
    v_cndmask_b32 v175, v127, v159, vcc
    s_waitcnt lgkmcnt(0)
    s_barrier
    v_mfma_f32_16x16x32_bf16 v[176:179], v[96:99], v[160:163], v[120:123]
    v_mfma_f32_16x16x32_bf16 v[180:183], v[56:59], v[160:163], v[104:107]
    v_mfma_f32_16x16x32_bf16 v[184:187], v[100:103], v[164:167], v[120:123]
    v_mfma_f32_16x16x32_bf16 v[188:191], v[60:63], v[164:167], v[104:107]
    v_mfma_f32_16x16x32_bf16 v[192:195], v[56:59], v[168:171], v[108:111]
    v_mfma_f32_16x16x32_bf16 v[196:199], v[64:67], v[168:171], v[104:107]
    v_mfma_f32_16x16x32_bf16 v[200:203], v[60:63], v[172:175], v[108:111]
    v_mfma_f32_16x16x32_bf16 v[204:207], v[68:71], v[172:175], v[104:107]
    s_add_u32 s75, s93, 491520
    s_add_u32 m0, s70, 122880
    s_nop 0
    buffer_load_dwordx4 v90, s[24:27], s75 offen lds
    s_add_u32 s75, s93, 491520
    s_add_u32 m0, s70, 131072
    s_nop 0
    buffer_load_dwordx4 v91, s[24:27], s75 offen lds
    v_max3_f32 v228, v176, v177, v180
    v_max3_f32 v229, v178, v179, v182
    v_max_f32 v228, v228, v181
    v_max_f32 v229, v229, v183
    v_max_f32 v236, v228, v229
    v_max3_f32 v230, v184, v185, v188
    v_max3_f32 v231, v186, v187, v190
    v_max_f32 v230, v230, v189
    v_max_f32 v231, v231, v191
    v_max_f32 v237, v230, v231
    v_max3_f32 v232, v192, v193, v196
    v_max3_f32 v233, v194, v195, v198
    v_max_f32 v232, v232, v197
    v_max_f32 v233, v233, v199
    v_max_f32 v238, v232, v233
    v_max3_f32 v234, v200, v201, v204
    v_max3_f32 v235, v202, v203, v206
    v_max_f32 v234, v234, v205
    v_max_f32 v235, v235, v207
    v_max_f32 v239, v234, v235
    v_permlane32_swap_b32 v236, v237
    s_nop 0
    v_permlane32_swap_b32 v238, v239
    v_max_f32 v236, v236, v237
    v_max_f32 v238, v238, v239
    s_nop 1
    v_permlane16_swap_b32 v236, v238
    v_max_f32 v236, v236, v238
    v_mul_f32 v236, 0xbea52b5c, v236
    v_mov_b32 v238, v236
    s_nop 1
    v_permlane16_swap_b32 v236, v238
    v_mov_b32 v237, v236
    v_mov_b32 v239, v238
    s_nop 0
    v_permlane32_swap_b32 v236, v237
    v_permlane32_swap_b32 v238, v239
    s_add_u32 s75, s93, 491520
    s_add_u32 m0, s70, 139264
    s_nop 0
    buffer_load_dwordx4 v92, s[24:27], s75 offen lds
    s_add_u32 s75, s93, 655360
    s_add_u32 m0, s70, 143360
    s_nop 0
    buffer_load_dwordx4 v90, s[24:27], s75 offen lds
    s_add_u32 s75, s93, 655360
    s_add_u32 m0, s70, 151552
    s_nop 0
    buffer_load_dwordx4 v91, s[24:27], s75 offen lds
    s_add_u32 s75, s93, 655360
    s_add_u32 m0, s70, 159744
    s_nop 0
    buffer_load_dwordx4 v92, s[24:27], s75 offen lds
    v_fmamk_f32 v228, v228, 0x3ea52b5c, v236
    v_fmamk_f32 v229, v229, 0x3ea52b5c, v236
    v_fmamk_f32 v230, v230, 0x3ea52b5c, v237
    v_fmamk_f32 v231, v231, 0x3ea52b5c, v237
    v_fmamk_f32 v232, v232, 0x3ea52b5c, v238
    v_fmamk_f32 v233, v233, 0x3ea52b5c, v238
    v_fmamk_f32 v234, v234, 0x3ea52b5c, v239
    v_fmamk_f32 v235, v235, 0x3ea52b5c, v239
    v_exp_f32 v228, v228
    v_exp_f32 v229, v229
    v_exp_f32 v230, v230
    v_exp_f32 v231, v231
    v_exp_f32 v232, v232
    v_exp_f32 v233, v233
    v_exp_f32 v234, v234
    v_exp_f32 v235, v235
    v_cvt_pk_bf16_f32 v228, v228, v228
    v_cvt_pk_bf16_f32 v229, v229, v229
    v_and_b32 v208, v228, v116
    v_and_b32 v209, v229, v117
    v_and_b32 v210, v228, v118
    v_and_b32 v211, v229, v119
    s_nop 1
    v_mfma_f32_16x16x32_bf16 v[24:27], v[112:115], v[208:211], 0
    v_mfma_f32_16x16x32_bf16 v[16:19], v[72:75], v[208:211], 0
    v_mfma_f32_16x16x32_bf16 v[20:23], v[84:87], v[208:211], 0
    v_cvt_pk_bf16_f32 v230, v230, v230
    v_cvt_pk_bf16_f32 v231, v231, v231
    v_and_b32 v212, v230, v116
    v_and_b32 v213, v231, v117
    v_and_b32 v214, v230, v118
    v_and_b32 v215, v231, v119
    s_nop 1
    v_mfma_f32_16x16x32_bf16 v[36:39], v[112:115], v[212:215], 0
    v_mfma_f32_16x16x32_bf16 v[28:31], v[78:81], v[212:215], 0
    v_mfma_f32_16x16x32_bf16 v[32:35], v[84:87], v[212:215], 0
    v_cvt_pk_bf16_f32 v232, v232, v232
    v_cvt_pk_bf16_f32 v233, v233, v233
    v_and_b32 v216, v232, v116
    v_and_b32 v217, v233, v117
    v_and_b32 v218, v232, v118
    v_and_b32 v219, v233, v119
    s_nop 1
    v_mfma_f32_16x16x32_bf16 v[48:51], v[112:115], v[216:219], 0
    v_mfma_f32_16x16x32_bf16 v[40:43], v[74:77], v[216:219], 0
    v_mfma_f32_16x16x32_bf16 v[44:47], v[86:89], v[216:219], 0
    v_cvt_pk_bf16_f32 v234, v234, v234
    v_cvt_pk_bf16_f32 v235, v235, v235
    v_and_b32 v220, v234, v116
    v_and_b32 v221, v235, v117
    v_and_b32 v222, v234, v118
    v_and_b32 v223, v235, v119
    s_nop 1
    v_mfma_f32_16x16x32_bf16 v[136:139], v[112:115], v[220:223], 0
    v_mfma_f32_16x16x32_bf16 v[128:131], v[80:83], v[220:223], 0
    v_mfma_f32_16x16x32_bf16 v[132:135], v[86:89], v[220:223], 0
    s_mov_b32 vcc_lo, 0xffff
    s_mov_b32 vcc_hi, 0x0
    v_rcp_f32 v24, v24
    v_rcp_f32 v36, v36
    v_cndmask_b32 v20, v32, v20, vcc
    v_cndmask_b32 v21, v33, v21, vcc
    v_cndmask_b32 v22, v34, v22, vcc
    v_cndmask_b32 v23, v35, v23, vcc
    v_mul_f32 v16, v16, v24
    v_mul_f32 v17, v17, v24
    v_mul_f32 v18, v18, v24
    v_mul_f32 v19, v19, v24
    v_mul_f32 v28, v28, v36
    v_mul_f32 v29, v29, v36
    v_mul_f32 v30, v30, v36
    v_mul_f32 v31, v31, v36
    v_cndmask_b32 v24, v36, v24, vcc
    v_cvt_pk_bf16_f32 v176, v16, v17
    v_cvt_pk_bf16_f32 v177, v18, v19
    v_cvt_pk_bf16_f32 v178, v28, v29
    v_cvt_pk_bf16_f32 v179, v30, v31
    v_mul_f32 v20, v20, v24
    v_mul_f32 v21, v21, v24
    v_mul_f32 v22, v22, v24
    v_mul_f32 v23, v23, v24
    v_cvt_pk_bf16_f32 v184, v20, v21
    v_cvt_pk_bf16_f32 v185, v22, v23
    v_rcp_f32 v48, v48
    v_rcp_f32 v136, v136
    v_cndmask_b32 v44, v132, v44, vcc
    v_cndmask_b32 v45, v133, v45, vcc
    v_cndmask_b32 v46, v134, v46, vcc
    v_cndmask_b32 v47, v135, v47, vcc
    v_mul_f32 v40, v40, v48
    v_mul_f32 v41, v41, v48
    v_mul_f32 v42, v42, v48
    v_mul_f32 v43, v43, v48
    v_mul_f32 v128, v128, v136
    v_mul_f32 v129, v129, v136
    v_mul_f32 v130, v130, v136
    v_mul_f32 v131, v131, v136
    v_cndmask_b32 v48, v136, v48, vcc
    v_cvt_pk_bf16_f32 v180, v40, v41
    v_cvt_pk_bf16_f32 v181, v42, v43
    v_cvt_pk_bf16_f32 v182, v128, v129
    v_cvt_pk_bf16_f32 v183, v130, v131
    v_mul_f32 v44, v44, v48
    v_mul_f32 v45, v45, v48
    v_mul_f32 v46, v46, v48
    v_mul_f32 v47, v47, v48
    v_cvt_pk_bf16_f32 v186, v44, v45
    v_cvt_pk_bf16_f32 v187, v46, v47
    s_mul_i32 s3, s42, 2560
    s_add_u32 s3, s3, s76
    s_add_u32 s3, s3, 0
    s_add_u32 s4, s3, 20480
    s_lshr_b32 s5, s42, 1
    s_mul_i32 s5, s5, 5120
    s_and_b32 s6, s42, 1
    s_lshl_b32 s6, s6, 3
    s_add_u32 s5, s5, s6
    s_add_u32 s5, s5, s76
    s_add_u32 s6, s5, 20480
    v_lshrrev_b32 v14, 4, v10
    v_mul_u32_u24 v14, 1024, v14
    v_add_u32 v14, v14, v6
    v_mov_b32 v11, s47
    s_cmp_eq_u32 s48, 1
    s_cbranch_scc1 L_fast_10
    buffer_store_dwordx4 v[176:179], v6, s[32:35], s3 offen sc1
    buffer_store_dwordx4 v[180:183], v6, s[32:35], s4 offen sc1
    s_mov_b32 exec_hi, 0
    buffer_store_dwordx2 v[184:185], v14, s[32:35], s5 offen offset:1024 sc1
    buffer_store_dwordx2 v[186:187], v14, s[32:35], s6 offen offset:1024 sc1
    s_branch L_pubd_10
L_fast_10:
    buffer_store_dwordx4 v[176:179], v6, s[32:35], s3 offen nt
    buffer_store_dwordx4 v[180:183], v6, s[32:35], s4 offen nt
    s_mov_b32 exec_hi, 0
    buffer_store_dwordx2 v[184:185], v14, s[32:35], s5 offen offset:1024 nt
    buffer_store_dwordx2 v[186:187], v14, s[32:35], s6 offen offset:1024 nt
L_pubd_10:
    s_mov_b64 exec, -1
    s_mul_i32 s7, s85, 51200
    s_add_u32 s7, s7, 61440
    v_and_b32 v0, 3, v10
    v_lshrrev_b32 v1, 2, v10
    v_mul_u32_u24 v1, 160, v1
    v_lshl_add_u32 v1, v0, 3, v1
    v_add_u32 v1, s7, v1
    v_lshrrev_b32 v2, 4, v10
    v_mul_u32_u24 v2, 20, v2
    v_bfe_u32 v3, v10, 2, 2
    v_add_u32 v2, v2, v3
    v_mul_u32_u24 v2, 160, v2
    v_lshl_add_u32 v2, v0, 3, v2
    v_add_u32 v2, s7, v2
    v_lshlrev_b32 v3, 2, v10
    s_mul_i32 s7, s43, 5120
    v_add_u32 v7, s7, v6
    s_xor_b32 s7, s43, 1
    s_mul_i32 s7, s7, 5120
    v_add_u32 v4, s7, v6
    s_waitcnt vmcnt(4) lgkmcnt(0)
    s_branch L_phase2
L_path_11:
    s_cmp_eq_u32 s44, 0
    s_cselect_b32 s87, s41, 0
    s_bfe_u32 s75, s84, 0x40004
    s_add_u32 s75, s75, s83
    s_cmp_ge_u32 s75, 10
    s_cselect_b32 s73, 10, 0
    s_sub_u32 s75, s75, s73
    s_mul_i32 s62, s75, 245760
    s_add_u32 s62, s62, s5
    s_lshl_b32 s52, s75, 7
    s_add_u32 s52, s52, s4
    s_bfe_u32 s75, s84, 0x40008
    s_add_u32 s75, s75, s83
    s_cmp_ge_u32 s75, 10
    s_cselect_b32 s73, 10, 0
    s_sub_u32 s75, s75, s73
    s_mul_i32 s63, s75, 245760
    s_add_u32 s63, s63, s5
    s_lshl_b32 s53, s75, 7
    s_add_u32 s53, s53, s4
    s_bfe_u32 s75, s84, 0x4000c
    s_add_u32 s75, s75, s83
    s_cmp_ge_u32 s75, 10
    s_cselect_b32 s73, 10, 0
    s_sub_u32 s75, s75, s73
    s_mul_i32 s64, s75, 245760
    s_add_u32 s64, s64, s5
    s_lshl_b32 s54, s75, 7
    s_add_u32 s54, s54, s4
    s_bfe_u32 s75, s84, 0x40010
    s_add_u32 s75, s75, s83
    s_cmp_ge_u32 s75, 10
    s_cselect_b32 s73, 10, 0
    s_sub_u32 s75, s75, s73
    s_mul_i32 s65, s75, 245760
    s_add_u32 s65, s65, s5
    s_lshl_b32 s55, s75, 7
    s_add_u32 s55, s55, s4
    s_bfe_u32 s75, s84, 0x40014
    s_add_u32 s75, s75, s83
    s_cmp_ge_u32 s75, 10
    s_cselect_b32 s73, 10, 0
    s_sub_u32 s75, s75, s73
    s_mul_i32 s66, s75, 245760
    s_add_u32 s66, s66, s5
    s_lshl_b32 s56, s75, 7
    s_add_u32 s56, s56, s4
    s_bfe_u32 s75, s84, 0x40018
    s_add_u32 s75, s75, s83
    s_cmp_ge_u32 s75, 10
    s_cselect_b32 s73, 10, 0
    s_sub_u32 s75, s75, s73
    s_mul_i32 s67, s75, 245760
    s_add_u32 s67, s67, s5
    s_lshl_b32 s57, s75, 7
    s_add_u32 s57, s57, s4
    s_bfe_u32 s75, s84, 0x4001c
    s_add_u32 s75, s75, s83
    s_cmp_ge_u32 s75, 10
    s_cselect_b32 s73, 10, 0
    s_sub_u32 s75, s75, s73
    s_mul_i32 s68, s75, 245760
    s_add_u32 s68, s68, s5
    s_lshl_b32 s58, s75, 7
    s_add_u32 s58, s58, s4
    s_mov_b32 s75, s85
    s_add_u32 s75, s75, s83
    s_cmp_ge_u32 s75, 10
    s_cselect_b32 s73, 10, 0
    s_sub_u32 s75, s75, s73
    s_mul_i32 s69, s75, 245760
    s_add_u32 s69, s69, s5
    s_lshl_b32 s59, s75, 7
    s_add_u32 s59, s59, s4
    s_mov_b32 s24, s8
    s_mov_b32 s25, s9
    s_mov_b32 s26, 819200
    s_mov_b32 s27, 0x20000
    s_mov_b32 s28, s12
    s_mov_b32 s29, s13
    s_mov_b32 s30, 5242880
    s_mov_b32 s31, 0x20000
    s_load_dwordx2 s[12:13], s[0:1], 16
    s_load_dwordx2 s[14:15], s[0:1], 0
    s_waitcnt lgkmcnt(0)
    s_lshl_b32 s3, s41, 3
    s_add_u32 s3, s3, s42
    s_lshl_b32 s3, s3, 3
    s_add_u32 s3, s3, s43
    s_mul_i32 s3, s3, 2560
    s_lshr_b32 s6, s41, 2
    s_mul_i32 s6, s6, 5
    s_add_u32 s6, s6, 1
    s_lshr_b32 s6, s6, 1
    s_add_u32 s6, s6, 5
    v_cmp_le_u32 vcc, 5, v10
    v_add_u32 v86, s6, v10
    v_subrev_u32 v87, 5, v86
    v_cndmask_b32 v86, v86, v87, vcc
    v_subrev_u32 v87, 10, v86
    v_min_u32 v86, v86, v87
    v_lshlrev_b32 v86, 7, v86
    v_add_u32 v87, 1280, v86
    v_cndmask_b32 v86, v86, v87, vcc
    s_mov_b32 s4, s14
    s_mov_b32 s5, s15
    s_mov_b32 s6, 2621440
    s_mov_b32 s7, 0x20000
    s_mov_b64 exec, 1023
    buffer_load_dword v95, v86, s[4:7], s3 offen
    s_mov_b64 exec, -1
    s_getreg_b32 s46, hwreg(HW_REG_XCC_ID, 0, 3)
    s_mul_i32 s93, s42, 160
    v_and_b32 v11, 15, v10
    v_lshrrev_b32 v12, 4, v10
    v_lshrrev_b32 v13, 1, v11
    v_xor_b32 v13, v13, v12
    v_lshlrev_b32 v13, 4, v13
    v_lshl_add_u32 v13, v11, 7, v13
    s_lshl_b32 s3, s44, 12
    v_add_u32 v6, s3, v13
    v_xor_b32 v7, 64, v6
    v_lshrrev_b32 v11, 5, v10
    v_lshlrev_b32 v11, 4, v11
    v_bfe_u32 v13, v10, 2, 3
    v_add_u32 v11, v11, v13
    v_mul_u32_u24 v11, 160, v11
    v_and_b32 v12, 3, v10
    v_lshl_add_u32 v8, v12, 3, v11
    v_add_u32 v8, 80, v8
    v_mad_u32_u24 v9, v12, 40, v11
    v_add_u32 v9, 10272, v9
    s_lshl_b32 s3, s40, 4
    s_add_u32 s3, s3, s41
    s_lshl_b32 s4, s41, 3
    s_lshl_b32 s5, s44, 1
    s_add_u32 s5, s5, s4
    s_mul_i32 s76, s5, 20480
    s_add_u32 s76, s76, 2621440
    s_and_b32 s85, s43, 1
    s_add_u32 s5, s4, s43
    s_mul_i32 s99, s5, 40960
    s_add_u32 s99, s99, 1280
    s_sub_u32 s5, s5, s85
    s_mul_i32 s98, s5, 20480
    s_mul_i32 s5, s85, 10240
    s_add_u32 s98, s98, s5
    s_add_u32 s98, s98, 2621440
    s_mov_b32 s91, s98
    s_add_u32 s99, s99, s93
    s_lshl_b32 s4, s3, 2
    s_add_u32 s5, s4, s44
    s_lshl_b32 s5, s5, 7
    s_lshl_b32 s6, s42, 3
    s_add_u32 s5, s5, s6
    s_add_u32 s9, s5, 8388612
    s_lshr_b32 s5, s43, 1
    s_add_u32 s5, s5, s4
    s_lshl_b32 s5, s5, 7
    s_add_u32 s5, s5, 8388608
    s_add_u32 s83, s5, 64
    s_lshl_b32 s7, s85, 2
    s_add_u32 s84, s83, s6
    s_add_u32 s84, s84, s7
    s_lshl_b32 s7, s85, 5
    s_add_u32 s8, s5, s7
    s_mov_b32 s94, 0x3fb8aa3b
    s_mov_b32 s95, 0x358637bd
    v_mov_b32 v80, s95
    v_mov_b32 v81, s95
    v_mov_b32 v82, s95
    v_mov_b32 v83, s95
    v_mov_b32 v84, 0
    v_and_b32 v11, 0x1ff, v0
    v_mul_u32_u24 v12, 6554, v11
    v_lshrrev_b32 v12, 16, v12
    v_mul_u32_u24 v13, 10, v12
    v_sub_u32 v11, v11, v13
    v_mul_u32_u24 v12, 1280, v12
    v_lshlrev_b32 v11, 4, v11
    v_add_u32 v90, v11, v12
    s_add_u32 s72, s43, 8
    s_cmp_ge_u32 s72, 10
    s_cselect_b32 s73, 81920, 0
    s_cselect_b32 s74, 10, 0
    s_sub_u32 s72, s72, s74
    s_lshl_b32 s72, s72, 6
    v_add_u32 v11, s72, v10
    v_mul_u32_u24 v12, 6554, v11
    v_lshrrev_b32 v12, 16, v12
    v_mul_u32_u24 v13, 10, v12
    v_sub_u32 v11, v11, v13
    v_mul_u32_u24 v12, 1280, v12
    v_lshlrev_b32 v11, 4, v11
    v_add3_u32 v91, v11, v12, s73
    v_and_b32 v11, 7, v10
    v_lshlrev_b32 v11, 7, v11
    s_mul_i32 s3, s42, 2560
    s_add_u32 s3, s3, 1280
    v_add_u32 v11, s3, v11
    v_bfe_u32 v12, v10, 3, 1
    v_mul_u32_u24 v12, 20480, v12
    v_add_u32 v11, v11, v12
    v_and_b32 v12, 1, v10
    v_lshlrev_b32 v12, 7, v12
    s_add_u32 s3, s3, 1024
    v_add_u32 v12, s3, v12
    v_bfe_u32 v13, v10, 1, 1
    v_mul_u32_u24 v13, 20480, v13
    v_add_u32 v12, v12, v13
    s_mov_b32 vcc_lo, 0xffff
    s_mov_b32 vcc_hi, 0x0
    v_cndmask_b32 v93, v12, v11, vcc
    v_mov_b32 v56, 0
    v_mov_b32 v57, 0xf149f2ca
    s_mov_b32 vcc_lo, 0x55505555
    s_mov_b32 vcc_hi, 0x50005500
    v_cndmask_b32 v16, v57, v56, vcc
    s_mov_b32 vcc_lo, 0x50000
    s_mov_b32 vcc_hi, 0x5550055
    v_cndmask_b32 v20, v57, v56, vcc
    v_mov_b32 v24, 0x3f803f80
    s_mov_b32 vcc_lo, 0xaaa0aaaa
    s_mov_b32 vcc_hi, 0xa000aa00
    v_cndmask_b32 v17, v57, v56, vcc
    s_mov_b32 vcc_lo, 0xa0000
    s_mov_b32 vcc_hi, 0xaaa00aa
    v_cndmask_b32 v21, v57, v56, vcc
    v_mov_b32 v25, 0x3f803f80
    s_mov_b32 vcc_lo, 0x55405554
    s_mov_b32 vcc_hi, 0x40005400
    v_cndmask_b32 v18, v57, v56, vcc
    s_mov_b32 vcc_lo, 0x150001
    s_mov_b32 vcc_hi, 0x15550155
    v_cndmask_b32 v22, v57, v56, vcc
    v_mov_b32 v26, 0x3f803f80
    s_mov_b32 vcc_lo, 0xaa80aaa8
    s_mov_b32 vcc_hi, 0x8000a800
    v_cndmask_b32 v19, v57, v56, vcc
    s_mov_b32 vcc_lo, 0x2a0002
    s_mov_b32 vcc_hi, 0x2aaa02aa
    v_cndmask_b32 v23, v57, v56, vcc
    v_mov_b32 v27, 0x3f803f80
    v_mov_b32 v57, 0xffff
    v_mov_b32 v58, 0xffff0000
    s_mov_b32 vcc_lo, 0xaaaaaaaa
    s_mov_b32 vcc_hi, 0xaaaaaaaa
    v_cndmask_b32 v57, v57, v58, vcc
    s_mov_b32 vcc_lo, 0xf0000
    s_mov_b32 vcc_hi, 0xfff00ff
    v_cndmask_b32 v28, v56, v57, vcc
    s_mov_b32 vcc_lo, 0x3f0003
    s_mov_b32 vcc_hi, 0x3fff03ff
    v_cndmask_b32 v29, v56, v57, vcc
    s_mov_b32 vcc_lo, 0xfff0ffff
    s_mov_b32 vcc_hi, 0xf000ff00
    v_cndmask_b32 v30, v56, v57, vcc
    s_mov_b32 vcc_lo, 0xffc0fffc
    s_mov_b32 vcc_hi, 0xc000fc00
    v_cndmask_b32 v31, v56, v57, vcc
    v_lshlrev_b32 v11, 4, v10
    v_add_u32 v11, 148480, v11
    ds_write_b128 v11, v[16:19] offset:0
    ds_write_b128 v11, v[20:23] offset:1024
    ds_write_b128 v11, v[24:27] offset:2048
    ds_write_b128 v11, v[28:31] offset:3072
    s_waitcnt lgkmcnt(0)
    s_add_u32 m0, s71, 37888
    s_nop 0
    buffer_load_dwordx4 v2, s[16:19], s51 offen lds
    s_add_u32 m0, s70, 53248
    s_nop 0
    buffer_load_dwordx4 v3, s[20:23], s61 offen lds
    s_add_u32 m0, s70, 61440
    s_nop 0
    buffer_load_dwordx4 v4, s[20:23], s61 offen lds
    s_cmp_eq_u32 s44, 3
    s_cbranch_scc1 L_gw6408
    s_waitcnt vmcnt(6)
    s_branch L_gx6408
L_gw6408:
    s_waitcnt vmcnt(11)
L_gx6408:
    s_barrier
    ds_read_b128 v[96:99], v6 offset:0
    ds_read_b128 v[100:103], v6 offset:2048
    ds_read_b64_tr_b16 v[56:57], v8 offset:16384
    ds_read_b64_tr_b16 v[58:59], v8 offset:17664
    ds_read_b64_tr_b16 v[60:61], v8 offset:16424
    ds_read_b64_tr_b16 v[62:63], v8 offset:17704
    ds_read_b64_tr_b16 v[64:65], v8 offset:26624
    ds_read_b64_tr_b16 v[66:67], v8 offset:27904
    ds_read_b64_tr_b16 v[68:69], v8 offset:26664
    ds_read_b64_tr_b16 v[70:71], v8 offset:27944
    ds_read_b64_tr_b16 v[72:73], v9 offset:16384
    ds_read_b64_tr_b16 v[74:75], v9 offset:17664
    s_waitcnt lgkmcnt(8)
    v_mfma_f32_16x16x32_bf16 v[16:19], v[56:59], v[96:99], 0
    v_mfma_f32_16x16x32_bf16 v[20:23], v[56:59], v[100:103], 0
    ds_read_b128 v[104:107], v7 offset:0
    ds_read_b128 v[108:111], v7 offset:2048
    ds_read_b64_tr_b16 v[56:57], v8 offset:21504
    ds_read_b64_tr_b16 v[58:59], v8 offset:22784
    s_waitcnt lgkmcnt(10)
    s_add_u32 m0, s71, 73728
    v_mfma_f32_16x16x32_bf16 v[24:27], v[60:63], v[96:99], 0
    v_mfma_f32_16x16x32_bf16 v[28:31], v[60:63], v[100:103], 0
    buffer_load_dwordx4 v1, s[16:19], s52 offen lds
    ds_read_b64_tr_b16 v[60:61], v8 offset:21544
    ds_read_b64_tr_b16 v[62:63], v8 offset:22824
    s_waitcnt lgkmcnt(10)
    v_mfma_f32_16x16x32_bf16 v[32:35], v[96:99], v[64:67], 0
    v_mfma_f32_16x16x32_bf16 v[36:39], v[100:103], v[64:67], 0
    ds_read_b64_tr_b16 v[64:65], v8 offset:31744
    ds_read_b64_tr_b16 v[66:67], v8 offset:33024
    s_waitcnt lgkmcnt(10)
    s_add_u32 m0, s71, 74752
    v_mfma_f32_16x16x32_bf16 v[40:43], v[96:99], v[68:71], 0
    v_mfma_f32_16x16x32_bf16 v[44:47], v[100:103], v[68:71], 0
    buffer_load_dwordx4 v2, s[16:19], s52 offen lds
    ds_read_b64_tr_b16 v[68:69], v8 offset:31784
    ds_read_b64_tr_b16 v[70:71], v8 offset:33064
    s_waitcnt lgkmcnt(10)
    v_mfma_f32_16x16x32_bf16 v[48:51], v[96:99], v[72:75], 0
    v_mfma_f32_16x16x32_bf16 v[52:55], v[100:103], v[72:75], 0
    ds_read_b64_tr_b16 v[72:73], v9 offset:21504
    ds_read_b64_tr_b16 v[74:75], v9 offset:22784
    s_waitcnt lgkmcnt(8)
    s_add_u32 m0, s70, 90112
    v_mfma_f32_16x16x32_bf16 v[16:19], v[56:59], v[104:107], v[16:19]
    v_mfma_f32_16x16x32_bf16 v[20:23], v[56:59], v[108:111], v[20:23]
    buffer_load_dwordx4 v3, s[20:23], s62 offen lds
    s_waitcnt lgkmcnt(6)
    v_mfma_f32_16x16x32_bf16 v[24:27], v[60:63], v[104:107], v[24:27]
    v_mfma_f32_16x16x32_bf16 v[28:31], v[60:63], v[108:111], v[28:31]
    s_waitcnt lgkmcnt(4)
    s_add_u32 m0, s70, 98304
    v_mfma_f32_16x16x32_bf16 v[32:35], v[104:107], v[64:67], v[32:35]
    v_mfma_f32_16x16x32_bf16 v[36:39], v[108:111], v[64:67], v[36:39]
    buffer_load_dwordx4 v4, s[20:23], s62 offen lds
    v_add_u32 v6, 36864, v6
    v_add_u32 v7, 36864, v7
    v_add_u32 v8, 36864, v8
    v_add_u32 v9, 36864, v9
    s_waitcnt vmcnt(4)
    s_barrier
    ds_read_b128 v[112:115], v6 offset:0
    ds_read_b128 v[116:119], v6 offset:2048
    ds_read_b64_tr_b16 v[56:57], v8 offset:16384
    ds_read_b64_tr_b16 v[58:59], v8 offset:17664
    ds_read_b64_tr_b16 v[60:61], v8 offset:16424
    ds_read_b64_tr_b16 v[62:63], v8 offset:17704
    ds_read_b64_tr_b16 v[64:65], v8 offset:26624
    ds_read_b64_tr_b16 v[66:67], v8 offset:27904
    s_waitcnt lgkmcnt(10)
    v_mfma_f32_16x16x32_bf16 v[40:43], v[104:107], v[68:71], v[40:43]
    v_mfma_f32_16x16x32_bf16 v[44:47], v[108:111], v[68:71], v[44:47]
    ds_read_b64_tr_b16 v[68:69], v8 offset:26664
    ds_read_b64_tr_b16 v[70:71], v8 offset:27944
    s_waitcnt lgkmcnt(10)
    s_add_u32 m0, s71, 110592
    v_mfma_f32_16x16x32_bf16 v[48:51], v[104:107], v[72:75], v[48:51]
    v_mfma_f32_16x16x32_bf16 v[52:55], v[108:111], v[72:75], v[52:55]
    buffer_load_dwordx4 v1, s[16:19], s53 offen lds
    ds_read_b64_tr_b16 v[72:73], v9 offset:16384
    ds_read_b64_tr_b16 v[74:75], v9 offset:17664
    s_waitcnt lgkmcnt(8)
    v_mfma_f32_16x16x32_bf16 v[16:19], v[56:59], v[112:115], v[16:19]
    v_mfma_f32_16x16x32_bf16 v[20:23], v[56:59], v[116:119], v[20:23]
    ds_read_b128 v[120:123], v7 offset:0
    ds_read_b128 v[124:127], v7 offset:2048
    ds_read_b64_tr_b16 v[56:57], v8 offset:21504
    ds_read_b64_tr_b16 v[58:59], v8 offset:22784
    s_waitcnt lgkmcnt(10)
    s_add_u32 m0, s71, 111616
    v_mfma_f32_16x16x32_bf16 v[24:27], v[60:63], v[112:115], v[24:27]
    v_mfma_f32_16x16x32_bf16 v[28:31], v[60:63], v[116:119], v[28:31]
    buffer_load_dwordx4 v2, s[16:19], s53 offen lds
    ds_read_b64_tr_b16 v[60:61], v8 offset:21544
    ds_read_b64_tr_b16 v[62:63], v8 offset:22824
    s_waitcnt lgkmcnt(10)
    v_mfma_f32_16x16x32_bf16 v[32:35], v[112:115], v[64:67], v[32:35]
    v_mfma_f32_16x16x32_bf16 v[36:39], v[116:119], v[64:67], v[36:39]
    ds_read_b64_tr_b16 v[64:65], v8 offset:31744
    ds_read_b64_tr_b16 v[66:67], v8 offset:33024
    s_waitcnt lgkmcnt(10)
    s_add_u32 m0, s70, 126976
    v_mfma_f32_16x16x32_bf16 v[40:43], v[112:115], v[68:71], v[40:43]
    v_mfma_f32_16x16x32_bf16 v[44:47], v[116:119], v[68:71], v[44:47]
    buffer_load_dwordx4 v3, s[20:23], s63 offen lds
    ds_read_b64_tr_b16 v[68:69], v8 offset:31784
    ds_read_b64_tr_b16 v[70:71], v8 offset:33064
    s_waitcnt lgkmcnt(10)
    v_mfma_f32_16x16x32_bf16 v[48:51], v[112:115], v[72:75], v[48:51]
    v_mfma_f32_16x16x32_bf16 v[52:55], v[116:119], v[72:75], v[52:55]
    ds_read_b64_tr_b16 v[72:73], v9 offset:21504
    ds_read_b64_tr_b16 v[74:75], v9 offset:22784
    s_waitcnt lgkmcnt(8)
    s_add_u32 m0, s70, 135168
    v_mfma_f32_16x16x32_bf16 v[16:19], v[56:59], v[120:123], v[16:19]
    v_mfma_f32_16x16x32_bf16 v[20:23], v[56:59], v[124:127], v[20:23]
    buffer_load_dwordx4 v4, s[20:23], s63 offen lds
    s_waitcnt lgkmcnt(6)
    v_mfma_f32_16x16x32_bf16 v[24:27], v[60:63], v[120:123], v[24:27]
    v_mfma_f32_16x16x32_bf16 v[28:31], v[60:63], v[124:127], v[28:31]
    s_waitcnt lgkmcnt(4)
    v_mfma_f32_16x16x32_bf16 v[32:35], v[120:123], v[64:67], v[32:35]
    v_mfma_f32_16x16x32_bf16 v[36:39], v[124:127], v[64:67], v[36:39]
    v_add_u32 v6, 36864, v6
    v_add_u32 v7, 36864, v7
    v_add_u32 v8, 36864, v8
    v_add_u32 v9, 36864, v9
    s_waitcnt vmcnt(4)
    s_barrier
    ds_read_b128 v[128:131], v6 offset:0
    ds_read_b128 v[132:135], v6 offset:2048
    ds_read_b64_tr_b16 v[56:57], v8 offset:16384
    ds_read_b64_tr_b16 v[58:59], v8 offset:17664
    ds_read_b64_tr_b16 v[60:61], v8 offset:16424
    ds_read_b64_tr_b16 v[62:63], v8 offset:17704
    ds_read_b64_tr_b16 v[64:65], v8 offset:26624
    ds_read_b64_tr_b16 v[66:67], v8 offset:27904
    s_waitcnt lgkmcnt(10)
    v_mfma_f32_16x16x32_bf16 v[40:43], v[120:123], v[68:71], v[40:43]
    v_mfma_f32_16x16x32_bf16 v[44:47], v[124:127], v[68:71], v[44:47]
    ds_read_b64_tr_b16 v[68:69], v8 offset:26664
    ds_read_b64_tr_b16 v[70:71], v8 offset:27944
    s_waitcnt lgkmcnt(10)
    s_add_u32 m0, s71, 0
    v_mfma_f32_16x16x32_bf16 v[48:51], v[120:123], v[72:75], v[48:51]
    v_mfma_f32_16x16x32_bf16 v[52:55], v[124:127], v[72:75], v[52:55]
    buffer_load_dwordx4 v1, s[16:19], s54 offen lds
    ds_read_b64_tr_b16 v[72:73], v9 offset:16384
    ds_read_b64_tr_b16 v[74:75], v9 offset:17664
    s_waitcnt lgkmcnt(8)
    v_mfma_f32_16x16x32_bf16 v[16:19], v[56:59], v[128:131], v[16:19]
    v_mfma_f32_16x16x32_bf16 v[20:23], v[56:59], v[132:135], v[20:23]
    ds_read_b128 v[136:139], v7 offset:0
    ds_read_b128 v[140:143], v7 offset:2048
    ds_read_b64_tr_b16 v[56:57], v8 offset:21504
    ds_read_b64_tr_b16 v[58:59], v8 offset:22784
    s_waitcnt lgkmcnt(10)
    s_add_u32 m0, s71, 1024
    v_mfma_f32_16x16x32_bf16 v[24:27], v[60:63], v[128:131], v[24:27]
    v_mfma_f32_16x16x32_bf16 v[28:31], v[60:63], v[132:135], v[28:31]
    buffer_load_dwordx4 v2, s[16:19], s54 offen lds
    ds_read_b64_tr_b16 v[60:61], v8 offset:21544
    ds_read_b64_tr_b16 v[62:63], v8 offset:22824
    s_waitcnt lgkmcnt(10)
    v_mfma_f32_16x16x32_bf16 v[32:35], v[128:131], v[64:67], v[32:35]
    v_mfma_f32_16x16x32_bf16 v[36:39], v[132:135], v[64:67], v[36:39]
    ds_read_b64_tr_b16 v[64:65], v8 offset:31744
    ds_read_b64_tr_b16 v[66:67], v8 offset:33024
    s_waitcnt lgkmcnt(10)
    s_add_u32 m0, s70, 16384
    v_mfma_f32_16x16x32_bf16 v[40:43], v[128:131], v[68:71], v[40:43]
    v_mfma_f32_16x16x32_bf16 v[44:47], v[132:135], v[68:71], v[44:47]
    buffer_load_dwordx4 v3, s[20:23], s64 offen lds
    ds_read_b64_tr_b16 v[68:69], v8 offset:31784
    ds_read_b64_tr_b16 v[70:71], v8 offset:33064
    s_waitcnt lgkmcnt(10)
    v_mfma_f32_16x16x32_bf16 v[48:51], v[128:131], v[72:75], v[48:51]
    v_mfma_f32_16x16x32_bf16 v[52:55], v[132:135], v[72:75], v[52:55]
    ds_read_b64_tr_b16 v[72:73], v9 offset:21504
    ds_read_b64_tr_b16 v[74:75], v9 offset:22784
    s_waitcnt lgkmcnt(8)
    s_add_u32 m0, s70, 24576
    v_mfma_f32_16x16x32_bf16 v[16:19], v[56:59], v[136:139], v[16:19]
    v_mfma_f32_16x16x32_bf16 v[20:23], v[56:59], v[140:143], v[20:23]
    buffer_load_dwordx4 v4, s[20:23], s64 offen lds
    s_waitcnt lgkmcnt(6)
    v_mfma_f32_16x16x32_bf16 v[24:27], v[60:63], v[136:139], v[24:27]
    v_mfma_f32_16x16x32_bf16 v[28:31], v[60:63], v[140:143], v[28:31]
    s_waitcnt lgkmcnt(4)
    v_mfma_f32_16x16x32_bf16 v[32:35], v[136:139], v[64:67], v[32:35]
    v_mfma_f32_16x16x32_bf16 v[36:39], v[140:143], v[64:67], v[36:39]
    v_add_u32 v6, 36864, v6
    v_add_u32 v7, 36864, v7
    v_add_u32 v8, 36864, v8
    v_add_u32 v9, 36864, v9
    s_waitcnt vmcnt(4)
    s_barrier
    ds_read_b128 v[144:147], v6 offset:0
    ds_read_b128 v[148:151], v6 offset:2048
    ds_read_b64_tr_b16 v[56:57], v8 offset:16384
    ds_read_b64_tr_b16 v[58:59], v8 offset:17664
    ds_read_b64_tr_b16 v[60:61], v8 offset:16424
    ds_read_b64_tr_b16 v[62:63], v8 offset:17704
    ds_read_b64_tr_b16 v[64:65], v8 offset:26624
    ds_read_b64_tr_b16 v[66:67], v8 offset:27904
    s_waitcnt lgkmcnt(10)
    s_add_u32 m0, s71, 36864
    v_mfma_f32_16x16x32_bf16 v[40:43], v[136:139], v[68:71], v[40:43]
    v_mfma_f32_16x16x32_bf16 v[44:47], v[140:143], v[68:71], v[44:47]
    buffer_load_dwordx4 v1, s[16:19], s55 offen lds
    ds_read_b64_tr_b16 v[68:69], v8 offset:26664
    ds_read_b64_tr_b16 v[70:71], v8 offset:27944
    s_waitcnt lgkmcnt(10)
    s_add_u32 m0, s71, 37888
    v_mfma_f32_16x16x32_bf16 v[48:51], v[136:139], v[72:75], v[48:51]
    v_mfma_f32_16x16x32_bf16 v[52:55], v[140:143], v[72:75], v[52:55]
    buffer_load_dwordx4 v2, s[16:19], s55 offen lds
    ds_read_b64_tr_b16 v[72:73], v9 offset:16384
    ds_read_b64_tr_b16 v[74:75], v9 offset:17664
    s_waitcnt lgkmcnt(8)
    s_add_u32 m0, s70, 53248
    v_mfma_f32_16x16x32_bf16 v[16:19], v[56:59], v[144:147], v[16:19]
    v_mfma_f32_16x16x32_bf16 v[20:23], v[56:59], v[148:151], v[20:23]
    buffer_load_dwordx4 v3, s[20:23], s65 offen lds
    ds_read_b128 v[152:155], v7 offset:0
    ds_read_b128 v[156:159], v7 offset:2048
    ds_read_b64_tr_b16 v[56:57], v8 offset:21504
    ds_read_b64_tr_b16 v[58:59], v8 offset:22784
    s_waitcnt lgkmcnt(10)
    s_add_u32 m0, s70, 61440
    v_mfma_f32_16x16x32_bf16 v[24:27], v[60:63], v[144:147], v[24:27]
    v_mfma_f32_16x16x32_bf16 v[28:31], v[60:63], v[148:151], v[28:31]
    buffer_load_dwordx4 v4, s[20:23], s65 offen lds
    ds_read_b64_tr_b16 v[60:61], v8 offset:21544
    ds_read_b64_tr_b16 v[62:63], v8 offset:22824
    s_waitcnt lgkmcnt(10)
    v_mfma_f32_16x16x32_bf16 v[32:35], v[144:147], v[64:67], v[32:35]
    v_mfma_f32_16x16x32_bf16 v[36:39], v[148:151], v[64:67], v[36:39]
    s_lshl_b32 s3, s41, 3
    s_add_u32 s3, s3, s42
    s_mul_i32 s3, s3, 50
    s_mul_i32 s6, s44, 13
    s_add_u32 s3, s3, s6
    v_add_u32 v86, s3, v10
    v_lshlrev_b32 v86, 7, v86
    s_mov_b64 exec, 8191
    buffer_load_dword v95, v86, s[24:27], 0 offen
    s_mov_b64 exec, -1
    ds_read_b64_tr_b16 v[64:65], v8 offset:31744
    ds_read_b64_tr_b16 v[66:67], v8 offset:33024
    s_waitcnt lgkmcnt(10)
    v_mfma_f32_16x16x32_bf16 v[40:43], v[144:147], v[68:71], v[40:43]
    v_mfma_f32_16x16x32_bf16 v[44:47], v[148:151], v[68:71], v[44:47]
    ds_read_b64_tr_b16 v[68:69], v8 offset:31784
    ds_read_b64_tr_b16 v[70:71], v8 offset:33064
    s_waitcnt lgkmcnt(10)
    v_mfma_f32_16x16x32_bf16 v[48:51], v[144:147], v[72:75], v[48:51]
    v_mfma_f32_16x16x32_bf16 v[52:55], v[148:151], v[72:75], v[52:55]
    ds_read_b64_tr_b16 v[72:73], v9 offset:21504
    ds_read_b64_tr_b16 v[74:75], v9 offset:22784
    s_waitcnt lgkmcnt(8)
    v_mfma_f32_16x16x32_bf16 v[16:19], v[56:59], v[152:155], v[16:19]
    v_mfma_f32_16x16x32_bf16 v[20:23], v[56:59], v[156:159], v[20:23]
    s_waitcnt lgkmcnt(6)
    v_mfma_f32_16x16x32_bf16 v[24:27], v[60:63], v[152:155], v[24:27]
    v_mfma_f32_16x16x32_bf16 v[28:31], v[60:63], v[156:159], v[28:31]
    s_waitcnt lgkmcnt(4)
    v_mfma_f32_16x16x32_bf16 v[32:35], v[152:155], v[64:67], v[32:35]
    v_mfma_f32_16x16x32_bf16 v[36:39], v[156:159], v[64:67], v[36:39]
    v_add_u32 v6, -110592, v6
    v_add_u32 v7, -110592, v7
    v_add_u32 v8, -110592, v8
    v_add_u32 v9, -110592, v9
    s_waitcnt vmcnt(5)
    s_barrier
    ds_read_b128 v[160:163], v6 offset:0
    ds_read_b128 v[164:167], v6 offset:2048
    ds_read_b64_tr_b16 v[56:57], v8 offset:16384
    ds_read_b64_tr_b16 v[58:59], v8 offset:17664
    ds_read_b64_tr_b16 v[60:61], v8 offset:16424
    ds_read_b64_tr_b16 v[62:63], v8 offset:17704
    ds_read_b64_tr_b16 v[64:65], v8 offset:26624
    ds_read_b64_tr_b16 v[66:67], v8 offset:27904
    s_waitcnt lgkmcnt(10)
    v_mfma_f32_16x16x32_bf16 v[40:43], v[152:155], v[68:71], v[40:43]
    v_mfma_f32_16x16x32_bf16 v[44:47], v[156:159], v[68:71], v[44:47]
    ds_read_b64_tr_b16 v[68:69], v8 offset:26664
    ds_read_b64_tr_b16 v[70:71], v8 offset:27944
    s_waitcnt lgkmcnt(10)
    s_add_u32 m0, s71, 73728
    v_mfma_f32_16x16x32_bf16 v[48:51], v[152:155], v[72:75], v[48:51]
    v_mfma_f32_16x16x32_bf16 v[52:55], v[156:159], v[72:75], v[52:55]
    buffer_load_dwordx4 v1, s[16:19], s56 offen lds
    ds_read_b64_tr_b16 v[72:73], v9 offset:16384
    ds_read_b64_tr_b16 v[74:75], v9 offset:17664
    s_waitcnt lgkmcnt(8)
    v_mfma_f32_16x16x32_bf16 v[16:19], v[56:59], v[160:163], v[16:19]
    v_mfma_f32_16x16x32_bf16 v[20:23], v[56:59], v[164:167], v[20:23]
    ds_read_b128 v[168:171], v7 offset:0
    ds_read_b128 v[172:175], v7 offset:2048
    ds_read_b64_tr_b16 v[56:57], v8 offset:21504
    ds_read_b64_tr_b16 v[58:59], v8 offset:22784
    s_waitcnt lgkmcnt(10)
    s_add_u32 m0, s71, 74752
    v_mfma_f32_16x16x32_bf16 v[24:27], v[60:63], v[160:163], v[24:27]
    v_mfma_f32_16x16x32_bf16 v[28:31], v[60:63], v[164:167], v[28:31]
    buffer_load_dwordx4 v2, s[16:19], s56 offen lds
    ds_read_b64_tr_b16 v[60:61], v8 offset:21544
    ds_read_b64_tr_b16 v[62:63], v8 offset:22824
    s_waitcnt lgkmcnt(10)
    v_mfma_f32_16x16x32_bf16 v[32:35], v[160:163], v[64:67], v[32:35]
    v_mfma_f32_16x16x32_bf16 v[36:39], v[164:167], v[64:67], v[36:39]
    ds_read_b64_tr_b16 v[64:65], v8 offset:31744
    ds_read_b64_tr_b16 v[66:67], v8 offset:33024
    s_waitcnt lgkmcnt(10)
    s_add_u32 m0, s70, 90112
    v_mfma_f32_16x16x32_bf16 v[40:43], v[160:163], v[68:71], v[40:43]
    v_mfma_f32_16x16x32_bf16 v[44:47], v[164:167], v[68:71], v[44:47]
    buffer_load_dwordx4 v3, s[20:23], s66 offen lds
    ds_read_b64_tr_b16 v[68:69], v8 offset:31784
    ds_read_b64_tr_b16 v[70:71], v8 offset:33064
    s_waitcnt lgkmcnt(10)
    v_mfma_f32_16x16x32_bf16 v[48:51], v[160:163], v[72:75], v[48:51]
    v_mfma_f32_16x16x32_bf16 v[52:55], v[164:167], v[72:75], v[52:55]
    ds_read_b64_tr_b16 v[72:73], v9 offset:21504
    ds_read_b64_tr_b16 v[74:75], v9 offset:22784
    s_waitcnt lgkmcnt(8)
    s_add_u32 m0, s70, 98304
    v_mfma_f32_16x16x32_bf16 v[16:19], v[56:59], v[168:171], v[16:19]
    v_mfma_f32_16x16x32_bf16 v[20:23], v[56:59], v[172:175], v[20:23]
    buffer_load_dwordx4 v4, s[20:23], s66 offen lds
    s_waitcnt lgkmcnt(6)
    v_mfma_f32_16x16x32_bf16 v[24:27], v[60:63], v[168:171], v[24:27]
    v_mfma_f32_16x16x32_bf16 v[28:31], v[60:63], v[172:175], v[28:31]
    s_waitcnt lgkmcnt(4)
    v_mfma_f32_16x16x32_bf16 v[32:35], v[168:171], v[64:67], v[32:35]
    v_mfma_f32_16x16x32_bf16 v[36:39], v[172:175], v[64:67], v[36:39]
    v_add_u32 v6, 36864, v6
    v_add_u32 v7, 36864, v7
    v_add_u32 v8, 36864, v8
    v_add_u32 v9, 36864, v9
    s_waitcnt vmcnt(5)
    s_barrier
    ds_read_b128 v[176:179], v6 offset:0
    ds_read_b128 v[180:183], v6 offset:2048
    ds_read_b64_tr_b16 v[56:57], v8 offset:16384
    ds_read_b64_tr_b16 v[58:59], v8 offset:17664
    ds_read_b64_tr_b16 v[60:61], v8 offset:16424
    ds_read_b64_tr_b16 v[62:63], v8 offset:17704
    ds_read_b64_tr_b16 v[64:65], v8 offset:26624
    ds_read_b64_tr_b16 v[66:67], v8 offset:27904
    s_waitcnt lgkmcnt(10)
    v_mfma_f32_16x16x32_bf16 v[40:43], v[168:171], v[68:71], v[40:43]
    v_mfma_f32_16x16x32_bf16 v[44:47], v[172:175], v[68:71], v[44:47]
    ds_read_b64_tr_b16 v[68:69], v8 offset:26664
    ds_read_b64_tr_b16 v[70:71], v8 offset:27944
    s_waitcnt lgkmcnt(10)
    s_add_u32 m0, s71, 110592
    v_mfma_f32_16x16x32_bf16 v[48:51], v[168:171], v[72:75], v[48:51]
    v_mfma_f32_16x16x32_bf16 v[52:55], v[172:175], v[72:75], v[52:55]
    buffer_load_dwordx4 v1, s[16:19], s57 offen lds
    ds_read_b64_tr_b16 v[72:73], v9 offset:16384
    ds_read_b64_tr_b16 v[74:75], v9 offset:17664
    s_waitcnt lgkmcnt(8)
    v_mfma_f32_16x16x32_bf16 v[16:19], v[56:59], v[176:179], v[16:19]
    v_mfma_f32_16x16x32_bf16 v[20:23], v[56:59], v[180:183], v[20:23]
    ds_read_b128 v[184:187], v7 offset:0
    ds_read_b128 v[188:191], v7 offset:2048
    ds_read_b64_tr_b16 v[56:57], v8 offset:21504
    ds_read_b64_tr_b16 v[58:59], v8 offset:22784
    s_waitcnt lgkmcnt(10)
    s_add_u32 m0, s71, 111616
    v_mfma_f32_16x16x32_bf16 v[24:27], v[60:63], v[176:179], v[24:27]
    v_mfma_f32_16x16x32_bf16 v[28:31], v[60:63], v[180:183], v[28:31]
    buffer_load_dwordx4 v2, s[16:19], s57 offen lds
    ds_read_b64_tr_b16 v[60:61], v8 offset:21544
    ds_read_b64_tr_b16 v[62:63], v8 offset:22824
    s_waitcnt lgkmcnt(10)
    v_mfma_f32_16x16x32_bf16 v[32:35], v[176:179], v[64:67], v[32:35]
    v_mfma_f32_16x16x32_bf16 v[36:39], v[180:183], v[64:67], v[36:39]
    ds_read_b64_tr_b16 v[64:65], v8 offset:31744
    ds_read_b64_tr_b16 v[66:67], v8 offset:33024
    s_waitcnt lgkmcnt(10)
    s_add_u32 m0, s70, 126976
    v_mfma_f32_16x16x32_bf16 v[40:43], v[176:179], v[68:71], v[40:43]
    v_mfma_f32_16x16x32_bf16 v[44:47], v[180:183], v[68:71], v[44:47]
    buffer_load_dwordx4 v3, s[20:23], s67 offen lds
    ds_read_b64_tr_b16 v[68:69], v8 offset:31784
    ds_read_b64_tr_b16 v[70:71], v8 offset:33064
    s_waitcnt lgkmcnt(10)
    v_mfma_f32_16x16x32_bf16 v[48:51], v[176:179], v[72:75], v[48:51]
    v_mfma_f32_16x16x32_bf16 v[52:55], v[180:183], v[72:75], v[52:55]
    ds_read_b64_tr_b16 v[72:73], v9 offset:21504
    ds_read_b64_tr_b16 v[74:75], v9 offset:22784
    s_waitcnt lgkmcnt(8)
    s_add_u32 m0, s70, 135168
    v_mfma_f32_16x16x32_bf16 v[16:19], v[56:59], v[184:187], v[16:19]
    v_mfma_f32_16x16x32_bf16 v[20:23], v[56:59], v[188:191], v[20:23]
    buffer_load_dwordx4 v4, s[20:23], s67 offen lds
    s_waitcnt lgkmcnt(6)
    v_mfma_f32_16x16x32_bf16 v[24:27], v[60:63], v[184:187], v[24:27]
    v_mfma_f32_16x16x32_bf16 v[28:31], v[60:63], v[188:191], v[28:31]
    s_waitcnt lgkmcnt(4)
    v_mfma_f32_16x16x32_bf16 v[32:35], v[184:187], v[64:67], v[32:35]
    v_mfma_f32_16x16x32_bf16 v[36:39], v[188:191], v[64:67], v[36:39]
    v_add_u32 v6, 36864, v6
    v_add_u32 v7, 36864, v7
    v_add_u32 v8, 36864, v8
    v_add_u32 v9, 36864, v9
    s_waitcnt vmcnt(4)
    s_barrier
    ds_read_b128 v[192:195], v6 offset:0
    ds_read_b128 v[196:199], v6 offset:2048
    ds_read_b64_tr_b16 v[56:57], v8 offset:16384
    ds_read_b64_tr_b16 v[58:59], v8 offset:17664
    ds_read_b64_tr_b16 v[60:61], v8 offset:16424
    ds_read_b64_tr_b16 v[62:63], v8 offset:17704
    ds_read_b64_tr_b16 v[64:65], v8 offset:26624
    ds_read_b64_tr_b16 v[66:67], v8 offset:27904
    s_waitcnt lgkmcnt(10)
    v_mfma_f32_16x16x32_bf16 v[40:43], v[184:187], v[68:71], v[40:43]
    v_mfma_f32_16x16x32_bf16 v[44:47], v[188:191], v[68:71], v[44:47]
    ds_read_b64_tr_b16 v[68:69], v8 offset:26664
    ds_read_b64_tr_b16 v[70:71], v8 offset:27944
    s_waitcnt lgkmcnt(10)
    s_add_u32 m0, s71, 0
    v_mfma_f32_16x16x32_bf16 v[48:51], v[184:187], v[72:75], v[48:51]
    v_mfma_f32_16x16x32_bf16 v[52:55], v[188:191], v[72:75], v[52:55]
    buffer_load_dwordx4 v1, s[16:19], s58 offen lds
    ds_read_b64_tr_b16 v[72:73], v9 offset:16384
    ds_read_b64_tr_b16 v[74:75], v9 offset:17664
    s_waitcnt lgkmcnt(8)
    v_mfma_f32_16x16x32_bf16 v[16:19], v[56:59], v[192:195], v[16:19]
    v_mfma_f32_16x16x32_bf16 v[20:23], v[56:59], v[196:199], v[20:23]
    ds_read_b128 v[200:203], v7 offset:0
    ds_read_b128 v[204:207], v7 offset:2048
    ds_read_b64_tr_b16 v[56:57], v8 offset:21504
    ds_read_b64_tr_b16 v[58:59], v8 offset:22784
    s_waitcnt lgkmcnt(10)
    s_add_u32 m0, s71, 1024
    v_mfma_f32_16x16x32_bf16 v[24:27], v[60:63], v[192:195], v[24:27]
    v_mfma_f32_16x16x32_bf16 v[28:31], v[60:63], v[196:199], v[28:31]
    buffer_load_dwordx4 v2, s[16:19], s58 offen lds
    ds_read_b64_tr_b16 v[60:61], v8 offset:21544
    ds_read_b64_tr_b16 v[62:63], v8 offset:22824
    s_waitcnt lgkmcnt(10)
    v_mfma_f32_16x16x32_bf16 v[32:35], v[192:195], v[64:67], v[32:35]
    v_mfma_f32_16x16x32_bf16 v[36:39], v[196:199], v[64:67], v[36:39]
    ds_read_b64_tr_b16 v[64:65], v8 offset:31744
    ds_read_b64_tr_b16 v[66:67], v8 offset:33024
    s_waitcnt lgkmcnt(10)
    s_add_u32 m0, s70, 16384
    v_mfma_f32_16x16x32_bf16 v[40:43], v[192:195], v[68:71], v[40:43]
    v_mfma_f32_16x16x32_bf16 v[44:47], v[196:199], v[68:71], v[44:47]
    buffer_load_dwordx4 v3, s[20:23], s68 offen lds
    ds_read_b64_tr_b16 v[68:69], v8 offset:31784
    ds_read_b64_tr_b16 v[70:71], v8 offset:33064
    s_waitcnt lgkmcnt(10)
    v_mfma_f32_16x16x32_bf16 v[48:51], v[192:195], v[72:75], v[48:51]
    v_mfma_f32_16x16x32_bf16 v[52:55], v[196:199], v[72:75], v[52:55]
    ds_read_b64_tr_b16 v[72:73], v9 offset:21504
    ds_read_b64_tr_b16 v[74:75], v9 offset:22784
    s_waitcnt lgkmcnt(8)
    s_add_u32 m0, s70, 24576
    v_mfma_f32_16x16x32_bf16 v[16:19], v[56:59], v[200:203], v[16:19]
    v_mfma_f32_16x16x32_bf16 v[20:23], v[56:59], v[204:207], v[20:23]
    buffer_load_dwordx4 v4, s[20:23], s68 offen lds
    s_waitcnt lgkmcnt(6)
    v_mfma_f32_16x16x32_bf16 v[24:27], v[60:63], v[200:203], v[24:27]
    v_mfma_f32_16x16x32_bf16 v[28:31], v[60:63], v[204:207], v[28:31]
    s_waitcnt lgkmcnt(4)
    v_mfma_f32_16x16x32_bf16 v[32:35], v[200:203], v[64:67], v[32:35]
    v_mfma_f32_16x16x32_bf16 v[36:39], v[204:207], v[64:67], v[36:39]
    v_add_u32 v6, 36864, v6
    v_add_u32 v7, 36864, v7
    v_add_u32 v8, 36864, v8
    v_add_u32 v9, 36864, v9
    s_waitcnt vmcnt(4)
    s_barrier
    ds_read_b128 v[208:211], v6 offset:0
    ds_read_b128 v[212:215], v6 offset:2048
    ds_read_b64_tr_b16 v[56:57], v8 offset:16384
    ds_read_b64_tr_b16 v[58:59], v8 offset:17664
    ds_read_b64_tr_b16 v[60:61], v8 offset:16424
    ds_read_b64_tr_b16 v[62:63], v8 offset:17704
    ds_read_b64_tr_b16 v[64:65], v8 offset:26624
    ds_read_b64_tr_b16 v[66:67], v8 offset:27904
    s_waitcnt lgkmcnt(10)
    v_mfma_f32_16x16x32_bf16 v[40:43], v[200:203], v[68:71], v[40:43]
    v_mfma_f32_16x16x32_bf16 v[44:47], v[204:207], v[68:71], v[44:47]
    v_mov_b32 v84, 147520
    ds_read_b32 v85, v84
    ds_read_b64_tr_b16 v[68:69], v8 offset:26664
    ds_read_b64_tr_b16 v[70:71], v8 offset:27944
    s_waitcnt lgkmcnt(11)
    s_add_u32 m0, s71, 36864
    v_mfma_f32_16x16x32_bf16 v[48:51], v[200:203], v[72:75], v[48:51]
    v_mfma_f32_16x16x32_bf16 v[52:55], v[204:207], v[72:75], v[52:55]
    buffer_load_dwordx4 v1, s[16:19], s59 offen lds
    ds_read_b64_tr_b16 v[72:73], v9 offset:16384
    ds_read_b64_tr_b16 v[74:75], v9 offset:17664
    s_waitcnt lgkmcnt(9)
    s_add_u32 m0, s71, 37888
    v_mfma_f32_16x16x32_bf16 v[16:19], v[56:59], v[208:211], v[16:19]
    v_mfma_f32_16x16x32_bf16 v[20:23], v[56:59], v[212:215], v[20:23]
    buffer_load_dwordx4 v2, s[16:19], s59 offen lds
    ds_read_b128 v[216:219], v7 offset:0
    ds_read_b128 v[220:223], v7 offset:2048
    ds_read_b64_tr_b16 v[56:57], v8 offset:21504
    ds_read_b64_tr_b16 v[58:59], v8 offset:22784
    s_waitcnt lgkmcnt(11)
    s_add_u32 m0, s70, 53248
    v_mfma_f32_16x16x32_bf16 v[24:27], v[60:63], v[208:211], v[24:27]
    v_mfma_f32_16x16x32_bf16 v[28:31], v[60:63], v[212:215], v[28:31]
    buffer_load_dwordx4 v3, s[20:23], s69 offen lds
    ds_read_b64_tr_b16 v[60:61], v8 offset:21544
    ds_read_b64_tr_b16 v[62:63], v8 offset:22824
    s_waitcnt lgkmcnt(11)
    s_add_u32 m0, s70, 61440
    v_mfma_f32_16x16x32_bf16 v[32:35], v[208:211], v[64:67], v[32:35]
    v_mfma_f32_16x16x32_bf16 v[36:39], v[212:215], v[64:67], v[36:39]
    buffer_load_dwordx4 v4, s[20:23], s69 offen lds
    ds_read_b64_tr_b16 v[64:65], v8 offset:31744
    ds_read_b64_tr_b16 v[66:67], v8 offset:33024
    s_waitcnt lgkmcnt(10)
    v_mfma_f32_16x16x32_bf16 v[40:43], v[208:211], v[68:71], v[40:43]
    v_mfma_f32_16x16x32_bf16 v[44:47], v[212:215], v[68:71], v[44:47]
    v_readfirstlane_b32 s3, v85
    s_nop 0
    s_and_b32 s48, s3, 1
    s_andn2_b32 s47, s3, 7
    ds_read_b64_tr_b16 v[68:69], v8 offset:31784
    ds_read_b64_tr_b16 v[70:71], v8 offset:33064
    s_waitcnt lgkmcnt(10)
    v_mfma_f32_16x16x32_bf16 v[48:51], v[208:211], v[72:75], v[48:51]
    v_mfma_f32_16x16x32_bf16 v[52:55], v[212:215], v[72:75], v[52:55]
    ds_read_b64_tr_b16 v[72:73], v9 offset:21504
    ds_read_b64_tr_b16 v[74:75], v9 offset:22784
    s_waitcnt lgkmcnt(8)
    v_mfma_f32_16x16x32_bf16 v[16:19], v[56:59], v[216:219], v[16:19]
    v_mfma_f32_16x16x32_bf16 v[20:23], v[56:59], v[220:223], v[20:23]
    s_waitcnt lgkmcnt(6)
    v_mfma_f32_16x16x32_bf16 v[24:27], v[60:63], v[216:219], v[24:27]
    v_mfma_f32_16x16x32_bf16 v[28:31], v[60:63], v[220:223], v[28:31]
    s_waitcnt lgkmcnt(4)
    v_mfma_f32_16x16x32_bf16 v[32:35], v[216:219], v[64:67], v[32:35]
    v_mfma_f32_16x16x32_bf16 v[36:39], v[220:223], v[64:67], v[36:39]
    v_add_u32 v6, -110592, v6
    v_add_u32 v7, -110592, v7
    v_add_u32 v8, -110592, v8
    v_add_u32 v9, -110592, v9
    s_waitcnt vmcnt(4)
    s_barrier
    ds_read_b128 v[224:227], v6 offset:0
    ds_read_b128 v[228:231], v6 offset:2048
    ds_read_b64_tr_b16 v[56:57], v8 offset:16384
    ds_read_b64_tr_b16 v[58:59], v8 offset:17664
    ds_read_b64_tr_b16 v[60:61], v8 offset:16424
    ds_read_b64_tr_b16 v[62:63], v8 offset:17704
    ds_read_b64_tr_b16 v[64:65], v8 offset:26624
    ds_read_b64_tr_b16 v[66:67], v8 offset:27904
    s_waitcnt lgkmcnt(10)
    v_mfma_f32_16x16x32_bf16 v[40:43], v[216:219], v[68:71], v[40:43]
    v_mfma_f32_16x16x32_bf16 v[44:47], v[220:223], v[68:71], v[44:47]
    ds_read_b64_tr_b16 v[68:69], v8 offset:26664
    ds_read_b64_tr_b16 v[70:71], v8 offset:27944
    s_waitcnt lgkmcnt(10)
    v_mfma_f32_16x16x32_bf16 v[48:51], v[216:219], v[72:75], v[48:51]
    v_mfma_f32_16x16x32_bf16 v[52:55], v[220:223], v[72:75], v[52:55]
    ds_read_b64_tr_b16 v[72:73], v9 offset:16384
    ds_read_b64_tr_b16 v[74:75], v9 offset:17664
    s_waitcnt lgkmcnt(8)
    v_mfma_f32_16x16x32_bf16 v[16:19], v[56:59], v[224:227], v[16:19]
    v_mfma_f32_16x16x32_bf16 v[20:23], v[56:59], v[228:231], v[20:23]
    v_subrev_u32 v4, 1280, v4
    ds_read_b128 v[232:235], v7 offset:0
    ds_read_b128 v[236:239], v7 offset:2048
    ds_read_b64_tr_b16 v[56:57], v8 offset:21504
    ds_read_b64_tr_b16 v[58:59], v8 offset:22784
    s_waitcnt lgkmcnt(10)
    v_mfma_f32_16x16x32_bf16 v[24:27], v[60:63], v[224:227], v[24:27]
    v_mfma_f32_16x16x32_bf16 v[28:31], v[60:63], v[228:231], v[28:31]
    ds_read_b64_tr_b16 v[60:61], v8 offset:21544
    ds_read_b64_tr_b16 v[62:63], v8 offset:22824
    s_waitcnt lgkmcnt(10)
    v_mfma_f32_16x16x32_bf16 v[32:35], v[224:227], v[64:67], v[32:35]
    v_mfma_f32_16x16x32_bf16 v[36:39], v[228:231], v[64:67], v[36:39]
    ds_read_b64_tr_b16 v[64:65], v8 offset:31744
    ds_read_b64_tr_b16 v[66:67], v8 offset:33024
    s_waitcnt lgkmcnt(10)
    s_sub_u32 s75, s60, 1280
    s_add_u32 m0, s70, 81920
    v_mfma_f32_16x16x32_bf16 v[40:43], v[224:227], v[68:71], v[40:43]
    v_mfma_f32_16x16x32_bf16 v[44:47], v[228:231], v[68:71], v[44:47]
    buffer_load_dwordx4 v3, s[20:23], s75 offen lds
    ds_read_b64_tr_b16 v[68:69], v8 offset:31784
    ds_read_b64_tr_b16 v[70:71], v8 offset:33064
    s_waitcnt lgkmcnt(10)
    v_mfma_f32_16x16x32_bf16 v[48:51], v[224:227], v[72:75], v[48:51]
    v_mfma_f32_16x16x32_bf16 v[52:55], v[228:231], v[72:75], v[52:55]
    ds_read_b64_tr_b16 v[72:73], v9 offset:21504
    ds_read_b64_tr_b16 v[74:75], v9 offset:22784
    s_waitcnt lgkmcnt(8)
    v_mfma_f32_16x16x32_bf16 v[16:19], v[56:59], v[232:235], v[16:19]
    v_mfma_f32_16x16x32_bf16 v[20:23], v[56:59], v[236:239], v[20:23]
    s_waitcnt lgkmcnt(6)
    s_sub_u32 s75, s61, 1280
    s_add_u32 m0, s70, 90112
    v_mfma_f32_16x16x32_bf16 v[24:27], v[60:63], v[232:235], v[24:27]
    v_mfma_f32_16x16x32_bf16 v[28:31], v[60:63], v[236:239], v[28:31]
    buffer_load_dwordx4 v4, s[20:23], s75 offen lds
    s_waitcnt lgkmcnt(4)
    v_mfma_f32_16x16x32_bf16 v[32:35], v[232:235], v[64:67], v[32:35]
    v_mfma_f32_16x16x32_bf16 v[36:39], v[236:239], v[64:67], v[36:39]
    v_add_u32 v6, 36864, v6
    v_add_u32 v7, 36864, v7
    v_add_u32 v8, 36864, v8
    v_add_u32 v9, 36864, v9
    s_waitcnt vmcnt(2) lgkmcnt(0)
    s_barrier
    ds_read_b128 v[240:243], v6 offset:0
    ds_read_b128 v[244:247], v6 offset:2048
    ds_read_b64_tr_b16 v[56:57], v8 offset:16384
    ds_read_b64_tr_b16 v[58:59], v8 offset:17664
    ds_read_b64_tr_b16 v[60:61], v9 offset:16384
    ds_read_b64_tr_b16 v[62:63], v9 offset:17664
    ds_read_b64_tr_b16 v[64:65], v8 offset:16424
    ds_read_b64_tr_b16 v[66:67], v8 offset:17704
    v_mfma_f32_16x16x32_bf16 v[40:43], v[232:235], v[68:71], v[40:43]
    v_mfma_f32_16x16x32_bf16 v[44:47], v[236:239], v[68:71], v[44:47]
    ds_read_b128 v[248:251], v7 offset:0
    ds_read_b128 v[252:255], v7 offset:2048
    ds_read_b64_tr_b16 v[68:69], v8 offset:21504
    ds_read_b64_tr_b16 v[70:71], v8 offset:22784
    s_sub_u32 s75, s62, 1280
    s_add_u32 m0, s70, 102400
    v_mfma_f32_16x16x32_bf16 v[48:51], v[232:235], v[72:75], v[48:51]
    v_mfma_f32_16x16x32_bf16 v[52:55], v[236:239], v[72:75], v[52:55]
    buffer_load_dwordx4 v3, s[20:23], s75 offen lds
    ds_read_b64_tr_b16 v[72:73], v9 offset:21504
    ds_read_b64_tr_b16 v[74:75], v9 offset:22784
    s_waitcnt lgkmcnt(10)
    v_mfma_f32_16x16x32_bf16 v[16:19], v[56:59], v[240:243], v[16:19]
    v_mfma_f32_16x16x32_bf16 v[20:23], v[56:59], v[244:247], v[20:23]
    ds_read_b64_tr_b16 v[56:57], v8 offset:21544
    ds_read_b64_tr_b16 v[58:59], v8 offset:22824
    s_waitcnt lgkmcnt(10)
    s_sub_u32 s75, s63, 1280
    s_add_u32 m0, s70, 110592
    v_mfma_f32_16x16x32_bf16 v[48:51], v[240:243], v[60:63], v[48:51]
    v_mfma_f32_16x16x32_bf16 v[52:55], v[244:247], v[60:63], v[52:55]
    buffer_load_dwordx4 v4, s[20:23], s75 offen lds
    ds_read_b64_tr_b16 v[60:61], v8 offset:26624
    ds_read_b64_tr_b16 v[62:63], v8 offset:27904
    s_waitcnt lgkmcnt(10)
    v_mfma_f32_16x16x32_bf16 v[24:27], v[64:67], v[240:243], v[24:27]
    v_mfma_f32_16x16x32_bf16 v[28:31], v[64:67], v[244:247], v[28:31]
    ds_read_b64_tr_b16 v[64:65], v8 offset:26664
    ds_read_b64_tr_b16 v[66:67], v8 offset:27944
    s_waitcnt lgkmcnt(8)
    s_sub_u32 s75, s64, 1280
    s_add_u32 m0, s70, 122880
    v_mfma_f32_16x16x32_bf16 v[16:19], v[68:71], v[248:251], v[16:19]
    v_mfma_f32_16x16x32_bf16 v[20:23], v[68:71], v[252:255], v[20:23]
    buffer_load_dwordx4 v3, s[20:23], s75 offen lds
    ds_read_b64_tr_b16 v[68:69], v8 offset:31744
    ds_read_b64_tr_b16 v[70:71], v8 offset:33024
    s_waitcnt lgkmcnt(8)
    v_mfma_f32_16x16x32_bf16 v[48:51], v[248:251], v[72:75], v[48:51]
    v_mfma_f32_16x16x32_bf16 v[52:55], v[252:255], v[72:75], v[52:55]
    ds_read_b64_tr_b16 v[72:73], v8 offset:31784
    ds_read_b64_tr_b16 v[74:75], v8 offset:33064
    s_waitcnt lgkmcnt(8)
    s_sub_u32 s75, s65, 1280
    s_add_u32 m0, s70, 131072
    v_mfma_f32_16x16x32_bf16 v[24:27], v[56:59], v[248:251], v[24:27]
    v_mfma_f32_16x16x32_bf16 v[28:31], v[56:59], v[252:255], v[28:31]
    buffer_load_dwordx4 v4, s[20:23], s75 offen lds
    s_waitcnt lgkmcnt(6)
    v_mfma_f32_16x16x32_bf16 v[32:35], v[240:243], v[60:63], v[32:35]
    v_mfma_f32_16x16x32_bf16 v[36:39], v[244:247], v[60:63], v[36:39]
    s_waitcnt lgkmcnt(4)
    v_mfma_f32_16x16x32_bf16 v[40:43], v[240:243], v[64:67], v[40:43]
    v_mfma_f32_16x16x32_bf16 v[44:47], v[244:247], v[64:67], v[44:47]
    s_waitcnt lgkmcnt(2)
    v_mfma_f32_16x16x32_bf16 v[32:35], v[248:251], v[68:71], v[32:35]
    v_mfma_f32_16x16x32_bf16 v[36:39], v[252:255], v[68:71], v[36:39]
    s_waitcnt lgkmcnt(0)
    v_mfma_f32_16x16x32_bf16 v[40:43], v[248:251], v[72:75], v[40:43]
    v_mfma_f32_16x16x32_bf16 v[44:47], v[252:255], v[72:75], v[44:47]
    v_lshlrev_b32 v6, 4, v10
    v_lshlrev_b32 v7, 3, v10
    v_add_u32 v8, 45056, v8
    v_add_u32 v9, 34816, v9
    v_cvt_pk_bf16_f32 v64, v20, v21
    v_cvt_pk_bf16_f32 v65, v22, v23
    v_cvt_pk_bf16_f32 v68, v28, v29
    v_cvt_pk_bf16_f32 v69, v30, v31
    v_cvt_pk_bf16_f32 v88, v52, v53
    v_cvt_pk_bf16_f32 v89, v54, v55
    v_cvt_pk_bf16_f32 v76, v36, v37
    v_cvt_pk_bf16_f32 v77, v38, v39
    v_cvt_pk_bf16_f32 v82, v44, v45
    v_cvt_pk_bf16_f32 v83, v46, v47
    v_cvt_pk_bf16_f32 v56, v16, v17
    v_cvt_pk_bf16_f32 v57, v18, v19
    v_cvt_pk_bf16_f32 v60, v24, v25
    v_cvt_pk_bf16_f32 v61, v26, v27
    v_cvt_pk_bf16_f32 v86, v48, v49
    v_cvt_pk_bf16_f32 v87, v50, v51
    v_cvt_pk_bf16_f32 v74, v32, v33
    v_cvt_pk_bf16_f32 v75, v34, v35
    v_cvt_pk_bf16_f32 v80, v40, v41
    v_cvt_pk_bf16_f32 v81, v42, v43
    s_mul_i32 s3, s43, 3072
    v_add_u32 v11, s3, v7
    s_waitcnt vmcnt(4) lgkmcnt(0)
    s_barrier
    ds_write_b64 v11, v[64:65] offset:20480
    ds_write_b64 v11, v[68:69] offset:20992
    ds_write_b64 v11, v[76:77] offset:21504
    ds_write_b64 v11, v[82:83] offset:22016
    ds_write_b64 v11, v[88:89] offset:22528
    ds_write_b64 v11, v[86:87] offset:23040
    s_cmp_eq_u32 s44, 3
    s_cbranch_scc0 L_nohp_11
    v_min_u32 v64, -2, v64
    v_min_u32 v65, -2, v65
    buffer_store_dwordx2 v[64:65], v7, s[32:35], s79 offen offset:0 sc1
    v_min_u32 v68, -2, v68
    v_min_u32 v69, -2, v69
    buffer_store_dwordx2 v[68:69], v7, s[32:35], s79 offen offset:512 sc1
    v_min_u32 v76, -2, v76
    v_min_u32 v77, -2, v77
    buffer_store_dwordx2 v[76:77], v7, s[32:35], s79 offen offset:1024 sc1
    v_min_u32 v82, -2, v82
    v_min_u32 v83, -2, v83
    buffer_store_dwordx2 v[82:83], v7, s[32:35], s79 offen offset:1536 sc1
    v_min_u32 v88, -2, v88
    v_min_u32 v89, -2, v89
    buffer_store_dwordx2 v[88:89], v7, s[32:35], s79 offen offset:2048 sc1
L_nohp_11:
    ds_read_b64_tr_b16 v[40:41], v8 offset:0
    ds_read_b64_tr_b16 v[42:43], v8 offset:1280
    ds_read_b64_tr_b16 v[44:45], v8 offset:40
    ds_read_b64_tr_b16 v[46:47], v8 offset:1320
    ds_read_b64_tr_b16 v[48:49], v8 offset:5120
    ds_read_b64_tr_b16 v[50:51], v8 offset:6400
    ds_read_b64_tr_b16 v[52:53], v8 offset:5160
    ds_read_b64_tr_b16 v[54:55], v8 offset:6440
    ds_read_b64_tr_b16 v[32:33], v8 offset:10240
    s_waitcnt lgkmcnt(12)
    ds_read_b64_tr_b16 v[34:35], v8 offset:11520
    ds_read_b64_tr_b16 v[36:37], v8 offset:10280
    ds_read_b64_tr_b16 v[38:39], v8 offset:11560
    s_waitcnt lgkmcnt(10)
    v_mfma_f32_16x16x32_bf16 v[16:19], v[40:43], v[96:99], 0
    v_mfma_f32_16x16x32_bf16 v[20:23], v[40:43], v[100:103], 0
    ds_read_b64_tr_b16 v[40:41], v8 offset:15360
    ds_read_b64_tr_b16 v[42:43], v8 offset:16640
    s_waitcnt lgkmcnt(10)
    v_mfma_f32_16x16x32_bf16 v[24:27], v[44:47], v[96:99], 0
    v_mfma_f32_16x16x32_bf16 v[28:31], v[44:47], v[100:103], 0
    ds_read_b64_tr_b16 v[44:45], v8 offset:15400
    ds_read_b64_tr_b16 v[46:47], v8 offset:16680
    s_waitcnt lgkmcnt(10)
    v_mfma_f32_16x16x32_bf16 v[16:19], v[48:51], v[104:107], v[16:19]
    v_mfma_f32_16x16x32_bf16 v[20:23], v[48:51], v[108:111], v[20:23]
    s_waitcnt lgkmcnt(8)
    v_mfma_f32_16x16x32_bf16 v[24:27], v[52:55], v[104:107], v[24:27]
    v_mfma_f32_16x16x32_bf16 v[28:31], v[52:55], v[108:111], v[28:31]
    s_waitcnt lgkmcnt(6)
    v_mfma_f32_16x16x32_bf16 v[16:19], v[32:35], v[112:115], v[16:19]
    v_mfma_f32_16x16x32_bf16 v[20:23], v[32:35], v[116:119], v[20:23]
    v_add_u32 v8, 20480, v8
    v_add_u32 v9, 20480, v9
    s_cmp_eq_u32 s44, 3
    s_cbranch_scc1 L_gw7146
    s_waitcnt vmcnt(2) lgkmcnt(0)
    s_branch L_gx7146
L_gw7146:
    s_waitcnt vmcnt(7) lgkmcnt(0)
L_gx7146:
    s_barrier
    ds_read_b64_tr_b16 v[48:49], v8 offset:0
    ds_read_b64_tr_b16 v[50:51], v8 offset:1280
    ds_read_b64_tr_b16 v[52:53], v8 offset:40
    ds_read_b64_tr_b16 v[54:55], v8 offset:1320
    ds_read_b64_tr_b16 v[32:33], v8 offset:5120
    ds_read_b64_tr_b16 v[34:35], v8 offset:6400
    v_mfma_f32_16x16x32_bf16 v[24:27], v[36:39], v[112:115], v[24:27]
    v_mfma_f32_16x16x32_bf16 v[28:31], v[36:39], v[116:119], v[28:31]
    ds_read_b64_tr_b16 v[36:37], v8 offset:5160
    ds_read_b64_tr_b16 v[38:39], v8 offset:6440
    s_sub_u32 s75, s66, 1280
    s_add_u32 m0, s70, 0
    v_mfma_f32_16x16x32_bf16 v[16:19], v[40:43], v[120:123], v[16:19]
    v_mfma_f32_16x16x32_bf16 v[20:23], v[40:43], v[124:127], v[20:23]
    buffer_load_dwordx4 v3, s[20:23], s75 offen lds
    ds_read_b64_tr_b16 v[40:41], v8 offset:10240
    ds_read_b64_tr_b16 v[42:43], v8 offset:11520
    v_mfma_f32_16x16x32_bf16 v[24:27], v[44:47], v[120:123], v[24:27]
    v_mfma_f32_16x16x32_bf16 v[28:31], v[44:47], v[124:127], v[28:31]
    ds_read_b64_tr_b16 v[44:45], v8 offset:10280
    ds_read_b64_tr_b16 v[46:47], v8 offset:11560
    s_waitcnt lgkmcnt(10)
    s_sub_u32 s75, s67, 1280
    s_add_u32 m0, s70, 8192
    v_mfma_f32_16x16x32_bf16 v[16:19], v[48:51], v[128:131], v[16:19]
    v_mfma_f32_16x16x32_bf16 v[20:23], v[48:51], v[132:135], v[20:23]
    buffer_load_dwordx4 v4, s[20:23], s75 offen lds
    ds_read_b64_tr_b16 v[48:49], v8 offset:15360
    ds_read_b64_tr_b16 v[50:51], v8 offset:16640
    s_waitcnt lgkmcnt(10)
    v_mfma_f32_16x16x32_bf16 v[24:27], v[52:55], v[128:131], v[24:27]
    v_mfma_f32_16x16x32_bf16 v[28:31], v[52:55], v[132:135], v[28:31]
    v_add_u32 v126, 148480, v6
    ds_read_b128 v[104:107], v126 offset:0
    ds_read_b128 v[108:111], v126 offset:1024
    ds_read_b128 v[112:115], v126 offset:2048
    ds_read_b64_tr_b16 v[52:53], v8 offset:15400
    ds_read_b64_tr_b16 v[54:55], v8 offset:16680
    s_waitcnt lgkmcnt(13)
    v_mfma_f32_16x16x32_bf16 v[16:19], v[32:35], v[136:139], v[16:19]
    v_mfma_f32_16x16x32_bf16 v[20:23], v[32:35], v[140:143], v[20:23]
    s_mov_b64 exec, 0xfffff
    buffer_load_dword v95, v93, s[32:35], s76 offen
    s_mov_b64 exec, 1
    buffer_load_dword v95, off, s[32:35], s8
    s_mov_b64 exec, -1
    ds_read_b128 v[116:119], v126 offset:3072
    ds_read_b128 v[120:123], v126 offset:1024
    v_mov_b32 v127, 0
    s_lshl_b32 s4, s44, 10
    v_add_u32 v124, s4, v7
    s_waitcnt lgkmcnt(13)
    v_mfma_f32_16x16x32_bf16 v[24:27], v[36:39], v[136:139], v[24:27]
    v_mfma_f32_16x16x32_bf16 v[28:31], v[36:39], v[140:143], v[28:31]
    s_waitcnt lgkmcnt(11)
    v_mfma_f32_16x16x32_bf16 v[16:19], v[40:43], v[144:147], v[16:19]
    v_mfma_f32_16x16x32_bf16 v[20:23], v[40:43], v[148:151], v[20:23]
    s_xor_b32 s3, s43, 4
    s_mul_i32 s3, s3, 3072
    v_add_u32 v11, s3, v7
    ds_read_b64 v[58:59], v11 offset:23040
    ds_read_b64 v[62:63], v11 offset:23040
    ds_read_b64 v[66:67], v11 offset:22528
    ds_read_b64 v[70:71], v11 offset:22528
    v_add_u32 v8, 20480, v8
    v_add_u32 v9, 20480, v9
    s_cmp_eq_u32 s44, 3
    s_cbranch_scc1 L_gw7217
    s_waitcnt vmcnt(4) lgkmcnt(0)
    s_branch L_gx7217
L_gw7217:
    s_waitcnt vmcnt(9) lgkmcnt(0)
L_gx7217:
    s_barrier
    ds_read_b64_tr_b16 v[32:33], v8 offset:0
    ds_read_b64_tr_b16 v[34:35], v8 offset:1280
    ds_read_b64_tr_b16 v[36:37], v8 offset:40
    ds_read_b64_tr_b16 v[38:39], v8 offset:1320
    ds_read_b64_tr_b16 v[40:41], v8 offset:5120
    ds_read_b64_tr_b16 v[42:43], v8 offset:6400
    v_mfma_f32_16x16x32_bf16 v[24:27], v[44:47], v[144:147], v[24:27]
    v_mfma_f32_16x16x32_bf16 v[28:31], v[44:47], v[148:151], v[28:31]
    ds_read_b64_tr_b16 v[44:45], v8 offset:5160
    ds_read_b64_tr_b16 v[46:47], v8 offset:6440
    v_mfma_f32_16x16x32_bf16 v[16:19], v[48:51], v[152:155], v[16:19]
    v_mfma_f32_16x16x32_bf16 v[20:23], v[48:51], v[156:159], v[20:23]
    ds_read_b64_tr_b16 v[48:49], v8 offset:10240
    ds_read_b64_tr_b16 v[50:51], v8 offset:11520
    s_sub_u32 s75, s68, 1280
    s_add_u32 m0, s70, 143360
    v_mfma_f32_16x16x32_bf16 v[24:27], v[52:55], v[152:155], v[24:27]
    v_mfma_f32_16x16x32_bf16 v[28:31], v[52:55], v[156:159], v[28:31]
    buffer_load_dwordx4 v3, s[20:23], s75 offen lds
    ds_read_b64_tr_b16 v[52:53], v8 offset:10280
    ds_read_b64_tr_b16 v[54:55], v8 offset:11560
    s_waitcnt lgkmcnt(10)
    v_mfma_f32_16x16x32_bf16 v[16:19], v[32:35], v[160:163], v[16:19]
    v_mfma_f32_16x16x32_bf16 v[20:23], v[32:35], v[164:167], v[20:23]
    ds_read_b64_tr_b16 v[32:33], v8 offset:15360
    ds_read_b64_tr_b16 v[34:35], v8 offset:16640
    ds_read_b64_tr_b16 v[128:129], v8 offset:15400
    ds_read_b64_tr_b16 v[130:131], v8 offset:16680
    s_waitcnt lgkmcnt(12)
    v_mfma_f32_16x16x32_bf16 v[24:27], v[36:39], v[160:163], v[24:27]
    v_mfma_f32_16x16x32_bf16 v[28:31], v[36:39], v[164:167], v[28:31]
    s_waitcnt lgkmcnt(10)
    s_sub_u32 s75, s69, 1280
    s_add_u32 m0, s70, 151552
    v_mfma_f32_16x16x32_bf16 v[16:19], v[40:43], v[168:171], v[16:19]
    v_mfma_f32_16x16x32_bf16 v[20:23], v[40:43], v[172:175], v[20:23]
    buffer_load_dwordx4 v4, s[20:23], s75 offen lds
    s_cmp_eq_u32 s44, 0
    s_cbranch_scc1 L_nof2_11
    s_waitcnt lgkmcnt(6)
    s_sub_u32 s3, s44, 1
    s_mul_i32 s3, s3, 3072
    v_add_u32 v11, s3, v7
    ds_read_b64 v[96:97], v11 offset:32768
    ds_read_b64 v[100:101], v11 offset:33280
    ds_read_b64 v[72:73], v11 offset:33792
    ds_read_b64 v[78:79], v11 offset:34304
    ds_read_b64 v[98:99], v11 offset:22528
    ds_read_b64 v[102:103], v11 offset:22528
    ds_read_b64 v[84:85], v11 offset:34816
L_nof2_11:
    s_waitcnt lgkmcnt(8)
    v_mfma_f32_16x16x32_bf16 v[24:27], v[44:47], v[168:171], v[24:27]
    v_mfma_f32_16x16x32_bf16 v[28:31], v[44:47], v[172:175], v[28:31]
    s_waitcnt lgkmcnt(6)
    v_mfma_f32_16x16x32_bf16 v[16:19], v[48:51], v[176:179], v[16:19]
    v_mfma_f32_16x16x32_bf16 v[20:23], v[48:51], v[180:183], v[20:23]
    v_add_u32 v8, -122880, v8
    v_add_u32 v9, -122880, v9
    s_waitcnt vmcnt(4) lgkmcnt(0)
    s_barrier
    ds_read_b64_tr_b16 v[132:133], v8 offset:0
    ds_read_b64_tr_b16 v[134:135], v8 offset:1280
    ds_read_b64_tr_b16 v[136:137], v8 offset:40
    ds_read_b64_tr_b16 v[138:139], v8 offset:1320
    ds_read_b64_tr_b16 v[140:141], v8 offset:5120
    ds_read_b64_tr_b16 v[142:143], v8 offset:6400
    ds_read_b64_tr_b16 v[144:145], v8 offset:5160
    ds_read_b64_tr_b16 v[146:147], v8 offset:6440
    ds_read_b64_tr_b16 v[148:149], v8 offset:10240
    ds_read_b64_tr_b16 v[150:151], v8 offset:11520
    ds_read_b64_tr_b16 v[152:153], v8 offset:10280
    ds_read_b64_tr_b16 v[154:155], v8 offset:11560
    v_mfma_f32_16x16x32_bf16 v[24:27], v[52:55], v[176:179], v[24:27]
    v_mfma_f32_16x16x32_bf16 v[28:31], v[52:55], v[180:183], v[28:31]
    ds_read_b64_tr_b16 v[36:37], v8 offset:15360
    ds_read_b64_tr_b16 v[38:39], v8 offset:16640
    v_mfma_f32_16x16x32_bf16 v[16:19], v[32:35], v[184:187], v[16:19]
    v_mfma_f32_16x16x32_bf16 v[20:23], v[32:35], v[188:191], v[20:23]
    s_cmp_eq_u32 s87, 0
    s_cbranch_scc1 L_nohl_11
    s_add_u32 s3, s49, 3072
    buffer_load_dwordx2 v[96:97], v7, s[32:35], s3 offen sc1
    s_add_u32 s3, s49, 3584
    buffer_load_dwordx2 v[100:101], v7, s[32:35], s3 offen sc1
    s_add_u32 s3, s49, 4096
    buffer_load_dwordx2 v[72:73], v7, s[32:35], s3 offen sc1
    s_add_u32 s3, s49, 4608
    buffer_load_dwordx2 v[78:79], v7, s[32:35], s3 offen sc1
    s_add_u32 s3, s49, 2048
    buffer_load_dwordx2 v[98:99], v7, s[32:35], s3 offen sc1
    s_add_u32 s3, s49, 5120
    buffer_load_dwordx2 v[84:85], v7, s[32:35], s3 offen sc1
    s_add_u32 s3, s49, 2048
    buffer_load_dwordx2 v[102:103], v7, s[32:35], s3 offen sc1
L_nohl_11:
    ds_read_b64_tr_b16 v[40:41], v8 offset:15400
    s_waitcnt lgkmcnt(12)
    ds_read_b64_tr_b16 v[42:43], v8 offset:16680
    v_mfma_f32_16x16x32_bf16 v[24:27], v[128:131], v[184:187], v[24:27]
    v_mfma_f32_16x16x32_bf16 v[28:31], v[128:131], v[188:191], v[28:31]
    s_add_u32 s75, s93, 0
    s_add_u32 m0, s70, 61440
    v_mfma_f32_16x16x32_bf16 v[16:19], v[132:135], v[192:195], v[16:19]
    v_mfma_f32_16x16x32_bf16 v[20:23], v[132:135], v[196:199], v[20:23]
    buffer_load_dwordx4 v90, s[24:27], s75 offen lds
    s_waitcnt lgkmcnt(12)
    v_mfma_f32_16x16x32_bf16 v[24:27], v[136:139], v[192:195], v[24:27]
    v_mfma_f32_16x16x32_bf16 v[28:31], v[136:139], v[196:199], v[28:31]
    s_waitcnt lgkmcnt(10)
    s_add_u32 s75, s93, 0
    s_add_u32 m0, s70, 69632
    v_mfma_f32_16x16x32_bf16 v[16:19], v[140:143], v[200:203], v[16:19]
    v_mfma_f32_16x16x32_bf16 v[20:23], v[140:143], v[204:207], v[20:23]
    buffer_load_dwordx4 v91, s[24:27], s75 offen lds
    s_waitcnt lgkmcnt(8)
    v_mfma_f32_16x16x32_bf16 v[24:27], v[144:147], v[200:203], v[24:27]
    v_mfma_f32_16x16x32_bf16 v[28:31], v[144:147], v[204:207], v[28:31]
    s_waitcnt lgkmcnt(6)
    v_mfma_f32_16x16x32_bf16 v[16:19], v[148:151], v[208:211], v[16:19]
    v_mfma_f32_16x16x32_bf16 v[20:23], v[148:151], v[212:215], v[20:23]
    v_add_u32 v8, 143360, v8
    v_add_u32 v9, 143360, v9
    s_cmp_lg_u32 s87, 0
    s_cbranch_scc1 L_gw7334
    s_waitcnt vmcnt(2) lgkmcnt(0)
    s_branch L_gx7334
L_gw7334:
    s_waitcnt vmcnt(9) lgkmcnt(0)
L_gx7334:
    s_barrier
    ds_read_b64_tr_b16 v[44:45], v8 offset:0
    ds_read_b64_tr_b16 v[46:47], v8 offset:1280
    ds_read_b64_tr_b16 v[48:49], v8 offset:5120
    ds_read_b64_tr_b16 v[50:51], v8 offset:6400
    ds_read_b64_tr_b16 v[52:53], v8 offset:10240
    ds_read_b64_tr_b16 v[54:55], v8 offset:11520
    ds_read_b64_tr_b16 v[32:33], v8 offset:15360
    ds_read_b64_tr_b16 v[34:35], v8 offset:16640
    ds_read_b64_tr_b16 v[128:129], v8 offset:40
    ds_read_b64_tr_b16 v[130:131], v8 offset:1320
    ds_read_b64_tr_b16 v[132:133], v8 offset:5160
    ds_read_b64_tr_b16 v[134:135], v8 offset:6440
    v_mfma_f32_16x16x32_bf16 v[24:27], v[152:155], v[208:211], v[24:27]
    v_mfma_f32_16x16x32_bf16 v[28:31], v[152:155], v[212:215], v[28:31]
    ds_read_b64_tr_b16 v[136:137], v8 offset:10280
    ds_read_b64_tr_b16 v[138:139], v8 offset:11560
    v_mfma_f32_16x16x32_bf16 v[16:19], v[36:39], v[216:219], v[16:19]
    v_mfma_f32_16x16x32_bf16 v[20:23], v[36:39], v[220:223], v[20:23]
    ds_read_b64_tr_b16 v[140:141], v8 offset:15400
    s_waitcnt lgkmcnt(12)
    ds_read_b64_tr_b16 v[142:143], v8 offset:16680
    s_add_u32 s75, s93, 163840
    s_add_u32 m0, s70, 81920
    v_mfma_f32_16x16x32_bf16 v[24:27], v[40:43], v[216:219], v[24:27]
    v_mfma_f32_16x16x32_bf16 v[28:31], v[40:43], v[220:223], v[28:31]
    buffer_load_dwordx4 v90, s[24:27], s75 offen lds
    v_mfma_f32_16x16x32_bf16 v[16:19], v[44:47], v[224:227], v[16:19]
    v_mfma_f32_16x16x32_bf16 v[20:23], v[44:47], v[228:231], v[20:23]
    s_waitcnt lgkmcnt(12)
    v_mfma_f32_16x16x32_bf16 v[16:19], v[48:51], v[232:235], v[16:19]
    v_mfma_f32_16x16x32_bf16 v[20:23], v[48:51], v[236:239], v[20:23]
    s_waitcnt lgkmcnt(10)
    s_add_u32 s75, s93, 163840
    s_add_u32 m0, s70, 90112
    v_mfma_f32_16x16x32_bf16 v[16:19], v[52:55], v[240:243], v[16:19]
    v_mfma_f32_16x16x32_bf16 v[20:23], v[52:55], v[244:247], v[20:23]
    buffer_load_dwordx4 v91, s[24:27], s75 offen lds
    s_waitcnt lgkmcnt(8)
    v_mfma_f32_16x16x32_bf16 v[16:19], v[32:35], v[248:251], v[16:19]
    v_mfma_f32_16x16x32_bf16 v[20:23], v[32:35], v[252:255], v[20:23]
    s_waitcnt lgkmcnt(6)
    v_mfma_f32_16x16x32_bf16 v[24:27], v[128:131], v[224:227], v[24:27]
    v_mfma_f32_16x16x32_bf16 v[28:31], v[128:131], v[228:231], v[28:31]
    s_nop 3
    v_cvt_pk_bf16_f32 v160, v16, v17
    v_cvt_pk_bf16_f32 v161, v18, v19
    v_cvt_pk_bf16_f32 v168, v20, v21
    v_cvt_pk_bf16_f32 v169, v22, v23
    s_waitcnt lgkmcnt(4)
    v_mfma_f32_16x16x32_bf16 v[24:27], v[132:135], v[232:235], v[24:27]
    v_mfma_f32_16x16x32_bf16 v[28:31], v[132:135], v[236:239], v[28:31]
    s_waitcnt lgkmcnt(2)
    v_mfma_f32_16x16x32_bf16 v[24:27], v[136:139], v[240:243], v[24:27]
    v_mfma_f32_16x16x32_bf16 v[28:31], v[136:139], v[244:247], v[28:31]
    s_waitcnt lgkmcnt(0)
    v_mfma_f32_16x16x32_bf16 v[24:27], v[140:143], v[248:251], v[24:27]
    v_mfma_f32_16x16x32_bf16 v[28:31], v[140:143], v[252:255], v[28:31]
    s_add_u32 s75, s93, 327680
    s_add_u32 m0, s70, 102400
    s_nop 0
    buffer_load_dwordx4 v90, s[24:27], s75 offen lds
    s_add_u32 s75, s93, 327680
    s_add_u32 m0, s70, 110592
    s_nop 0
    buffer_load_dwordx4 v91, s[24:27], s75 offen lds
    s_add_u32 s75, s93, 491520
    s_add_u32 m0, s70, 122880
    s_nop 0
    buffer_load_dwordx4 v90, s[24:27], s75 offen lds
    v_cvt_pk_bf16_f32 v164, v24, v25
    v_cvt_pk_bf16_f32 v165, v26, v27
    v_cvt_pk_bf16_f32 v172, v28, v29
    v_cvt_pk_bf16_f32 v173, v30, v31
    s_cmp_eq_u32 s44, 0
    s_cbranch_scc0 L_hdone_11
    s_cmp_eq_u32 s41, 0
    s_cbranch_scc0 L_hwait_11
    v_mov_b32 v96, 0
    v_mov_b32 v97, 0
    v_mov_b32 v100, 0
    v_mov_b32 v101, 0
    v_mov_b32 v72, 0
    v_mov_b32 v73, 0
    v_mov_b32 v78, 0
    v_mov_b32 v79, 0
    v_mov_b32 v98, 0
    v_mov_b32 v99, 0
    v_mov_b32 v84, 0
    v_mov_b32 v85, 0
    v_mov_b32 v102, 0
    v_mov_b32 v103, 0
    v_mov_b32 v120, 0xf149f2ca
    v_mov_b32 v121, 0xf149f2ca
    v_mov_b32 v122, 0xf149f2ca
    v_mov_b32 v123, 0xf149f2ca
    s_branch L_hok_11
L_hwait_11:
    s_waitcnt vmcnt(7)
    v_max3_u32 v228, v96, v97, v100
    v_max3_u32 v228, v228, v101, v72
    v_max3_u32 v228, v228, v73, v78
    v_max3_u32 v228, v228, v79, v98
    v_max3_u32 v228, v228, v99, v84
    v_max3_u32 v228, v228, v85, v102
    v_max_u32 v228, v228, v103
    v_cmp_eq_u32 vcc, -1, v228
    s_cbranch_vccz L_hok_11
    s_mov_b32 s92, 0
L_hsp_11:
    s_add_u32 s3, s49, 3072
    buffer_load_dwordx2 v[96:97], v7, s[32:35], s3 offen sc1
    s_add_u32 s3, s49, 3584
    buffer_load_dwordx2 v[100:101], v7, s[32:35], s3 offen sc1
    s_add_u32 s3, s49, 4096
    buffer_load_dwordx2 v[72:73], v7, s[32:35], s3 offen sc1
    s_add_u32 s3, s49, 4608
    buffer_load_dwordx2 v[78:79], v7, s[32:35], s3 offen sc1
    s_add_u32 s3, s49, 2048
    buffer_load_dwordx2 v[98:99], v7, s[32:35], s3 offen sc1
    s_add_u32 s3, s49, 5120
    buffer_load_dwordx2 v[84:85], v7, s[32:35], s3 offen sc1
    s_add_u32 s3, s49, 2048
    buffer_load_dwordx2 v[102:103], v7, s[32:35], s3 offen sc1
    s_waitcnt vmcnt(0)
    v_max3_u32 v228, v96, v97, v100
    v_max3_u32 v228, v228, v101, v72
    v_max3_u32 v228, v228, v73, v78
    v_max3_u32 v228, v228, v79, v98
    v_max3_u32 v228, v228, v99, v84
    v_max3_u32 v228, v228, v85, v102
    v_max_u32 v228, v228, v103
    v_cmp_eq_u32 vcc, -1, v228
    s_cbranch_vccz L_hok_11
    s_add_u32 s92, s92, 1
    s_cmp_lt_u32 s92, 200000
    s_cbranch_scc1 L_hsp_11
L_hok_11:
L_hdone_11:
    s_waitcnt lgkmcnt(0)
    s_barrier
    ds_read_b64 v[156:157], v124 offset:49152
    ds_read_b64 v[158:159], v124 offset:49664
    s_waitcnt lgkmcnt(1)
    s_mov_b32 vcc_lo, 0x0
    s_mov_b32 vcc_hi, 0xffff
    v_cndmask_b32 v162, v127, v156, vcc
    v_cndmask_b32 v163, v127, v157, vcc
    s_mov_b32 vcc_lo, 0x0
    s_mov_b32 vcc_hi, 0xffff0000
    v_cndmask_b32 v166, v127, v156, vcc
    v_cndmask_b32 v167, v127, v157, vcc
    v_mfma_f32_16x16x32_bf16 v[176:179], v[96:99], v[160:163], v[120:123]
    v_mfma_f32_16x16x32_bf16 v[180:183], v[56:59], v[160:163], v[104:107]
    v_mfma_f32_16x16x32_bf16 v[184:187], v[100:103], v[164:167], v[120:123]
    v_mfma_f32_16x16x32_bf16 v[188:191], v[60:63], v[164:167], v[104:107]
    s_waitcnt lgkmcnt(0)
    s_mov_b32 vcc_lo, 0x0
    s_mov_b32 vcc_hi, 0xffff
    v_cndmask_b32 v170, v127, v158, vcc
    v_cndmask_b32 v171, v127, v159, vcc
    s_mov_b32 vcc_lo, 0x0
    s_mov_b32 vcc_hi, 0xffff0000
    v_cndmask_b32 v174, v127, v158, vcc
    v_cndmask_b32 v175, v127, v159, vcc
    v_mfma_f32_16x16x32_bf16 v[192:195], v[56:59], v[168:171], v[108:111]
    v_mfma_f32_16x16x32_bf16 v[196:199], v[64:67], v[168:171], v[104:107]
    v_mfma_f32_16x16x32_bf16 v[200:203], v[60:63], v[172:175], v[108:111]
    v_mfma_f32_16x16x32_bf16 v[204:207], v[68:71], v[172:175], v[104:107]
    s_add_u32 s75, s93, 491520
    s_add_u32 m0, s70, 131072
    s_nop 0
    buffer_load_dwordx4 v91, s[24:27], s75 offen lds
    s_add_u32 s75, s93, 655360
    s_add_u32 m0, s70, 143360
    s_nop 0
    buffer_load_dwordx4 v90, s[24:27], s75 offen lds
    v_max3_f32 v228, v176, v177, v180
    v_max3_f32 v229, v178, v179, v182
    v_max_f32 v228, v228, v181
    v_max_f32 v229, v229, v183
    v_max_f32 v236, v228, v229
    v_max3_f32 v230, v184, v185, v188
    v_max3_f32 v231, v186, v187, v190
    v_max_f32 v230, v230, v189
    v_max_f32 v231, v231, v191
    v_max_f32 v237, v230, v231
    v_max3_f32 v232, v192, v193, v196
    v_max3_f32 v233, v194, v195, v198
    v_max_f32 v232, v232, v197
    v_max_f32 v233, v233, v199
    v_max_f32 v238, v232, v233
    v_max3_f32 v234, v200, v201, v204
    v_max3_f32 v235, v202, v203, v206
    v_max_f32 v234, v234, v205
    v_max_f32 v235, v235, v207
    v_max_f32 v239, v234, v235
    v_permlane32_swap_b32 v236, v237
    s_nop 0
    v_permlane32_swap_b32 v238, v239
    v_max_f32 v236, v236, v237
    v_max_f32 v238, v238, v239
    s_nop 1
    v_permlane16_swap_b32 v236, v238
    v_max_f32 v236, v236, v238
    v_mul_f32 v236, 0xbea52b5c, v236
    v_mov_b32 v238, v236
    s_nop 1
    v_permlane16_swap_b32 v236, v238
    v_mov_b32 v237, v236
    v_mov_b32 v239, v238
    s_nop 0
    v_permlane32_swap_b32 v236, v237
    v_permlane32_swap_b32 v238, v239
    s_add_u32 s75, s93, 655360
    s_add_u32 m0, s70, 151552
    s_nop 0
    buffer_load_dwordx4 v91, s[24:27], s75 offen lds
    v_fmamk_f32 v228, v228, 0x3ea52b5c, v236
    v_fmamk_f32 v229, v229, 0x3ea52b5c, v236
    v_fmamk_f32 v230, v230, 0x3ea52b5c, v237
    v_fmamk_f32 v231, v231, 0x3ea52b5c, v237
    v_fmamk_f32 v232, v232, 0x3ea52b5c, v238
    v_fmamk_f32 v233, v233, 0x3ea52b5c, v238
    v_fmamk_f32 v234, v234, 0x3ea52b5c, v239
    v_fmamk_f32 v235, v235, 0x3ea52b5c, v239
    v_exp_f32 v228, v228
    v_exp_f32 v229, v229
    v_exp_f32 v230, v230
    v_exp_f32 v231, v231
    v_exp_f32 v232, v232
    v_exp_f32 v233, v233
    v_exp_f32 v234, v234
    v_exp_f32 v235, v235
    v_cvt_pk_bf16_f32 v228, v228, v228
    v_cvt_pk_bf16_f32 v229, v229, v229
    v_and_b32 v208, v228, v116
    v_and_b32 v209, v229, v117
    v_and_b32 v210, v228, v118
    v_and_b32 v211, v229, v119
    s_nop 1
    v_mfma_f32_16x16x32_bf16 v[24:27], v[112:115], v[208:211], 0
    v_mfma_f32_16x16x32_bf16 v[16:19], v[72:75], v[208:211], 0
    v_mfma_f32_16x16x32_bf16 v[20:23], v[84:87], v[208:211], 0
    v_cvt_pk_bf16_f32 v230, v230, v230
    v_cvt_pk_bf16_f32 v231, v231, v231
    v_and_b32 v212, v230, v116
    v_and_b32 v213, v231, v117
    v_and_b32 v214, v230, v118
    v_and_b32 v215, v231, v119
    s_nop 1
    v_mfma_f32_16x16x32_bf16 v[36:39], v[112:115], v[212:215], 0
    v_mfma_f32_16x16x32_bf16 v[28:31], v[78:81], v[212:215], 0
    v_mfma_f32_16x16x32_bf16 v[32:35], v[84:87], v[212:215], 0
    v_cvt_pk_bf16_f32 v232, v232, v232
    v_cvt_pk_bf16_f32 v233, v233, v233
    v_and_b32 v216, v232, v116
    v_and_b32 v217, v233, v117
    v_and_b32 v218, v232, v118
    v_and_b32 v219, v233, v119
    s_nop 1
    v_mfma_f32_16x16x32_bf16 v[48:51], v[112:115], v[216:219], 0
    v_mfma_f32_16x16x32_bf16 v[40:43], v[74:77], v[216:219], 0
    v_mfma_f32_16x16x32_bf16 v[44:47], v[86:89], v[216:219], 0
    v_cvt_pk_bf16_f32 v234, v234, v234
    v_cvt_pk_bf16_f32 v235, v235, v235
    v_and_b32 v220, v234, v116
    v_and_b32 v221, v235, v117
    v_and_b32 v222, v234, v118
    v_and_b32 v223, v235, v119
    s_nop 1
    v_mfma_f32_16x16x32_bf16 v[136:139], v[112:115], v[220:223], 0
    v_mfma_f32_16x16x32_bf16 v[128:131], v[80:83], v[220:223], 0
    v_mfma_f32_16x16x32_bf16 v[132:135], v[86:89], v[220:223], 0
    s_mov_b32 vcc_lo, 0x0
    s_mov_b32 vcc_hi, 0xffff
    v_rcp_f32 v48, v48
    s_nop 2
    v_rcp_f32 v136, v136
    s_nop 0
    v_cndmask_b32 v44, v132, v44, vcc
    v_cndmask_b32 v45, v133, v45, vcc
    v_cndmask_b32 v46, v134, v46, vcc
    v_cndmask_b32 v47, v135, v47, vcc
    v_mul_f32 v40, v40, v48
    v_mul_f32 v41, v41, v48
    v_mul_f32 v42, v42, v48
    v_mul_f32 v43, v43, v48
    v_mul_f32 v128, v128, v136
    v_mul_f32 v129, v129, v136
    v_mul_f32 v130, v130, v136
    v_mul_f32 v131, v131, v136
    v_cndmask_b32 v48, v136, v48, vcc
    v_cvt_pk_bf16_f32 v180, v40, v41
    v_cvt_pk_bf16_f32 v181, v42, v43
    v_cvt_pk_bf16_f32 v182, v128, v129
    v_cvt_pk_bf16_f32 v183, v130, v131
    v_mul_f32 v44, v44, v48
    v_mul_f32 v45, v45, v48
    v_mul_f32 v46, v46, v48
    v_mul_f32 v47, v47, v48
    v_cvt_pk_bf16_f32 v186, v44, v45
    v_cvt_pk_bf16_f32 v187, v46, v47
    v_rcp_f32 v24, v24
    v_rcp_f32 v36, v36
    v_cndmask_b32 v20, v32, v20, vcc
    v_cndmask_b32 v21, v33, v21, vcc
    v_cndmask_b32 v22, v34, v22, vcc
    v_cndmask_b32 v23, v35, v23, vcc
    v_mul_f32 v16, v16, v24
    v_mul_f32 v17, v17, v24
    v_mul_f32 v18, v18, v24
    v_mul_f32 v19, v19, v24
    v_mul_f32 v28, v28, v36
    v_mul_f32 v29, v29, v36
    v_mul_f32 v30, v30, v36
    v_mul_f32 v31, v31, v36
    v_cndmask_b32 v24, v36, v24, vcc
    v_cvt_pk_bf16_f32 v176, v16, v17
    v_cvt_pk_bf16_f32 v177, v18, v19
    v_cvt_pk_bf16_f32 v178, v28, v29
    v_cvt_pk_bf16_f32 v179, v30, v31
    v_mul_f32 v20, v20, v24
    v_mul_f32 v21, v21, v24
    v_mul_f32 v22, v22, v24
    v_mul_f32 v23, v23, v24
    v_cvt_pk_bf16_f32 v184, v20, v21
    v_cvt_pk_bf16_f32 v185, v22, v23
    s_mul_i32 s3, s42, 2560
    s_add_u32 s3, s3, s76
    s_add_u32 s3, s3, 1280
    s_add_u32 s4, s3, 20480
    s_lshr_b32 s5, s42, 1
    s_mul_i32 s5, s5, 5120
    s_and_b32 s6, s42, 1
    s_lshl_b32 s6, s6, 3
    s_add_u32 s5, s5, s6
    s_add_u32 s5, s5, s76
    s_add_u32 s6, s5, 20480
    v_lshrrev_b32 v14, 4, v10
    v_mul_u32_u24 v14, 1024, v14
    v_add_u32 v14, v14, v6
    v_mov_b32 v11, s47
    s_cmp_eq_u32 s48, 1
    s_cbranch_scc1 L_fast_11
    buffer_store_dwordx4 v[176:179], v6, s[32:35], s3 offen sc1
    buffer_store_dwordx4 v[180:183], v6, s[32:35], s4 offen sc1
    s_mov_b32 exec_lo, 0
    buffer_store_dwordx2 v[184:185], v14, s[32:35], s5 offen offset:1024 sc1
    buffer_store_dwordx2 v[186:187], v14, s[32:35], s6 offen offset:1024 sc1
    s_branch L_pubd_11
L_fast_11:
    buffer_store_dwordx4 v[176:179], v6, s[32:35], s3 offen nt
    buffer_store_dwordx4 v[180:183], v6, s[32:35], s4 offen nt
    s_mov_b32 exec_lo, 0
    buffer_store_dwordx2 v[184:185], v14, s[32:35], s5 offen offset:1024 nt
    buffer_store_dwordx2 v[186:187], v14, s[32:35], s6 offen offset:1024 nt
L_pubd_11:
    s_mov_b64 exec, -1
    s_mul_i32 s7, s85, 51200
    s_add_u32 s7, s7, 61440
    v_and_b32 v0, 3, v10
    v_lshrrev_b32 v1, 2, v10
    v_mul_u32_u24 v1, 160, v1
    v_lshl_add_u32 v1, v0, 3, v1
    v_add_u32 v1, s7, v1
    v_lshrrev_b32 v2, 4, v10
    v_mul_u32_u24 v2, 20, v2
    v_bfe_u32 v3, v10, 2, 2
    v_add_u32 v2, v2, v3
    v_mul_u32_u24 v2, 160, v2
    v_lshl_add_u32 v2, v0, 3, v2
    v_add_u32 v2, s7, v2
    v_lshlrev_b32 v3, 2, v10
    s_mul_i32 s7, s43, 5120
    v_add_u32 v7, s7, v6
    s_xor_b32 s7, s43, 1
    s_mul_i32 s7, s7, 5120
    v_add_u32 v4, s7, v6
    s_waitcnt vmcnt(4) lgkmcnt(0)
    s_branch L_phase2
L_codeend:
.section .rodata,"a"
.p2align 6
.amdhsa_kernel concat_heads__linear_attn_block__sliding_local_dilated__prompt_kernel
  .amdhsa_next_free_vgpr 256
  .amdhsa_next_free_sgpr 102
  .amdhsa_accum_offset 256
  .amdhsa_group_segment_fixed_size 0
  .amdhsa_kernarg_size 72
  .amdhsa_user_sgpr_count 2
  .amdhsa_user_sgpr_kernarg_segment_ptr 1
  .amdhsa_system_sgpr_workgroup_id_x 1
.end_amdhsa_kernel
```
